```python
import torch

def _softmax(x, axis=-1):
    return torch.softmax(x, dim=axis)
def _gelu(x):
    return torch.nn.functional.gelu(x, approximate="tanh")
def _silu(x):
    return torch.nn.functional.silu(x)
def _sigmoid(x):
    return torch.sigmoid(x)
def _layernorm(x, axis=-1, eps=1e-5):
    m = x.mean(dim=axis, keepdim=True)
    v = x.var(dim=axis, keepdim=True, unbiased=False)
    return (x - m) / torch.sqrt(v + eps)
def _scatter_add(tgt, idx, src, axis=0):
    return tgt.clone().index_add_(axis, idx, src)
def _segment_sum(src, seg, n):
    out = torch.zeros((n,) + src.shape[1:], dtype=src.dtype)
    return out.index_add_(0, seg, src)
def _pad(x, pw):
    flat = tuple(v for pair in reversed(pw) for v in pair)
    return torch.nn.functional.pad(x, flat)

kernel_name = 'parallel_sum__compressed_kv_cla__dense_activation_relu__prompt'

def setup_inputs():

    _w = (lambda a: (lambda t: t.to(torch.bfloat16) if t.is_floating_point() else t)(torch.as_tensor(a)))
    def _A_setup():
        B, H, Sq, Sk, D, M = 1, 32, 2048, 2048, 128, 640
        Dc = 4 * D
        return {
            "x": _w((lambda *s: torch.randn(*s, dtype=torch.bfloat16) * 0.05)(B, Sq, M)),
            "c_kv": _w((lambda *s: torch.randn(*s, dtype=torch.bfloat16) * 1.6)(B, Sk, Dc)),
            "w_q": _w((lambda *s: torch.randn(*s, dtype=torch.bfloat16) * 0.8)(M, H, D) * (M ** -0.5)),
            "w_uk": _w((lambda *s: torch.randn(*s, dtype=torch.bfloat16) * 0.8)(Dc, H, D) * (Dc ** -0.5)),
            "w_uv": _w((lambda *s: torch.randn(*s, dtype=torch.bfloat16) * 1.6)(Dc, H, D) * (Dc ** -0.5)),
            "w_o": _w((lambda *s: torch.randn(*s, dtype=torch.bfloat16) * 1.6)(H, D, M) * ((H * D) ** -0.5)),
        }
    _A_in = _A_setup()

    def _B_setup():
        B, S, D, Dff = 1, 2048, 640, 1728
        return {
            "x": _w((lambda *s: torch.randn(*s, dtype=torch.bfloat16) * 0.05)(B, S, D)),
            "w1": _w((lambda *s: torch.randn(*s, dtype=torch.bfloat16) * 0.05)(D, Dff)),
            "w2": _w((lambda *s: torch.randn(*s, dtype=torch.bfloat16) * 0.05)(Dff, D)),
        }
    _B_in = _B_setup()

    return {
        "A_x": _A_in["x"],
        "A_c_kv": _A_in["c_kv"],
        "A_w_q": _A_in["w_q"],
        "A_w_uk": _A_in["w_uk"],
        "A_w_uv": _A_in["w_uv"],
        "A_w_o": _A_in["w_o"],
        "B_x": _B_in["x"],
        "B_w1": _B_in["w1"],
        "B_w2": _B_in["w2"],
    }

def reference(A_x, A_c_kv, A_w_q, A_w_uk, A_w_uv, A_w_o, B_x, B_w1, B_w2):
    def _A_ref(x, c_kv, w_q, w_uk, w_uv, w_o):
        B, Sq, M = x.shape[0], x.shape[1], x.shape[2]
        Sk = c_kv.shape[1]
        H, D = w_q.shape[1], w_q.shape[2]
        q = torch.einsum("bqm,mhd->bhqd", x, w_q)
        k = torch.einsum("bkc,chd->bhkd", c_kv, w_uk)
        v = torch.einsum("bkc,chd->bhkd", c_kv, w_uv)
        scores = torch.einsum("bhqd,bhkd->bhqk", q, k) * (D ** -0.5)
        off = Sk - Sq
        qi = torch.arange(Sq)[:, None]
        kj = torch.arange(Sk)[None, :]
        cmask = kj <= (qi + off)
        scores = torch.where(cmask[None, None], scores, -1e9)
        p = _softmax(scores, axis=-1)
        ctx = torch.einsum("bhqk,bhkd->bhqd", p, v)
        return torch.einsum("bhqd,hdm->bqm", ctx, w_o)

    def _B_ref(x, w1, w2):
        h = torch.einsum("bsd,df->bsf", x, w1)
        zero = torch.zeros_like(h)
        h = torch.maximum(h, zero)
        return torch.einsum("bsf,fd->bsd", h, w2)

    x = A_x
    xn = _layernorm(x, axis=-1)
    return x + _A_ref(xn, A_c_kv, A_w_q, A_w_uk, A_w_uv, A_w_o) + _B_ref(xn, B_w1, B_w2)
```

```asm
; @launch grid=(256,1,1) block=(512,1,1) lds=163840
.amdgcn_target "amdgcn-amd-amdhsa--gfx950"
.macro MF d, a, b, c
v_mfma_f32_16x16x32_bf16 v[\d:\d+3], v[\a:\a+3], v[\b:\b+3], v[\c:\c+3]
.endm
.macro TR d, a, o
ds_read_b64_tr_b16 v[\d:\d+1], v\a offset:\o
.endm
.macro RD d, a, o
ds_read_b128 v[\d:\d+3], v\a offset:\o
.endm
.text
.globl parallel_sum__compressed_kv_cla__dense_activation_relu__prompt_kernel
.p2align 8
.type parallel_sum__compressed_kv_cla__dense_activation_relu__prompt_kernel,@function
parallel_sum__compressed_kv_cla__dense_activation_relu__prompt_kernel:
 s_cmp_lt_u32 s2, 256
 s_cbranch_scc1 L_go
 s_endpgm
L_go:
 s_load_dwordx16 s[64:79], s[0:1], 0
 s_load_dwordx8 s[80:87], s[0:1], 64
 v_lshrrev_b32 v16, 6, v0
 v_and_b32 v0, 63, v0
 v_readfirstlane_b32 s48, v16
 v_lshlrev_b32 v1, 4, v0
 v_mov_b32 v4, 0
 s_and_b32 s57, s2, 7
 s_lshr_b32 s58, s2, 3
 s_lshl_b32 s49, s57, 2
 s_and_b32 s57, s58, 3
 s_add_u32 s49, s49, s57
 s_lshr_b32 s50, s58, 2
 s_lshr_b32 s92, 0x20202022, s49
 s_and_b32 s92, s92, 1
 s_bfm_b32 s3, s49, 0
 s_and_b32 s3, s3, 0x20202022
 s_bcnt1_i32_b32 s3, s3
 s_sub_u32 s3, s49, s3
 s_mov_b32 s63, 0
 s_sub_u32 s57, 15, s50
 s_cmp_lt_u32 s48, 4
 s_cselect_b32 s57, s57, s50
 s_lshl_b32 s51, s57, 2
 s_and_b32 s57, s48, 3
 s_add_u32 s51, s51, s57
 s_lshl_b32 s52, s48, 12
 s_mul_i32 s53, s48, 1056
 v_lshrrev_b32 v16, 4, v0
 v_and_b32 v17, 15, v0
 v_lshrrev_b32 v18, 3, v0
 v_and_b32 v19, 7, v0
 s_lshl_b32 s57, s50, 8
 s_lshl_b32 s58, s48, 5
 s_add_u32 s57, s57, s58
 v_add_u32 v18, s57, v18
 v_lshlrev_b32 v18, 10, v18
 v_xor_b32 v19, v19, v16
 v_lshlrev_b32 v19, 4, v19
 v_add_u32 v112, v18, v19
 v_xor_b32 v113, 64, v112
 v_add_u32 v113, 0x2000, v113
 v_add_u32 v114, 0x4000, v112
 v_add_u32 v115, 0x4000, v113
 v_and_b32 v18, 1, v16
 v_lshlrev_b32 v18, 2, v18
 v_lshrrev_b32 v19, 1, v16
 v_lshl_add_u32 v18, v19, 4, v18
 s_lshr_b32 s57, s48, 2
 s_lshl_b32 s57, s57, 3
 s_and_b32 s58, s48, 3
 s_add_u32 s57, s57, s58
 v_add_u32 v18, s57, v18
 v_lshlrev_b32 v18, 13, v18
 v_lshl_add_u32 v18, v17, 4, v18
 s_lshl_b32 s57, s49, 8
 v_add_u32 v2, s57, v18
 s_waitcnt lgkmcnt(0)
 s_mov_b32 s8, s66
 s_and_b32 s9, s67, 0xffff
 s_mov_b32 s10, 0x200000
 s_mov_b32 s11, 0x20000
 s_mov_b32 s16, s70
 s_and_b32 s17, s71, 0xffff
 s_mov_b32 s18, 0x400000
 s_mov_b32 s19, 0x20000
 s_mov_b32 s20, s72
 s_and_b32 s21, s73, 0xffff
 s_mov_b32 s22, 0x400000
 s_mov_b32 s23, 0x20000
 s_mov_b32 s4, s64
 s_and_b32 s5, s65, 0xffff
 s_mov_b32 s6, 0x280000
 s_mov_b32 s7, 0x20000
 s_add_u32 s54, s63, 0
 s_and_b32 s54, s54, 7
 s_lshl_b32 s55, s54, 19
 s_lshl_b32 s54, s54, 7
 s_add_u32 s56, s55, 0x40000
 s_add_u32 m0, s52, 0
 s_nop 0
 buffer_load_dwordx4 v112, s[8:11], s54 offen  lds
 s_add_u32 m0, s53, 32768
 s_nop 0
 buffer_load_dwordx4 v2, s[16:19], s55 offen  lds
 s_add_u32 m0, s52, 1024
 s_nop 0
 buffer_load_dwordx4 v113, s[8:11], s54 offen  lds
 s_add_u32 m0, s53, 49664
 s_nop 0
 buffer_load_dwordx4 v2, s[20:23], s55 offen  lds
 s_add_u32 m0, s52, 2048
 s_nop 0
 buffer_load_dwordx4 v114, s[8:11], s54 offen  lds
 s_add_u32 m0, s53, 41216
 s_nop 0
 buffer_load_dwordx4 v2, s[16:19], s56 offen  lds
 s_add_u32 m0, s52, 3072
 s_nop 0
 buffer_load_dwordx4 v115, s[8:11], s54 offen  lds
 s_add_u32 m0, s53, 58112
 s_nop 0
 buffer_load_dwordx4 v2, s[20:23], s56 offen  lds
 s_lshl_b32 s57, s2, 3
 s_add_u32 s57, s57, s48
 s_mul_i32 s57, s57, 1280
 v_lshlrev_b32 v18, 2, v0
 buffer_load_dword v8, v18, s[4:7], s57 offen offset:0
 buffer_load_dword v13, v18, s[4:7], s57 offen offset:256
 buffer_load_dword v14, v18, s[4:7], s57 offen offset:512
 buffer_load_dword v126, v18, s[4:7], s57 offen offset:768
 buffer_load_dword v127, v18, s[4:7], s57 offen offset:1024
 s_add_u32 s54, s63, 1
 s_and_b32 s54, s54, 7
 s_lshl_b32 s55, s54, 19
 s_lshl_b32 s54, s54, 7
 s_add_u32 s56, s55, 0x40000
 s_add_u32 m0, s52, 66560
 s_nop 0
 buffer_load_dwordx4 v112, s[8:11], s54 offen  lds
 s_add_u32 m0, s53, 99328
 s_nop 0
 buffer_load_dwordx4 v2, s[16:19], s55 offen  lds
 s_add_u32 m0, s52, 67584
 s_nop 0
 buffer_load_dwordx4 v113, s[8:11], s54 offen  lds
 s_add_u32 m0, s53, 116224
 s_nop 0
 buffer_load_dwordx4 v2, s[20:23], s55 offen  lds
 s_add_u32 m0, s52, 68608
 s_nop 0
 buffer_load_dwordx4 v114, s[8:11], s54 offen  lds
 s_add_u32 m0, s53, 107776
 s_nop 0
 buffer_load_dwordx4 v2, s[16:19], s56 offen  lds
 s_add_u32 m0, s52, 69632
 s_nop 0
 buffer_load_dwordx4 v115, s[8:11], s54 offen  lds
 s_add_u32 m0, s53, 124672
 s_nop 0
 buffer_load_dwordx4 v2, s[20:23], s56 offen  lds
 s_mov_b32 s44, s86
 s_and_b32 s45, s87, 0xffff
 s_mov_b32 s46, 0x10000000
 s_mov_b32 s47, 0x20000
 s_mov_b32 s12, s68
 s_and_b32 s13, s69, 0xffff
 s_mov_b32 s14, 0x500000
 s_mov_b32 s15, 0x20000
 s_mov_b32 s28, s78
 s_and_b32 s29, s79, 0xffff
 s_mov_b32 s30, 0x21c000
 s_mov_b32 s31, 0x20000
 s_mov_b32 s40, s84
 s_and_b32 s41, s85, 0xffff
 s_mov_b32 s42, 0x100
 s_mov_b32 s43, 0x20000
 s_mov_b32 s24, s74
 s_and_b32 s25, s75, 0xffff
 s_mov_b32 s26, 0x500000
 s_mov_b32 s27, 0x20000
 s_mov_b32 s32, s80
 s_and_b32 s33, s81, 0xffff
 s_mov_b32 s34, 0x21c000
 s_mov_b32 s35, 0x20000
 s_mov_b32 s36, s82
 s_and_b32 s37, s83, 0xffff
 s_mov_b32 s38, 0x280000
 s_mov_b32 s39, 0x20000
 s_cmp_lg_u32 s48, 6
 s_cbranch_scc1 Lpfi_1
 s_getpc_b64 s[98:99]
L_pc:
 s_lshr_b32 s57, s2, 3
 s_mul_i32 s57, s57, 8192
 v_mul_u32_u24 v122, 128, v0
 v_add_u32 v122, s57, v122
 v_and_b32 v122, 0xfffffffc, v122
 v_min_u32 v122, L_exit-L_pc, v122
 global_load_dword v123, v122, s[98:99]
Lpfi_1:
 s_cmp_lg_u32 s48, 7
 s_cbranch_scc1 Lzf_2
 s_lshl_b32 s57, s2, 9
 buffer_store_dword v4, v18, s[44:47], s57 offen sc1
 buffer_store_dword v4, v18, s[44:47], s57 offen offset:256 sc1
Lzf_2:
 v_lshrrev_b32 v19, 1, v17
 v_xor_b32 v19, v19, v16
 v_lshlrev_b32 v19, 4, v19
 v_lshl_add_u32 v19, v17, 7, v19
 s_lshr_b32 s57, s48, 2
 s_lshl_b32 s57, s57, 14
 v_add_u32 v116, s57, v19
 v_xor_b32 v117, 64, v116
 v_add_u32 v118, 66560, v116
 v_add_u32 v119, 66560, v117
 v_lshrrev_b32 v19, 2, v17
 v_and_b32 v22, 1, v16
 v_lshl_add_u32 v19, v22, 2, v19
 v_lshrrev_b32 v22, 1, v16
 v_lshlrev_b32 v22, 9, v22
 v_and_b32 v23, 3, v17
 v_lshl_add_u32 v22, v23, 3, v22
 v_mul_u32_u24 v23, 1056, v19
 v_add_u32 v23, v23, v22
 v_add_u32 v9, 87808, v23
 v_add_u32 v10, 138496, v23
 s_and_b32 s57, s48, 3
 s_lshl_b32 s57, s57, 6
 v_add_u32 v23, s57, v23
 v_add_u32 v120, 32768, v23
 v_add_u32 v121, 99328, v23
 v_lshrrev_b32 v23, 1, v19
 v_mul_u32_u24 v23, 1056, v23
 v_add_u32 v23, v23, v22
 v_and_b32 v19, 1, v19
 v_lshl_add_u32 v23, v19, 7, v23
 v_add_u32 v11, 104704, v23
 v_add_u32 v12, 155392, v23
 v_bfe_u32 v22, v0, 3, 1
 v_bfe_u32 v23, v0, 4, 1
 v_lshl_add_u32 v22, v23, 2, v22
 v_lshrrev_b32 v23, 5, v0
 v_lshl_add_u32 v22, v23, 4, v22
 s_and_b32 s57, s48, 1
 s_lshl_b32 s57, s57, 1
 s_bfe_u32 s58, s48, 0x10001
 s_lshl_b32 s58, s58, 3
 s_add_u32 s57, s57, s58
 s_lshr_b32 s58, s48, 2
 s_lshl_b32 s58, s58, 5
 s_add_u32 s57, s57, s58
 v_add_u32 v22, s57, v22
 v_mul_u32_u24 v22, 3456, v22
 v_and_b32 v23, 7, v0
 v_lshl_add_u32 v22, v23, 4, v22
 s_lshl_b32 s57, s3, 7
 v_add_u32 v3, s57, v22
 s_mul_i32 s59, s51, 40960
 s_add_u32 s59, s59, 0x20000
 s_mul_i32 s60, s49, 0x106000
 s_add_u32 s60, s60, 0x960000
 s_lshl_b32 s57, s50, 16
 s_add_u32 s60, s60, s57
 s_lshr_b32 s57, s48, 2
 s_lshl_b32 s57, s57, 15
 s_add_u32 s60, s60, s57
 s_and_b32 s57, s48, 3
 s_lshl_b32 s58, s57, 11
 s_add_u32 s61, s60, s58
 s_add_u32 s61, s61, 0x83000
 s_lshl_b32 s57, s57, 10
 s_add_u32 s60, s60, s57
 s_mul_i32 s62, s51, 0x1b000
 s_lshl_b32 s57, s3, 12
 s_add_u32 s62, s62, s57
 s_add_u32 s62, s62, 0x2a0000
 s_mov_b32 s64, 0x3e0293ee
 s_mov_b32 s65, 0x3e0293ee
 s_lshl_b32 s57, s50, 3
 s_add_u32 s57, s57, s48
 s_lshl_b32 s57, s57, 13
 s_lshl_b32 s58, s49, 8
 s_add_u32 s57, s57, s58
 v_and_b32 v122, 1, v0
 v_lshlrev_b32 v122, 7, v122
 v_add_u32 v122, s57, v122
 s_mul_i32 s57, s50, 80
 s_mul_i32 s58, s48, 10
 s_add_u32 s57, s57, s58
 v_lshrrev_b32 v124, 1, v0
 v_min_u32 v124, 1, v124
 v_add_u32 v124, s57, v124
 v_mul_u32_u24 v125, 3456, v124
 v_and_b32 v19, 1, v0
 v_lshlrev_b32 v124, 13, v124
 v_lshl_add_u32 v124, v19, 7, v124
 s_lshl_b32 s57, s3, 7
 v_add_u32 v125, s57, v125
 s_lshl_b32 s57, s49, 8
 v_add_u32 v124, s57, v124
 s_mov_b32 s73, 0
 s_mov_b32 s69, s51
 s_mul_i32 s75, s51, 0x43000
 s_lshl_b32 s57, s49, 13
 s_add_u32 s75, s75, s57
 s_add_u32 s75, s75, 0x2a20000
 s_mul_i32 s77, s49, 0x106000
 s_add_u32 s77, s77, 0x960000
 s_and_b32 s57, s48, 3
 s_lshl_b32 s57, s57, 12
 s_add_u32 s77, s77, s57
 s_add_u32 s71, s77, 0x81000
 s_add_u32 s70, s77, 8192
 s_mov_b32 s72, s57
 s_cmp_lt_u32 s57, 8192
 s_cselect_b32 s78, s77, s71
 s_sub_u32 s94, s77, s57
 s_lshl_b32 s57, s50, 15
 s_sub_u32 s94, s94, s57
 s_add_u32 s94, s94, 0x80000
 s_add_u32 s95, s94, 0x83000
 s_and_b32 s80, s2, 1
 s_bfe_u32 s57, s2, 0x20001
 s_lshl_b32 s57, s57, 2
 s_bfe_u32 s58, s2, 0x20003
 s_add_u32 s57, s57, s58
 s_lshl_b32 s79, s57, 2
 s_and_b32 s54, s48, 3
 s_add_u32 s79, s79, s54
 s_lshr_b32 s57, s48, 2
 s_lshl_b32 s58, s57, 12
 s_mul_i32 s81, s79, 0x1b000
 s_add_u32 s81, s81, s58
 s_add_u32 s81, s81, 0x2a0000
 s_mul_i32 s82, s79, 0x43000
 s_add_u32 s82, s82, s58
 s_add_u32 s82, s82, 0x2a20000
 s_lshr_b32 s55, s2, 5
 s_mul_i32 s58, s80, 6
 s_xor_b32 s55, s55, s58
 s_lshl_b32 s58, s55, 2
 s_lshr_b32 s87, 0x88888888, s58
 s_and_b32 s87, s87, 15
 s_lshl_b32 s56, s87, 2
 s_sub_u32 s56, s56, 2
 s_mul_i32 s56, s56, s80
 s_lshl_b32 s58, s56, 11
 s_add_u32 s81, s81, s58
 s_lshl_b32 s58, s80, 17
 s_add_u32 s82, s82, s58
 s_lshl_b32 s58, s48, 1
 s_mul_i32 s85, s48, 3
 s_sub_u32 s85, s85, 4
 s_max_i32 s85, s85, s58
 s_lshl_b32 s85, s85, 10
 s_mul_i32 s83, s55, 0xe5800
 s_add_u32 s83, s83, 0x45a0000
 s_mul_i32 s58, s80, 327680
 s_add_u32 s84, s83, s58
 s_add_u32 s84, s84, 276480
 s_mul_i32 s58, s56, 5120
 s_add_u32 s83, s83, s58
 s_lshl_b32 s86, s79, 1
 s_add_u32 s86, s86, s80
 s_lshl_b32 s86, s86, 8
 s_add_u32 s86, s86, 12288
 v_add_u32 v15, 4096, v1
 v_lshrrev_b32 v7, 2, v0
 v_mul_u32_u24 v7, 160, v7
 v_and_b32 v18, 3, v0
 v_lshl_add_u32 v7, v18, 3, v7
 s_mul_i32 s58, s57, 10240
 s_add_u32 s58, s58, 143360
 v_add_u32 v7, s58, v7
 s_lshl_b32 s58, s79, 1
 s_add_u32 s58, s58, s57
 s_lshl_b32 s58, s58, 4
 v_and_b32 v18, 15, v0
 v_add_u32 v18, s58, v18
 v_mul_u32_u24 v6, 1280, v18
 v_lshrrev_b32 v18, 4, v0
 v_lshl_add_u32 v6, v18, 3, v6
 s_mul_i32 s57, s55, 160
 v_add_u32 v6, s57, v6
 s_waitcnt vmcnt(13)
 s_barrier
 TR 48,120,0
 TR 50,120,256
 TR 52,120,32
 TR 54,120,288
 TR 56,120,16896
 TR 58,120,17152
 TR 60,120,16928
 TR 62,120,17184
 RD 16,116,0
 RD 20,116,2048
 RD 24,116,4096
 RD 28,116,6144
 RD 32,116,8192
 RD 36,116,10240
 RD 40,116,12288
 RD 44,116,14336
 s_add_u32 s93, s63, 2
 s_and_b32 s93, s93, 7
 s_lshl_b32 s93, s93, 19
 buffer_load_dword v123, v122, s[16:19], s93 offen
 buffer_load_dword v123, v122, s[20:23], s93 offen
 s_lshl_b32 s93, s2, 3
 s_add_u32 s93, s93, s48
 s_lshl_b32 s93, s93, 10
 buffer_load_dword v123, v4, s[8:11], s93 offen offset:256
 s_add_u32 s93, s63, 3
 s_and_b32 s93, s93, 7
 s_lshl_b32 s93, s93, 19
 buffer_load_dword v123, v122, s[16:19], s93 offen
 buffer_load_dword v123, v122, s[20:23], s93 offen
 s_lshl_b32 s93, s2, 3
 s_add_u32 s93, s93, s48
 s_lshl_b32 s93, s93, 10
 buffer_load_dword v123, v4, s[8:11], s93 offen offset:384
 s_waitcnt lgkmcnt(7)
 v_mfma_f32_16x16x32_bf16 v[128:131], v[48:51], v[16:19], 0
 TR 96,120,8448
 v_mfma_f32_16x16x32_bf16 v[132:135], v[52:55], v[16:19], 0
 TR 98,120,8704
 v_mfma_f32_16x16x32_bf16 v[192:195], v[16:19], v[56:59], 0
 v_mfma_f32_16x16x32_bf16 v[196:199], v[16:19], v[60:63], 0
 TR 100,120,8480
 s_waitcnt lgkmcnt(9)
 v_mfma_f32_16x16x32_bf16 v[136:139], v[48:51], v[20:23], 0
 TR 102,120,8736
 v_mfma_f32_16x16x32_bf16 v[140:143], v[52:55], v[20:23], 0
 v_mfma_f32_16x16x32_bf16 v[200:203], v[20:23], v[56:59], 0
 TR 104,120,25344
 v_mfma_f32_16x16x32_bf16 v[204:207], v[20:23], v[60:63], 0
 TR 106,120,25600
 s_waitcnt lgkmcnt(11)
 v_mfma_f32_16x16x32_bf16 v[144:147], v[48:51], v[24:27], 0
 v_mfma_f32_16x16x32_bf16 v[148:151], v[52:55], v[24:27], 0
 TR 108,120,25376
 v_mfma_f32_16x16x32_bf16 v[208:211], v[24:27], v[56:59], 0
 TR 110,120,25632
 v_mfma_f32_16x16x32_bf16 v[212:215], v[24:27], v[60:63], 0
 s_waitcnt lgkmcnt(12)
 v_mfma_f32_16x16x32_bf16 v[152:155], v[48:51], v[28:31], 0
 RD 64,117,0
 v_mfma_f32_16x16x32_bf16 v[156:159], v[52:55], v[28:31], 0
 RD 68,117,2048
 v_mfma_f32_16x16x32_bf16 v[216:219], v[28:31], v[56:59], 0
 v_mfma_f32_16x16x32_bf16 v[220:223], v[28:31], v[60:63], 0
 RD 72,117,4096
 s_waitcnt lgkmcnt(14)
 v_mfma_f32_16x16x32_bf16 v[160:163], v[48:51], v[32:35], 0
 RD 76,117,6144
 v_mfma_f32_16x16x32_bf16 v[164:167], v[52:55], v[32:35], 0
 v_mfma_f32_16x16x32_bf16 v[224:227], v[32:35], v[56:59], 0
 RD 80,117,8192
 v_mfma_f32_16x16x32_bf16 v[228:231], v[32:35], v[60:63], 0
 RD 84,117,10240
 s_waitcnt lgkmcnt(15)
 v_mfma_f32_16x16x32_bf16 v[168:171], v[48:51], v[36:39], 0
 v_mfma_f32_16x16x32_bf16 v[172:175], v[52:55], v[36:39], 0
 RD 88,117,12288
 v_mfma_f32_16x16x32_bf16 v[232:235], v[36:39], v[56:59], 0
 RD 92,117,14336
 v_mfma_f32_16x16x32_bf16 v[236:239], v[36:39], v[60:63], 0
 v_mfma_f32_16x16x32_bf16 v[176:179], v[48:51], v[40:43], 0
 v_mfma_f32_16x16x32_bf16 v[180:183], v[52:55], v[40:43], 0
 v_mfma_f32_16x16x32_bf16 v[240:243], v[40:43], v[56:59], 0
 v_mfma_f32_16x16x32_bf16 v[244:247], v[40:43], v[60:63], 0
 s_waitcnt lgkmcnt(15)
 v_mfma_f32_16x16x32_bf16 v[184:187], v[48:51], v[44:47], 0
 v_mfma_f32_16x16x32_bf16 v[188:191], v[52:55], v[44:47], 0
 v_mfma_f32_16x16x32_bf16 v[248:251], v[44:47], v[56:59], 0
 v_mfma_f32_16x16x32_bf16 v[252:255], v[44:47], v[60:63], 0
 s_waitcnt vmcnt(14)
 v_lshlrev_b32 v24, 16, v8
 v_and_b32 v25, 0xffff0000, v8
 v_lshlrev_b32 v26, 16, v13
 v_and_b32 v27, 0xffff0000, v13
 v_lshlrev_b32 v28, 16, v14
 v_and_b32 v29, 0xffff0000, v14
 v_lshlrev_b32 v30, 16, v126
 v_and_b32 v31, 0xffff0000, v126
 v_lshlrev_b32 v32, 16, v127
 v_and_b32 v33, 0xffff0000, v127
 v_add_f32 v34, v24, v25
 v_add_f32 v34, v34, v26
 v_add_f32 v34, v34, v27
 v_add_f32 v34, v34, v28
 v_add_f32 v34, v34, v29
 v_add_f32 v34, v34, v30
 v_add_f32 v34, v34, v31
 v_add_f32 v34, v34, v32
 v_add_f32 v34, v34, v33
 s_nop 1
 v_add_f32_dpp v34, v34, v34 row_ror:8 row_mask:0xf bank_mask:0xf
 s_nop 1
 v_add_f32_dpp v34, v34, v34 row_ror:4 row_mask:0xf bank_mask:0xf
 s_nop 1
 v_add_f32_dpp v34, v34, v34 row_ror:2 row_mask:0xf bank_mask:0xf
 s_nop 1
 v_add_f32_dpp v34, v34, v34 row_ror:1 row_mask:0xf bank_mask:0xf
 v_mov_b32 v35, v34
 s_nop 1
 v_permlane16_swap_b32 v34, v35
 v_add_f32 v34, v34, v35
 v_mov_b32 v35, v34
 s_nop 1
 v_permlane32_swap_b32 v34, v35
 v_add_f32 v34, v34, v35
 v_mul_f32 v34, 0x3acccccd, v34
 v_sub_f32 v36, v24, v34
 v_mul_f32 v37, v36, v36
 v_sub_f32 v36, v25, v34
 v_fmac_f32 v37, v36, v36
 v_sub_f32 v36, v26, v34
 v_fmac_f32 v37, v36, v36
 v_sub_f32 v36, v27, v34
 v_fmac_f32 v37, v36, v36
 v_sub_f32 v36, v28, v34
 v_fmac_f32 v37, v36, v36
 v_sub_f32 v36, v29, v34
 v_fmac_f32 v37, v36, v36
 v_sub_f32 v36, v30, v34
 v_fmac_f32 v37, v36, v36
 v_sub_f32 v36, v31, v34
 v_fmac_f32 v37, v36, v36
 v_sub_f32 v36, v32, v34
 v_fmac_f32 v37, v36, v36
 v_sub_f32 v36, v33, v34
 v_fmac_f32 v37, v36, v36
 s_nop 1
 v_add_f32_dpp v37, v37, v37 row_ror:8 row_mask:0xf bank_mask:0xf
 s_nop 1
 v_add_f32_dpp v37, v37, v37 row_ror:4 row_mask:0xf bank_mask:0xf
 s_nop 1
 v_add_f32_dpp v37, v37, v37 row_ror:2 row_mask:0xf bank_mask:0xf
 s_nop 1
 v_add_f32_dpp v37, v37, v37 row_ror:1 row_mask:0xf bank_mask:0xf
 v_mov_b32 v35, v37
 s_nop 1
 v_permlane16_swap_b32 v37, v35
 v_add_f32 v37, v37, v35
 v_mov_b32 v35, v37
 s_nop 1
 v_permlane32_swap_b32 v37, v35
 v_add_f32 v37, v37, v35
 v_mul_f32 v37, 0x3acccccd, v37
 v_cvt_pk_bf16_f32 v34, v34, v34
 v_lshlrev_b32 v34, 16, v34
 v_cvt_pk_bf16_f32 v37, v37, v37
 v_lshlrev_b32 v37, 16, v37
 v_add_f32 v37, 0x3727c5ac, v37
 v_cvt_pk_bf16_f32 v37, v37, v37
 v_lshlrev_b32 v37, 16, v37
 v_sqrt_f32 v37, v37
 s_nop 0
 v_cvt_pk_bf16_f32 v37, v37, v37
 v_lshlrev_b32 v37, 16, v37
 v_rcp_f32 v37, v37
 v_sub_f32 v24, v24, v34
 v_sub_f32 v25, v25, v34
 v_sub_f32 v26, v26, v34
 v_sub_f32 v27, v27, v34
 v_sub_f32 v28, v28, v34
 v_sub_f32 v29, v29, v34
 v_sub_f32 v30, v30, v34
 v_sub_f32 v31, v31, v34
 v_sub_f32 v32, v32, v34
 v_sub_f32 v33, v33, v34
 v_cvt_pk_bf16_f32 v8, v24, v25
 v_cvt_pk_bf16_f32 v13, v26, v27
 v_cvt_pk_bf16_f32 v14, v28, v29
 v_cvt_pk_bf16_f32 v126, v30, v31
 v_cvt_pk_bf16_f32 v127, v32, v33
 v_lshlrev_b32 v24, 16, v8
 v_and_b32 v25, 0xffff0000, v8
 v_lshlrev_b32 v26, 16, v13
 v_and_b32 v27, 0xffff0000, v13
 v_lshlrev_b32 v28, 16, v14
 v_and_b32 v29, 0xffff0000, v14
 v_lshlrev_b32 v30, 16, v126
 v_and_b32 v31, 0xffff0000, v126
 v_lshlrev_b32 v32, 16, v127
 v_and_b32 v33, 0xffff0000, v127
 v_mul_f32 v24, v24, v37
 v_mul_f32 v25, v25, v37
 v_mul_f32 v26, v26, v37
 v_mul_f32 v27, v27, v37
 v_mul_f32 v28, v28, v37
 v_mul_f32 v29, v29, v37
 v_mul_f32 v30, v30, v37
 v_mul_f32 v31, v31, v37
 v_mul_f32 v32, v32, v37
 v_mul_f32 v33, v33, v37
 v_cvt_pk_bf16_f32 v8, v24, v25
 v_cvt_pk_bf16_f32 v13, v26, v27
 v_cvt_pk_bf16_f32 v14, v28, v29
 v_cvt_pk_bf16_f32 v126, v30, v31
 v_cvt_pk_bf16_f32 v127, v32, v33
 s_mul_i32 s57, s48, 1296
 s_add_u32 s57, s57, 138496
 v_lshl_add_u32 v38, v0, 2, s57
 ds_write_b32 v38, v8 offset:0
 ds_write_b32 v38, v13 offset:256
 ds_write_b32 v38, v14 offset:512
 ds_write_b32 v38, v126 offset:768
 ds_write_b32 v38, v127 offset:1024
 s_waitcnt vmcnt(6) lgkmcnt(0)
 s_barrier
 s_cmp_ge_u32 s48, 5
 s_cbranch_scc1 Lxs_3
 v_and_b32 v32, 7, v0
 v_lshrrev_b32 v33, 3, v0
 v_mul_u32_u24 v34, 1296, v32
 v_lshl_add_u32 v34, v33, 4, v34
 s_lshl_b32 s57, s48, 8
 s_add_u32 s57, s57, 138496
 v_add_u32 v34, s57, v34
 ds_read_b128 v[40:43], v34
 RD 44,34,128
 v_lshrrev_b32 v35, 2, v33
 v_lshlrev_b32 v35, 11, v35
 v_and_b32 v36, 3, v33
 v_lshl_add_u32 v35, v36, 8, v35
 v_lshl_add_u32 v35, v32, 4, v35
 s_lshr_b32 s57, s2, 2
 s_mul_i32 s57, s57, 40960
 s_bfe_u32 s58, s2, 0x10001
 s_lshl_b32 s58, s58, 10
 s_add_u32 s57, s57, s58
 s_and_b32 s58, s2, 1
 s_lshl_b32 s58, s58, 7
 s_add_u32 s57, s57, s58
 s_lshl_b32 s58, s48, 13
 s_add_u32 s57, s57, s58
 s_add_u32 s57, s57, 0x20000
 s_add_u32 s58, s57, 4096
 s_waitcnt lgkmcnt(0)
 buffer_store_dwordx4 v[40:43], v35, s[44:47], s57 offen sc1
 buffer_store_dwordx4 v[44:47], v35, s[44:47], s58 offen sc1
 s_nop 0
Lxs_3:
 MF 128,96,64,128
 TR 48,121,0
 MF 132,100,64,132
 TR 50,121,256
 s_add_u32 s54, s63, 2
 s_and_b32 s54, s54, 7
 s_lshl_b32 s55, s54, 19
 s_lshl_b32 s54, s54, 7
 s_add_u32 s56, s55, 0x40000
 s_add_u32 m0, s52, 0
 s_nop 0
 buffer_load_dwordx4 v112, s[8:11], s54 offen  lds
 MF 192,64,104,192
 MF 196,64,108,196
 TR 52,121,32
 MF 136,96,68,136
 TR 54,121,288
 s_add_u32 m0, s53, 32768
 s_nop 0
 buffer_load_dwordx4 v2, s[16:19], s55 offen  lds
 MF 140,100,68,140
 MF 200,68,104,200
 TR 56,121,16896
 MF 204,68,108,204
 TR 58,121,17152
 s_add_u32 m0, s52, 1024
 s_nop 0
 buffer_load_dwordx4 v113, s[8:11], s54 offen  lds
 MF 144,96,72,144
 MF 148,100,72,148
 TR 60,121,16928
 MF 208,72,104,208
 TR 62,121,17184
 s_add_u32 m0, s53, 49664
 s_nop 0
 buffer_load_dwordx4 v2, s[20:23], s55 offen  lds
 MF 212,72,108,212
 MF 152,96,76,152
 RD 16,118,0
 MF 156,100,76,156
 RD 20,118,2048
 s_add_u32 m0, s52, 2048
 s_nop 0
 buffer_load_dwordx4 v114, s[8:11], s54 offen  lds
 MF 216,76,104,216
 MF 220,76,108,220
 RD 24,118,4096
 MF 160,96,80,160
 RD 28,118,6144
 s_add_u32 m0, s53, 41216
 s_nop 0
 buffer_load_dwordx4 v2, s[16:19], s56 offen  lds
 MF 164,100,80,164
 MF 224,80,104,224
 RD 32,118,8192
 MF 228,80,108,228
 RD 36,118,10240
 s_add_u32 m0, s52, 3072
 s_nop 0
 buffer_load_dwordx4 v115, s[8:11], s54 offen  lds
 MF 168,96,84,168
 MF 172,100,84,172
 RD 40,118,12288
 MF 232,84,104,232
 RD 44,118,14336
 s_add_u32 m0, s53, 58112
 s_nop 0
 buffer_load_dwordx4 v2, s[20:23], s56 offen  lds
 MF 236,84,108,236
 MF 176,96,88,176
 MF 180,100,88,180
 MF 240,88,104,240
 MF 244,88,108,244
 MF 184,96,92,184
 MF 188,100,92,188
 s_add_u32 s93, s63, 4
 s_and_b32 s93, s93, 7
 s_lshl_b32 s93, s93, 19
 buffer_load_dword v123, v122, s[16:19], s93 offen
 MF 248,92,104,248
 buffer_load_dword v123, v122, s[20:23], s93 offen
 s_lshl_b32 s93, s2, 3
 s_add_u32 s93, s93, s48
 s_lshl_b32 s93, s93, 10
 buffer_load_dword v123, v4, s[8:11], s93 offen offset:512
 MF 252,92,108,252
 s_waitcnt lgkmcnt(7)
 MF 128,48,16,128
 TR 96,121,8448
 MF 132,52,16,132
 TR 98,121,8704
 MF 192,16,56,192
 MF 196,16,60,196
 TR 100,121,8480
 s_waitcnt lgkmcnt(9)
 MF 136,48,20,136
 TR 102,121,8736
 MF 140,52,20,140
 MF 200,20,56,200
 TR 104,121,25344
 MF 204,20,60,204
 TR 106,121,25600
 s_waitcnt lgkmcnt(11)
 MF 144,48,24,144
 MF 148,52,24,148
 TR 108,121,25376
 MF 208,24,56,208
 TR 110,121,25632
 MF 212,24,60,212
 s_waitcnt lgkmcnt(12)
 MF 152,48,28,152
 RD 64,119,0
 MF 156,52,28,156
 RD 68,119,2048
 MF 216,28,56,216
 MF 220,28,60,220
 RD 72,119,4096
 s_waitcnt lgkmcnt(14)
 MF 160,48,32,160
 RD 76,119,6144
 MF 164,52,32,164
 MF 224,32,56,224
 RD 80,119,8192
 MF 228,32,60,228
 RD 84,119,10240
 s_waitcnt lgkmcnt(15)
 MF 168,48,36,168
 MF 172,52,36,172
 RD 88,119,12288
 MF 232,36,56,232
 RD 92,119,14336
 MF 236,36,60,236
 MF 176,48,40,176
 MF 180,52,40,180
 MF 240,40,56,240
 MF 244,40,60,244
 s_waitcnt lgkmcnt(15)
 MF 184,48,44,184
 MF 188,52,44,188
 MF 248,44,56,248
 MF 252,44,60,252
 s_waitcnt vmcnt(3) lgkmcnt(0)
 s_barrier
 MF 128,96,64,128
 TR 48,120,0
 MF 132,100,64,132
 TR 50,120,256
 s_add_u32 s54, s63, 3
 s_and_b32 s54, s54, 7
 s_lshl_b32 s55, s54, 19
 s_lshl_b32 s54, s54, 7
 s_add_u32 s56, s55, 0x40000
 s_add_u32 m0, s52, 66560
 s_nop 0
 buffer_load_dwordx4 v112, s[8:11], s54 offen  lds
 MF 192,64,104,192
 MF 196,64,108,196
 TR 52,120,32
 MF 136,96,68,136
 TR 54,120,288
 s_add_u32 m0, s53, 99328
 s_nop 0
 buffer_load_dwordx4 v2, s[16:19], s55 offen  lds
 MF 140,100,68,140
 MF 200,68,104,200
 TR 56,120,16896
 MF 204,68,108,204
 TR 58,120,17152
 s_add_u32 m0, s52, 67584
 s_nop 0
 buffer_load_dwordx4 v113, s[8:11], s54 offen  lds
 MF 144,96,72,144
 MF 148,100,72,148
 TR 60,120,16928
 MF 208,72,104,208
 TR 62,120,17184
 s_add_u32 m0, s53, 116224
 s_nop 0
 buffer_load_dwordx4 v2, s[20:23], s55 offen  lds
 MF 212,72,108,212
 MF 152,96,76,152
 RD 16,116,0
 MF 156,100,76,156
 RD 20,116,2048
 s_add_u32 m0, s52, 68608
 s_nop 0
 buffer_load_dwordx4 v114, s[8:11], s54 offen  lds
 MF 216,76,104,216
 MF 220,76,108,220
 RD 24,116,4096
 MF 160,96,80,160
 RD 28,116,6144
 s_add_u32 m0, s53, 107776
 s_nop 0
 buffer_load_dwordx4 v2, s[16:19], s56 offen  lds
 MF 164,100,80,164
 MF 224,80,104,224
 RD 32,116,8192
 MF 228,80,108,228
 RD 36,116,10240
 s_add_u32 m0, s52, 69632
 s_nop 0
 buffer_load_dwordx4 v115, s[8:11], s54 offen  lds
 MF 168,96,84,168
 MF 172,100,84,172
 RD 40,116,12288
 MF 232,84,104,232
 RD 44,116,14336
 s_add_u32 m0, s53, 124672
 s_nop 0
 buffer_load_dwordx4 v2, s[20:23], s56 offen  lds
 MF 236,84,108,236
 MF 176,96,88,176
 MF 180,100,88,180
 MF 240,88,104,240
 MF 244,88,108,244
 MF 184,96,92,184
 MF 188,100,92,188
 s_add_u32 s93, s63, 5
 s_and_b32 s93, s93, 7
 s_lshl_b32 s93, s93, 19
 buffer_load_dword v123, v122, s[16:19], s93 offen
 MF 248,92,104,248
 buffer_load_dword v123, v122, s[20:23], s93 offen
 s_lshl_b32 s93, s2, 3
 s_add_u32 s93, s93, s48
 s_lshl_b32 s93, s93, 10
 buffer_load_dword v123, v4, s[8:11], s93 offen offset:640
 s_mov_b32 s57, 0
 buffer_load_dword v123, v124, s[12:15], s57 offen
 MF 252,92,108,252
 s_mov_b32 s57, 0
 buffer_load_dword v123, v125, s[28:31], s57 offen
 s_and_b32 s57, s2, 1
 s_lshl_b32 s57, s57, 7
 s_cmp_eq_u32 s48, 0
 s_cselect_b32 s57, s57, 0x10000000
 v_mov_b32 v5, 1
 s_mov_b64 exec, 1
 buffer_atomic_add v5, v4, s[40:43], s57 offen
 s_mov_b64 exec, -1
 s_waitcnt lgkmcnt(7)
 MF 128,48,16,128
 TR 96,120,8448
 MF 132,52,16,132
 TR 98,120,8704
 MF 192,16,56,192
 MF 196,16,60,196
 TR 100,120,8480
 s_waitcnt lgkmcnt(9)
 MF 136,48,20,136
 TR 102,120,8736
 MF 140,52,20,140
 MF 200,20,56,200
 TR 104,120,25344
 MF 204,20,60,204
 TR 106,120,25600
 s_waitcnt lgkmcnt(11)
 MF 144,48,24,144
 MF 148,52,24,148
 TR 108,120,25376
 MF 208,24,56,208
 TR 110,120,25632
 MF 212,24,60,212
 s_waitcnt lgkmcnt(12)
 MF 152,48,28,152
 RD 64,117,0
 MF 156,52,28,156
 RD 68,117,2048
 MF 216,28,56,216
 MF 220,28,60,220
 RD 72,117,4096
 s_waitcnt lgkmcnt(14)
 MF 160,48,32,160
 RD 76,117,6144
 MF 164,52,32,164
 MF 224,32,56,224
 RD 80,117,8192
 MF 228,32,60,228
 RD 84,117,10240
 s_waitcnt lgkmcnt(15)
 MF 168,48,36,168
 MF 172,52,36,172
 RD 88,117,12288
 MF 232,36,56,232
 RD 92,117,14336
 MF 236,36,60,236
 MF 176,48,40,176
 MF 180,52,40,180
 MF 240,40,56,240
 MF 244,40,60,244
 s_waitcnt lgkmcnt(15)
 MF 184,48,44,184
 MF 188,52,44,188
 MF 248,44,56,248
 MF 252,44,60,252
 s_waitcnt vmcnt(6) lgkmcnt(0)
 s_barrier
 MF 128,96,64,128
 TR 48,121,0
 MF 132,100,64,132
 TR 50,121,256
 s_add_u32 s54, s63, 4
 s_and_b32 s54, s54, 7
 s_lshl_b32 s55, s54, 19
 s_lshl_b32 s54, s54, 7
 s_add_u32 s56, s55, 0x40000
 s_add_u32 m0, s52, 0
 s_nop 0
 buffer_load_dwordx4 v112, s[8:11], s54 offen  lds
 MF 192,64,104,192
 MF 196,64,108,196
 TR 52,121,32
 MF 136,96,68,136
 TR 54,121,288
 s_add_u32 m0, s53, 32768
 s_nop 0
 buffer_load_dwordx4 v2, s[16:19], s55 offen  lds
 MF 140,100,68,140
 MF 200,68,104,200
 TR 56,121,16896
 MF 204,68,108,204
 TR 58,121,17152
 s_add_u32 m0, s52, 1024
 s_nop 0
 buffer_load_dwordx4 v113, s[8:11], s54 offen  lds
 MF 144,96,72,144
 MF 148,100,72,148
 TR 60,121,16928
 MF 208,72,104,208
 TR 62,121,17184
 s_add_u32 m0, s53, 49664
 s_nop 0
 buffer_load_dwordx4 v2, s[20:23], s55 offen  lds
 MF 212,72,108,212
 MF 152,96,76,152
 RD 16,118,0
 MF 156,100,76,156
 RD 20,118,2048
 s_add_u32 m0, s52, 2048
 s_nop 0
 buffer_load_dwordx4 v114, s[8:11], s54 offen  lds
 MF 216,76,104,216
 MF 220,76,108,220
 RD 24,118,4096
 MF 160,96,80,160
 RD 28,118,6144
 s_add_u32 m0, s53, 41216
 s_nop 0
 buffer_load_dwordx4 v2, s[16:19], s56 offen  lds
 MF 164,100,80,164
 MF 224,80,104,224
 RD 32,118,8192
 MF 228,80,108,228
 RD 36,118,10240
 s_add_u32 m0, s52, 3072
 s_nop 0
 buffer_load_dwordx4 v115, s[8:11], s54 offen  lds
 MF 168,96,84,168
 MF 172,100,84,172
 RD 40,118,12288
 MF 232,84,104,232
 RD 44,118,14336
 s_add_u32 m0, s53, 58112
 s_nop 0
 buffer_load_dwordx4 v2, s[20:23], s56 offen  lds
 MF 236,84,108,236
 MF 176,96,88,176
 MF 180,100,88,180
 MF 240,88,104,240
 MF 244,88,108,244
 MF 184,96,92,184
 MF 188,100,92,188
 s_add_u32 s93, s63, 6
 s_and_b32 s93, s93, 7
 s_lshl_b32 s93, s93, 19
 buffer_load_dword v123, v122, s[16:19], s93 offen
 MF 248,92,104,248
 buffer_load_dword v123, v122, s[20:23], s93 offen
 s_lshl_b32 s93, s2, 3
 s_add_u32 s93, s93, s48
 s_lshl_b32 s93, s93, 10
 buffer_load_dword v123, v4, s[8:11], s93 offen offset:768
 s_mov_b32 s57, 16384
 buffer_load_dword v123, v124, s[12:15], s57 offen
 MF 252,92,108,252
 s_mov_b32 s57, 6912
 buffer_load_dword v123, v125, s[28:31], s57 offen
 s_waitcnt lgkmcnt(7)
 MF 128,48,16,128
 TR 96,121,8448
 MF 132,52,16,132
 TR 98,121,8704
 MF 192,16,56,192
 MF 196,16,60,196
 TR 100,121,8480
 s_waitcnt lgkmcnt(9)
 MF 136,48,20,136
 TR 102,121,8736
 MF 140,52,20,140
 MF 200,20,56,200
 TR 104,121,25344
 MF 204,20,60,204
 TR 106,121,25600
 s_waitcnt lgkmcnt(11)
 MF 144,48,24,144
 MF 148,52,24,148
 TR 108,121,25376
 MF 208,24,56,208
 TR 110,121,25632
 MF 212,24,60,212
 s_waitcnt lgkmcnt(12)
 MF 152,48,28,152
 RD 64,119,0
 MF 156,52,28,156
 RD 68,119,2048
 MF 216,28,56,216
 MF 220,28,60,220
 RD 72,119,4096
 s_waitcnt lgkmcnt(14)
 MF 160,48,32,160
 RD 76,119,6144
 MF 164,52,32,164
 MF 224,32,56,224
 RD 80,119,8192
 MF 228,32,60,228
 RD 84,119,10240
 s_waitcnt lgkmcnt(15)
 MF 168,48,36,168
 MF 172,52,36,172
 RD 88,119,12288
 MF 232,36,56,232
 RD 92,119,14336
 MF 236,36,60,236
 MF 176,48,40,176
 MF 180,52,40,180
 MF 240,40,56,240
 MF 244,40,60,244
 s_waitcnt lgkmcnt(15)
 MF 184,48,44,184
 MF 188,52,44,188
 MF 248,44,56,248
 MF 252,44,60,252
 s_waitcnt vmcnt(5) lgkmcnt(0)
 s_barrier
 MF 128,96,64,128
 TR 48,120,0
 MF 132,100,64,132
 TR 50,120,256
 s_add_u32 s54, s63, 5
 s_and_b32 s54, s54, 7
 s_lshl_b32 s55, s54, 19
 s_lshl_b32 s54, s54, 7
 s_add_u32 s56, s55, 0x40000
 s_add_u32 m0, s52, 66560
 s_nop 0
 buffer_load_dwordx4 v112, s[8:11], s54 offen  lds
 MF 192,64,104,192
 MF 196,64,108,196
 TR 52,120,32
 MF 136,96,68,136
 TR 54,120,288
 s_add_u32 m0, s53, 99328
 s_nop 0
 buffer_load_dwordx4 v2, s[16:19], s55 offen  lds
 MF 140,100,68,140
 MF 200,68,104,200
 TR 56,120,16896
 MF 204,68,108,204
 TR 58,120,17152
 s_add_u32 m0, s52, 67584
 s_nop 0
 buffer_load_dwordx4 v113, s[8:11], s54 offen  lds
 MF 144,96,72,144
 MF 148,100,72,148
 TR 60,120,16928
 MF 208,72,104,208
 TR 62,120,17184
 s_add_u32 m0, s53, 116224
 s_nop 0
 buffer_load_dwordx4 v2, s[20:23], s55 offen  lds
 MF 212,72,108,212
 MF 152,96,76,152
 RD 16,116,0
 MF 156,100,76,156
 RD 20,116,2048
 s_add_u32 m0, s52, 68608
 s_nop 0
 buffer_load_dwordx4 v114, s[8:11], s54 offen  lds
 MF 216,76,104,216
 MF 220,76,108,220
 RD 24,116,4096
 MF 160,96,80,160
 RD 28,116,6144
 s_add_u32 m0, s53, 107776
 s_nop 0
 buffer_load_dwordx4 v2, s[16:19], s56 offen  lds
 MF 164,100,80,164
 MF 224,80,104,224
 RD 32,116,8192
 MF 228,80,108,228
 RD 36,116,10240
 s_add_u32 m0, s52, 69632
 s_nop 0
 buffer_load_dwordx4 v115, s[8:11], s54 offen  lds
 MF 168,96,84,168
 MF 172,100,84,172
 RD 40,116,12288
 MF 232,84,104,232
 RD 44,116,14336
 s_add_u32 m0, s53, 124672
 s_nop 0
 buffer_load_dwordx4 v2, s[20:23], s56 offen  lds
 MF 236,84,108,236
 MF 176,96,88,176
 MF 180,100,88,180
 MF 240,88,104,240
 MF 244,88,108,244
 MF 184,96,92,184
 MF 188,100,92,188
 s_add_u32 s93, s63, 7
 s_and_b32 s93, s93, 7
 s_lshl_b32 s93, s93, 19
 buffer_load_dword v123, v122, s[16:19], s93 offen
 MF 248,92,104,248
 buffer_load_dword v123, v122, s[20:23], s93 offen
 s_lshl_b32 s93, s2, 3
 s_add_u32 s93, s93, s48
 s_lshl_b32 s93, s93, 10
 buffer_load_dword v123, v4, s[8:11], s93 offen offset:896
 s_mov_b32 s57, 32768
 buffer_load_dword v123, v124, s[12:15], s57 offen
 MF 252,92,108,252
 s_mov_b32 s57, 13824
 buffer_load_dword v123, v125, s[28:31], s57 offen
 s_waitcnt lgkmcnt(7)
 MF 128,48,16,128
 TR 96,120,8448
 MF 132,52,16,132
 TR 98,120,8704
 MF 192,16,56,192
 MF 196,16,60,196
 TR 100,120,8480
 s_waitcnt lgkmcnt(9)
 MF 136,48,20,136
 TR 102,120,8736
 MF 140,52,20,140
 MF 200,20,56,200
 TR 104,120,25344
 MF 204,20,60,204
 TR 106,120,25600
 s_waitcnt lgkmcnt(11)
 MF 144,48,24,144
 MF 148,52,24,148
 TR 108,120,25376
 MF 208,24,56,208
 TR 110,120,25632
 MF 212,24,60,212
 s_waitcnt lgkmcnt(12)
 MF 152,48,28,152
 RD 64,117,0
 MF 156,52,28,156
 RD 68,117,2048
 MF 216,28,56,216
 MF 220,28,60,220
 RD 72,117,4096
 s_waitcnt lgkmcnt(14)
 MF 160,48,32,160
 RD 76,117,6144
 MF 164,52,32,164
 MF 224,32,56,224
 RD 80,117,8192
 MF 228,32,60,228
 RD 84,117,10240
 s_waitcnt lgkmcnt(15)
 MF 168,48,36,168
 MF 172,52,36,172
 RD 88,117,12288
 MF 232,36,56,232
 RD 92,117,14336
 MF 236,36,60,236
 MF 176,48,40,176
 MF 180,52,40,180
 MF 240,40,56,240
 MF 244,40,60,244
 s_waitcnt lgkmcnt(15)
 MF 184,48,44,184
 MF 188,52,44,188
 MF 248,44,56,248
 MF 252,44,60,252
 s_waitcnt vmcnt(5) lgkmcnt(0)
 s_barrier
 MF 128,96,64,128
 TR 48,121,0
 MF 132,100,64,132
 TR 50,121,256
 s_add_u32 s54, s63, 6
 s_and_b32 s54, s54, 7
 s_lshl_b32 s55, s54, 19
 s_lshl_b32 s54, s54, 7
 s_add_u32 s56, s55, 0x40000
 s_add_u32 m0, s52, 0
 s_nop 0
 buffer_load_dwordx4 v112, s[8:11], s54 offen  lds
 MF 192,64,104,192
 MF 196,64,108,196
 TR 52,121,32
 MF 136,96,68,136
 TR 54,121,288
 s_add_u32 m0, s53, 32768
 s_nop 0
 buffer_load_dwordx4 v2, s[16:19], s55 offen  lds
 MF 140,100,68,140
 MF 200,68,104,200
 TR 56,121,16896
 MF 204,68,108,204
 TR 58,121,17152
 s_add_u32 m0, s52, 1024
 s_nop 0
 buffer_load_dwordx4 v113, s[8:11], s54 offen  lds
 MF 144,96,72,144
 MF 148,100,72,148
 TR 60,121,16928
 MF 208,72,104,208
 TR 62,121,17184
 s_add_u32 m0, s53, 49664
 s_nop 0
 buffer_load_dwordx4 v2, s[20:23], s55 offen  lds
 MF 212,72,108,212
 MF 152,96,76,152
 RD 16,118,0
 MF 156,100,76,156
 RD 20,118,2048
 s_add_u32 m0, s52, 2048
 s_nop 0
 buffer_load_dwordx4 v114, s[8:11], s54 offen  lds
 MF 216,76,104,216
 MF 220,76,108,220
 RD 24,118,4096
 MF 160,96,80,160
 RD 28,118,6144
 s_add_u32 m0, s53, 41216
 s_nop 0
 buffer_load_dwordx4 v2, s[16:19], s56 offen  lds
 MF 164,100,80,164
 MF 224,80,104,224
 RD 32,118,8192
 MF 228,80,108,228
 RD 36,118,10240
 s_add_u32 m0, s52, 3072
 s_nop 0
 buffer_load_dwordx4 v115, s[8:11], s54 offen  lds
 MF 168,96,84,168
 MF 172,100,84,172
 RD 40,118,12288
 MF 232,84,104,232
 RD 44,118,14336
 s_add_u32 m0, s53, 58112
 s_nop 0
 buffer_load_dwordx4 v2, s[20:23], s56 offen  lds
 MF 236,84,108,236
 MF 176,96,88,176
 MF 180,100,88,180
 MF 240,88,104,240
 MF 244,88,108,244
 MF 184,96,92,184
 MF 188,100,92,188
 MF 248,92,104,248
 s_mov_b32 s57, 49152
 buffer_load_dword v123, v124, s[12:15], s57 offen
 MF 252,92,108,252
 s_mov_b32 s57, 20736
 buffer_load_dword v123, v125, s[28:31], s57 offen
 s_waitcnt lgkmcnt(7)
 MF 128,48,16,128
 TR 96,121,8448
 MF 132,52,16,132
 TR 98,121,8704
 MF 192,16,56,192
 MF 196,16,60,196
 TR 100,121,8480
 s_waitcnt lgkmcnt(9)
 MF 136,48,20,136
 TR 102,121,8736
 MF 140,52,20,140
 MF 200,20,56,200
 TR 104,121,25344
 MF 204,20,60,204
 TR 106,121,25600
 s_waitcnt lgkmcnt(11)
 MF 144,48,24,144
 MF 148,52,24,148
 TR 108,121,25376
 MF 208,24,56,208
 TR 110,121,25632
 MF 212,24,60,212
 s_waitcnt lgkmcnt(12)
 MF 152,48,28,152
 RD 64,119,0
 MF 156,52,28,156
 RD 68,119,2048
 MF 216,28,56,216
 MF 220,28,60,220
 RD 72,119,4096
 s_waitcnt lgkmcnt(14)
 MF 160,48,32,160
 RD 76,119,6144
 MF 164,52,32,164
 MF 224,32,56,224
 RD 80,119,8192
 MF 228,32,60,228
 RD 84,119,10240
 s_waitcnt lgkmcnt(15)
 MF 168,48,36,168
 MF 172,52,36,172
 RD 88,119,12288
 MF 232,36,56,232
 RD 92,119,14336
 MF 236,36,60,236
 MF 176,48,40,176
 MF 180,52,40,180
 MF 240,40,56,240
 MF 244,40,60,244
 s_waitcnt lgkmcnt(15)
 MF 184,48,44,184
 MF 188,52,44,188
 MF 248,44,56,248
 MF 252,44,60,252
 s_waitcnt vmcnt(2) lgkmcnt(0)
 s_barrier
 MF 128,96,64,128
 TR 48,120,0
 MF 132,100,64,132
 TR 50,120,256
 s_add_u32 s54, s63, 7
 s_and_b32 s54, s54, 7
 s_lshl_b32 s55, s54, 19
 s_lshl_b32 s54, s54, 7
 s_add_u32 s56, s55, 0x40000
 s_add_u32 m0, s52, 66560
 s_nop 0
 buffer_load_dwordx4 v112, s[8:11], s54 offen  lds
 MF 192,64,104,192
 MF 196,64,108,196
 TR 52,120,32
 MF 136,96,68,136
 TR 54,120,288
 s_add_u32 m0, s53, 99328
 s_nop 0
 buffer_load_dwordx4 v2, s[16:19], s55 offen  lds
 MF 140,100,68,140
 MF 200,68,104,200
 TR 56,120,16896
 MF 204,68,108,204
 TR 58,120,17152
 s_add_u32 m0, s52, 67584
 s_nop 0
 buffer_load_dwordx4 v113, s[8:11], s54 offen  lds
 MF 144,96,72,144
 MF 148,100,72,148
 TR 60,120,16928
 MF 208,72,104,208
 TR 62,120,17184
 s_add_u32 m0, s53, 116224
 s_nop 0
 buffer_load_dwordx4 v2, s[20:23], s55 offen  lds
 MF 212,72,108,212
 MF 152,96,76,152
 RD 16,116,0
 MF 156,100,76,156
 RD 20,116,2048
 s_add_u32 m0, s52, 68608
 s_nop 0
 buffer_load_dwordx4 v114, s[8:11], s54 offen  lds
 MF 216,76,104,216
 MF 220,76,108,220
 RD 24,116,4096
 MF 160,96,80,160
 RD 28,116,6144
 s_add_u32 m0, s53, 107776
 s_nop 0
 buffer_load_dwordx4 v2, s[16:19], s56 offen  lds
 MF 164,100,80,164
 MF 224,80,104,224
 RD 32,116,8192
 MF 228,80,108,228
 RD 36,116,10240
 s_add_u32 m0, s52, 69632
 s_nop 0
 buffer_load_dwordx4 v115, s[8:11], s54 offen  lds
 MF 168,96,84,168
 MF 172,100,84,172
 RD 40,116,12288
 MF 232,84,104,232
 RD 44,116,14336
 s_add_u32 m0, s53, 124672
 s_nop 0
 buffer_load_dwordx4 v2, s[20:23], s56 offen  lds
 MF 236,84,108,236
 MF 176,96,88,176
 s_lshl_b32 s57, s48, 7
 buffer_load_dword v5, v4, s[40:43], s57 offen sc1
 MF 180,100,88,180
 MF 240,88,104,240
 MF 244,88,108,244
 MF 184,96,92,184
 MF 188,100,92,188
 MF 248,92,104,248
 s_mov_b32 s57, 65536
 buffer_load_dword v123, v124, s[12:15], s57 offen
 MF 252,92,108,252
 s_mov_b32 s57, 27648
 buffer_load_dword v123, v125, s[28:31], s57 offen
 s_waitcnt lgkmcnt(7)
 MF 128,48,16,128
 TR 96,120,8448
 MF 132,52,16,132
 TR 98,120,8704
 MF 192,16,56,192
 MF 196,16,60,196
 TR 100,120,8480
 s_waitcnt lgkmcnt(9)
 MF 136,48,20,136
 TR 102,120,8736
 MF 140,52,20,140
 MF 200,20,56,200
 TR 104,120,25344
 MF 204,20,60,204
 TR 106,120,25600
 s_waitcnt lgkmcnt(11)
 MF 144,48,24,144
 MF 148,52,24,148
 TR 108,120,25376
 MF 208,24,56,208
 TR 110,120,25632
 MF 212,24,60,212
 s_waitcnt lgkmcnt(12)
 MF 152,48,28,152
 RD 64,117,0
 MF 156,52,28,156
 RD 68,117,2048
 MF 216,28,56,216
 MF 220,28,60,220
 RD 72,117,4096
 s_waitcnt lgkmcnt(14)
 MF 160,48,32,160
 RD 76,117,6144
 MF 164,52,32,164
 MF 224,32,56,224
 RD 80,117,8192
 MF 228,32,60,228
 RD 84,117,10240
 s_waitcnt lgkmcnt(15)
 MF 168,48,36,168
 MF 172,52,36,172
 RD 88,117,12288
 MF 232,36,56,232
 RD 92,117,14336
 MF 236,36,60,236
 MF 176,48,40,176
 MF 180,52,40,180
 MF 240,40,56,240
 MF 244,40,60,244
 s_waitcnt lgkmcnt(15)
 MF 184,48,44,184
 MF 188,52,44,188
 MF 248,44,56,248
 MF 252,44,60,252
 s_waitcnt vmcnt(2)
 s_cmp_ge_u32 s48, 2
 s_cbranch_scc1 Lg1_4
 v_readfirstlane_b32 s57, v5
 s_cmp_ge_u32 s57, 0x80
 s_cbranch_scc1 Lg1_4
 s_lshl_b32 s58, s48, 7
 s_mov_b32 s66, 0x10000
Lpoll_5:
 buffer_load_dword v5, v4, s[40:43], s58 offen sc1
 s_waitcnt vmcnt(0)
 v_readfirstlane_b32 s57, v5
 s_cmp_ge_u32 s57, 0x80
 s_cbranch_scc1 Lpolld_6
 s_sleep 2
 s_sub_u32 s66, s66, 1
 s_cmp_lg_u32 s66, 0
 s_cbranch_scc1 Lpoll_5
Lpolld_6:
Lg1_4:
 s_waitcnt lgkmcnt(0)
 s_barrier
 MF 128,96,64,128
 TR 48,121,0
 MF 132,100,64,132
 TR 50,121,256
 s_mov_b32 s55, 0x0
 s_add_u32 m0, s53, 138496
 s_nop 0
 buffer_load_dwordx4 v2, s[12:15], s55 offen  lds
 MF 192,64,104,192
 MF 196,64,108,196
 TR 52,121,32
 MF 136,96,68,136
 TR 54,121,288
 MF 140,100,68,140
 MF 200,68,104,200
 TR 56,121,16896
 MF 204,68,108,204
 TR 58,121,17152
 s_mov_b32 s56, 0x40000
 s_add_u32 m0, s53, 146944
 s_nop 0
 buffer_load_dwordx4 v2, s[12:15], s56 offen  lds
 MF 144,96,72,144
 MF 148,100,72,148
 TR 60,121,16928
 MF 208,72,104,208
 TR 62,121,17184
 MF 212,72,108,212
 MF 152,96,76,152
 RD 16,118,0
 MF 156,100,76,156
 RD 20,118,2048
 MF 216,76,104,216
 s_mov_b32 s54, 0x0
 s_add_u32 m0, s53, 155392
 s_nop 0
 buffer_load_dwordx4 v3, s[28:31], s54 offen  lds
 MF 220,76,108,220
 RD 24,118,4096
 MF 160,96,80,160
 RD 28,118,6144
 MF 164,100,80,164
 MF 224,80,104,224
 RD 32,118,8192
 MF 228,80,108,228
 RD 36,118,10240
 MF 168,96,84,168
 MF 172,100,84,172
 RD 40,118,12288
 MF 232,84,104,232
 RD 44,118,14336
 MF 236,84,108,236
 MF 176,96,88,176
 MF 180,100,88,180
 MF 240,88,104,240
 MF 244,88,108,244
 MF 184,96,92,184
 MF 188,100,92,188
 MF 248,92,104,248
 MF 252,92,108,252
 s_waitcnt lgkmcnt(7)
 MF 128,48,16,128
 TR 96,121,8448
 MF 132,52,16,132
 TR 98,121,8704
 MF 192,16,56,192
 MF 196,16,60,196
 TR 100,121,8480
 s_waitcnt lgkmcnt(9)
 MF 136,48,20,136
 TR 102,121,8736
 MF 140,52,20,140
 MF 200,20,56,200
 TR 104,121,25344
 MF 204,20,60,204
 TR 106,121,25600
 s_waitcnt lgkmcnt(11)
 MF 144,48,24,144
 MF 148,52,24,148
 TR 108,121,25376
 MF 208,24,56,208
 TR 110,121,25632
 MF 212,24,60,212
 s_waitcnt lgkmcnt(12)
 MF 152,48,28,152
 RD 64,119,0
 MF 156,52,28,156
 RD 68,119,2048
 MF 216,28,56,216
 MF 220,28,60,220
 RD 72,119,4096
 s_waitcnt lgkmcnt(14)
 MF 160,48,32,160
 RD 76,119,6144
 MF 164,52,32,164
 MF 224,32,56,224
 RD 80,119,8192
 MF 228,32,60,228
 RD 84,119,10240
 s_waitcnt lgkmcnt(15)
 MF 168,48,36,168
 MF 172,52,36,172
 RD 88,119,12288
 MF 232,36,56,232
 RD 92,119,14336
 MF 236,36,60,236
 MF 176,48,40,176
 MF 180,52,40,180
 MF 240,40,56,240
 MF 244,40,60,244
 s_waitcnt lgkmcnt(15)
 MF 184,48,44,184
 MF 188,52,44,188
 MF 248,44,56,248
 MF 252,44,60,252
 s_waitcnt lgkmcnt(7)
 MF 128,96,64,128
 s_add_u32 s58, s59, 0
 buffer_load_dwordx4 v[16:19], v1, s[44:47], s58 offen offset:0 sc1
 MF 132,100,64,132
 MF 192,64,104,192
 buffer_load_dwordx4 v[20:23], v1, s[44:47], s58 offen offset:1024 sc1
 MF 196,64,108,196
 s_waitcnt lgkmcnt(6)
 MF 136,96,68,136
 MF 140,100,68,140
 buffer_load_dwordx4 v[24:27], v1, s[44:47], s58 offen offset:2048 sc1
 MF 200,68,104,200
 MF 204,68,108,204
 buffer_load_dwordx4 v[28:31], v1, s[44:47], s58 offen offset:3072 sc1
 s_waitcnt lgkmcnt(5)
 MF 144,96,72,144
 MF 148,100,72,148
 MF 208,72,104,208
 s_add_u32 s58, s59, 4096
 buffer_load_dwordx4 v[32:35], v1, s[44:47], s58 offen offset:0 sc1
 MF 212,72,108,212
 s_waitcnt lgkmcnt(4)
 MF 152,96,76,152
 MF 156,100,76,156
 buffer_load_dwordx4 v[36:39], v1, s[44:47], s58 offen offset:1024 sc1
 MF 216,76,104,216
 MF 220,76,108,220
 buffer_load_dwordx4 v[40:43], v1, s[44:47], s58 offen offset:2048 sc1
 s_waitcnt lgkmcnt(3)
 MF 160,96,80,160
 MF 164,100,80,164
 MF 224,80,104,224
 buffer_load_dwordx4 v[44:47], v1, s[44:47], s58 offen offset:3072 sc1
 MF 228,80,108,228
 s_waitcnt lgkmcnt(2)
 MF 168,96,84,168
 MF 172,100,84,172
 MF 232,84,104,232
 MF 236,84,108,236
 s_waitcnt lgkmcnt(1)
 MF 176,96,88,176
 MF 180,100,88,180
 MF 240,88,104,240
 MF 244,88,108,244
 s_waitcnt lgkmcnt(0)
 MF 184,96,92,184
 MF 188,100,92,188
 MF 248,92,104,248
 MF 252,92,108,252
 s_cmp_lg_u32 s92, 0
 s_cbranch_scc1 L_q_noffn
 s_waitcnt vmcnt(8)
 s_barrier
 s_mov_b32 s55, 0x80000
 s_add_u32 m0, s53, 87808
 s_nop 0
 buffer_load_dwordx4 v2, s[12:15], s55 offen  lds
 s_mov_b32 s56, 0xc0000
 s_add_u32 m0, s53, 96256
 s_nop 0
 buffer_load_dwordx4 v2, s[12:15], s56 offen  lds
 s_mov_b32 s54, 0x36000
 s_add_u32 m0, s53, 104704
 s_nop 0
 buffer_load_dwordx4 v3, s[28:31], s54 offen  lds
 TR 112,10,0
 TR 114,10,256
 TR 116,10,32
 TR 118,10,288
 TR 120,10,64
 TR 122,10,320
 TR 124,10,96
 TR 126,10,352
 v_cvt_pk_bf16_f32 v64, v128, v129
 v_cvt_pk_bf16_f32 v65, v130, v131
 v_cvt_pk_bf16_f32 v66, v132, v133
 v_cvt_pk_bf16_f32 v67, v134, v135
 v_cvt_pk_bf16_f32 v68, v136, v137
 v_cvt_pk_bf16_f32 v69, v138, v139
 v_cvt_pk_bf16_f32 v70, v140, v141
 v_cvt_pk_bf16_f32 v71, v142, v143
 v_cvt_pk_bf16_f32 v72, v144, v145
 v_cvt_pk_bf16_f32 v73, v146, v147
 v_cvt_pk_bf16_f32 v74, v148, v149
 v_cvt_pk_bf16_f32 v75, v150, v151
 v_cvt_pk_bf16_f32 v76, v152, v153
 v_cvt_pk_bf16_f32 v77, v154, v155
 v_cvt_pk_bf16_f32 v78, v156, v157
 v_cvt_pk_bf16_f32 v79, v158, v159
 v_cvt_pk_bf16_f32 v80, v160, v161
 v_cvt_pk_bf16_f32 v81, v162, v163
 v_cvt_pk_bf16_f32 v82, v164, v165
 v_cvt_pk_bf16_f32 v83, v166, v167
 TR 96,10,128
 TR 98,10,384
 s_waitcnt lgkmcnt(8)
 s_waitcnt vmcnt(9)
 v_mfma_f32_16x16x32_bf16 v[160:163], v[112:115], v[16:19], 0
 TR 100,10,160
 v_mfma_f32_16x16x32_bf16 v[164:167], v[112:115], v[20:23], 0
 TR 102,10,416
 v_cvt_pk_bf16_f32 v84, v168, v169
 v_cvt_pk_bf16_f32 v85, v170, v171
 v_cvt_pk_bf16_f32 v86, v172, v173
 v_cvt_pk_bf16_f32 v87, v174, v175
 s_waitcnt lgkmcnt(8)
 v_mfma_f32_16x16x32_bf16 v[168:171], v[116:119], v[16:19], 0
 TR 104,10,192
 v_mfma_f32_16x16x32_bf16 v[172:175], v[116:119], v[20:23], 0
 TR 106,10,448
 v_cvt_pk_bf16_f32 v88, v176, v177
 v_cvt_pk_bf16_f32 v89, v178, v179
 v_cvt_pk_bf16_f32 v90, v180, v181
 v_cvt_pk_bf16_f32 v91, v182, v183
 s_waitcnt lgkmcnt(8)
 v_mfma_f32_16x16x32_bf16 v[176:179], v[120:123], v[16:19], 0
 TR 108,10,224
 v_mfma_f32_16x16x32_bf16 v[180:183], v[120:123], v[20:23], 0
 TR 110,10,480
 v_cvt_pk_bf16_f32 v92, v184, v185
 v_cvt_pk_bf16_f32 v93, v186, v187
 v_cvt_pk_bf16_f32 v94, v188, v189
 v_cvt_pk_bf16_f32 v95, v190, v191
 s_waitcnt lgkmcnt(8)
 v_mfma_f32_16x16x32_bf16 v[184:187], v[124:127], v[16:19], 0
 TR 112,12,0
 v_mfma_f32_16x16x32_bf16 v[188:191], v[124:127], v[20:23], 0
 TR 114,12,256
 v_cvt_pk_bf16_f32 v128, v192, v193
 v_cvt_pk_bf16_f32 v129, v194, v195
 v_cvt_pk_bf16_f32 v132, v196, v197
 v_cvt_pk_bf16_f32 v133, v198, v199
 s_waitcnt lgkmcnt(8)
 v_mfma_f32_16x16x32_bf16 v[192:195], v[96:99], v[16:19], 0
 TR 116,12,32
 v_mfma_f32_16x16x32_bf16 v[196:199], v[96:99], v[20:23], 0
 TR 118,12,288
 v_cvt_pk_bf16_f32 v130, v200, v201
 v_cvt_pk_bf16_f32 v131, v202, v203
 v_cvt_pk_bf16_f32 v134, v204, v205
 v_cvt_pk_bf16_f32 v135, v206, v207
 s_add_u32 s58, s59, 8192
 buffer_load_dwordx4 v[48:51], v1, s[44:47], s58 offen offset:0 sc1
 s_waitcnt lgkmcnt(8)
 v_mfma_f32_16x16x32_bf16 v[200:203], v[100:103], v[16:19], 0
 TR 120,12,64
 v_mfma_f32_16x16x32_bf16 v[204:207], v[100:103], v[20:23], 0
 TR 122,12,320
 v_cvt_pk_bf16_f32 v136, v208, v209
 v_cvt_pk_bf16_f32 v137, v210, v211
 v_cvt_pk_bf16_f32 v140, v212, v213
 v_cvt_pk_bf16_f32 v141, v214, v215
 buffer_load_dwordx4 v[52:55], v1, s[44:47], s58 offen offset:1024 sc1
 s_waitcnt lgkmcnt(8)
 v_mfma_f32_16x16x32_bf16 v[208:211], v[104:107], v[16:19], 0
 TR 124,12,96
 v_mfma_f32_16x16x32_bf16 v[212:215], v[104:107], v[20:23], 0
 TR 126,12,352
 v_cvt_pk_bf16_f32 v138, v216, v217
 v_cvt_pk_bf16_f32 v139, v218, v219
 v_cvt_pk_bf16_f32 v142, v220, v221
 v_cvt_pk_bf16_f32 v143, v222, v223
 s_waitcnt lgkmcnt(8)
 v_mfma_f32_16x16x32_bf16 v[216:219], v[108:111], v[16:19], 0
 TR 96,10,8448
 v_mfma_f32_16x16x32_bf16 v[220:223], v[108:111], v[20:23], 0
 TR 98,10,8704
 v_cvt_pk_bf16_f32 v144, v224, v225
 v_cvt_pk_bf16_f32 v145, v226, v227
 v_cvt_pk_bf16_f32 v148, v228, v229
 v_cvt_pk_bf16_f32 v149, v230, v231
 buffer_load_dwordx4 v[56:59], v1, s[44:47], s58 offen offset:2048 sc1
 s_waitcnt lgkmcnt(8)
 v_mfma_f32_16x16x32_bf16 v[224:227], v[112:115], v[16:19], 0
 TR 100,10,8480
 v_mfma_f32_16x16x32_bf16 v[228:231], v[112:115], v[20:23], 0
 TR 102,10,8736
 v_cvt_pk_bf16_f32 v146, v232, v233
 v_cvt_pk_bf16_f32 v147, v234, v235
 v_cvt_pk_bf16_f32 v150, v236, v237
 v_cvt_pk_bf16_f32 v151, v238, v239
 buffer_load_dwordx4 v[60:63], v1, s[44:47], s58 offen offset:3072 sc1
 s_waitcnt lgkmcnt(8)
 v_mfma_f32_16x16x32_bf16 v[232:235], v[116:119], v[16:19], 0
 TR 104,10,8512
 v_mfma_f32_16x16x32_bf16 v[236:239], v[116:119], v[20:23], 0
 TR 106,10,8768
 v_cvt_pk_bf16_f32 v152, v240, v241
 v_cvt_pk_bf16_f32 v153, v242, v243
 v_cvt_pk_bf16_f32 v156, v244, v245
 v_cvt_pk_bf16_f32 v157, v246, v247
 s_waitcnt lgkmcnt(8)
 v_mfma_f32_16x16x32_bf16 v[240:243], v[120:123], v[16:19], 0
 TR 108,10,8544
 v_mfma_f32_16x16x32_bf16 v[244:247], v[120:123], v[20:23], 0
 TR 110,10,8800
 v_cvt_pk_bf16_f32 v154, v248, v249
 v_cvt_pk_bf16_f32 v155, v250, v251
 v_cvt_pk_bf16_f32 v158, v252, v253
 v_cvt_pk_bf16_f32 v159, v254, v255
 s_add_u32 s57, s60, 0
 buffer_store_dwordx4 v[64:67], v1, s[44:47], s57 offen sc1
 s_waitcnt lgkmcnt(8)
 v_mfma_f32_16x16x32_bf16 v[248:251], v[124:127], v[16:19], 0
 TR 112,10,8576
 v_mfma_f32_16x16x32_bf16 v[252:255], v[124:127], v[20:23], 0
 TR 114,10,8832
 s_waitcnt lgkmcnt(8)
 s_waitcnt vmcnt(12)
 MF 160,96,24,160
 TR 116,10,8608
 MF 164,96,28,164
 TR 118,10,8864
 s_add_u32 s57, s61, 0
 buffer_store_dwordx4 v[128:131], v1, s[44:47], s57 offen offset:0 sc1
 s_waitcnt lgkmcnt(8)
 MF 168,100,24,168
 TR 120,10,8640
 MF 172,100,28,172
 TR 122,10,8896
 s_add_u32 s57, s60, 4096
 buffer_store_dwordx4 v[68:71], v1, s[44:47], s57 offen sc1
 s_waitcnt lgkmcnt(8)
 MF 176,104,24,176
 TR 124,10,8672
 MF 180,104,28,180
 TR 126,10,8928
 s_waitcnt lgkmcnt(8)
 MF 184,108,24,184
 TR 96,12,4224
 MF 188,108,28,188
 TR 98,12,4480
 s_add_u32 s57, s61, 0
 buffer_store_dwordx4 v[132:135], v1, s[44:47], s57 offen offset:1024 sc1
 s_waitcnt lgkmcnt(8)
 MF 192,112,24,192
 TR 100,12,4256
 MF 196,112,28,196
 TR 102,12,4512
 s_waitcnt lgkmcnt(8)
 MF 200,116,24,200
 TR 104,12,4288
 MF 204,116,28,204
 TR 106,12,4544
 s_waitcnt lgkmcnt(8)
 MF 208,120,24,208
 TR 108,12,4320
 MF 212,120,28,212
 TR 110,12,4576
 s_waitcnt lgkmcnt(8)
 MF 216,124,24,216
 s_waitcnt vmcnt(8)
 s_barrier
 TR 112,9,0
 MF 220,124,28,220
 TR 114,9,256
 s_mov_b32 s55, 0x100000
 s_add_u32 m0, s53, 113152
 s_nop 0
 buffer_load_dwordx4 v2, s[12:15], s55 offen  lds
 s_waitcnt lgkmcnt(8)
 MF 224,96,24,224
 TR 116,9,32
 MF 228,96,28,228
 TR 118,9,288
 s_mov_b32 s56, 0x140000
 s_add_u32 m0, s53, 121600
 s_nop 0
 buffer_load_dwordx4 v2, s[12:15], s56 offen  lds
 s_waitcnt lgkmcnt(8)
 MF 232,100,24,232
 TR 120,9,64
 MF 236,100,28,236
 TR 122,9,320
 s_mov_b32 s54, 0x6c000
 s_add_u32 m0, s53, 130048
 s_nop 0
 buffer_load_dwordx4 v3, s[28:31], s54 offen  lds
 s_waitcnt lgkmcnt(8)
 MF 240,104,24,240
 TR 124,9,96
 MF 244,104,28,244
 TR 126,9,352
 s_waitcnt lgkmcnt(8)
 MF 248,108,24,248
 TR 96,9,128
 MF 252,108,28,252
 TR 98,9,384
 s_waitcnt lgkmcnt(8)
 MF 160,112,32,160
 TR 100,9,160
 MF 164,112,36,164
 TR 102,9,416
 s_waitcnt lgkmcnt(8)
 MF 168,116,32,168
 TR 104,9,192
 MF 172,116,36,172
 TR 106,9,448
 s_add_u32 s58, s59, 12288
 buffer_load_dwordx4 v[16:19], v1, s[44:47], s58 offen offset:0 sc1
 s_waitcnt lgkmcnt(8)
 MF 176,120,32,176
 TR 108,9,224
 MF 180,120,36,180
 TR 110,9,480
 s_waitcnt lgkmcnt(8)
 MF 184,124,32,184
 TR 112,11,0
 MF 188,124,36,188
 TR 114,11,256
 buffer_load_dwordx4 v[20:23], v1, s[44:47], s58 offen offset:1024 sc1
 s_waitcnt lgkmcnt(8)
 MF 192,96,32,192
 TR 116,11,32
 MF 196,96,36,196
 TR 118,11,288
 s_waitcnt lgkmcnt(8)
 MF 200,100,32,200
 TR 120,11,64
 MF 204,100,36,204
 TR 122,11,320
 buffer_load_dwordx4 v[24:27], v1, s[44:47], s58 offen offset:2048 sc1
 s_waitcnt lgkmcnt(8)
 MF 208,104,32,208
 TR 124,11,96
 MF 212,104,36,212
 TR 126,11,352
 s_waitcnt lgkmcnt(8)
 MF 216,108,32,216
 TR 96,9,8448
 MF 220,108,36,220
 TR 98,9,8704
 buffer_load_dwordx4 v[28:31], v1, s[44:47], s58 offen offset:3072 sc1
 s_waitcnt lgkmcnt(8)
 MF 224,112,32,224
 TR 100,9,8480
 MF 228,112,36,228
 TR 102,9,8736
 s_waitcnt lgkmcnt(8)
 MF 232,116,32,232
 TR 104,9,8512
 MF 236,116,36,236
 TR 106,9,8768
 s_waitcnt lgkmcnt(8)
 MF 240,120,32,240
 TR 108,9,8544
 MF 244,120,36,244
 TR 110,9,8800
 s_add_u32 s57, s60, 8192
 buffer_store_dwordx4 v[72:75], v1, s[44:47], s57 offen sc1
 s_waitcnt lgkmcnt(8)
 MF 248,124,32,248
 TR 112,9,8576
 MF 252,124,36,252
 TR 114,9,8832
 s_waitcnt lgkmcnt(8)
 MF 160,96,40,160
 TR 116,9,8608
 MF 164,96,44,164
 TR 118,9,8864
 s_add_u32 s57, s61, 8192
 buffer_store_dwordx4 v[136:139], v1, s[44:47], s57 offen offset:0 sc1
 s_waitcnt lgkmcnt(8)
 MF 168,100,40,168
 TR 120,9,8640
 MF 172,100,44,172
 TR 122,9,8896
 s_waitcnt lgkmcnt(8)
 MF 176,104,40,176
 TR 124,9,8672
 MF 180,104,44,180
 TR 126,9,8928
 s_add_u32 s57, s60, 12288
 buffer_store_dwordx4 v[76:79], v1, s[44:47], s57 offen sc1
 s_waitcnt lgkmcnt(8)
 MF 184,108,40,184
 TR 96,11,4224
 MF 188,108,44,188
 TR 98,11,4480
 s_waitcnt lgkmcnt(8)
 MF 192,112,40,192
 TR 100,11,4256
 MF 196,112,44,196
 TR 102,11,4512
 s_waitcnt lgkmcnt(8)
 MF 200,116,40,200
 TR 104,11,4288
 MF 204,116,44,204
 TR 106,11,4544
 s_waitcnt lgkmcnt(8)
 MF 208,120,40,208
 TR 108,11,4320
 MF 212,120,44,212
 TR 110,11,4576
 s_waitcnt lgkmcnt(8)
 MF 216,124,40,216
 s_waitcnt vmcnt(7)
 s_barrier
 TR 112,9,25344
 MF 220,124,44,220
 TR 114,9,25600
 s_mov_b32 s55, 0x180000
 s_add_u32 m0, s53, 138496
 s_nop 0
 buffer_load_dwordx4 v2, s[12:15], s55 offen  lds
 s_waitcnt lgkmcnt(8)
 MF 224,96,40,224
 TR 116,9,25376
 MF 228,96,44,228
 TR 118,9,25632
 s_mov_b32 s56, 0x1c0000
 s_add_u32 m0, s53, 146944
 s_nop 0
 buffer_load_dwordx4 v2, s[12:15], s56 offen  lds
 s_waitcnt lgkmcnt(8)
 MF 232,100,40,232
 TR 120,9,25408
 MF 236,100,44,236
 TR 122,9,25664
 s_mov_b32 s54, 0xa2000
 s_add_u32 m0, s53, 155392
 s_nop 0
 buffer_load_dwordx4 v3, s[28:31], s54 offen  lds
 s_waitcnt lgkmcnt(8)
 MF 240,104,40,240
 TR 124,9,25440
 MF 244,104,44,244
 TR 126,9,25696
 s_waitcnt lgkmcnt(8)
 MF 248,108,40,248
 TR 96,9,25472
 MF 252,108,44,252
 TR 98,9,25728
 s_waitcnt lgkmcnt(8)
 MF 160,112,48,160
 TR 100,9,25504
 MF 164,112,52,164
 TR 102,9,25760
 s_waitcnt lgkmcnt(8)
 MF 168,116,48,168
 TR 104,9,25536
 MF 172,116,52,172
 TR 106,9,25792
 s_add_u32 s58, s59, 16384
 buffer_load_dwordx4 v[32:35], v1, s[44:47], s58 offen offset:0 sc1
 s_waitcnt lgkmcnt(8)
 MF 176,120,48,176
 TR 108,9,25568
 MF 180,120,52,180
 TR 110,9,25824
 s_waitcnt lgkmcnt(8)
 MF 184,124,48,184
 TR 112,11,25344
 MF 188,124,52,188
 TR 114,11,25600
 buffer_load_dwordx4 v[36:39], v1, s[44:47], s58 offen offset:1024 sc1
 s_waitcnt lgkmcnt(8)
 MF 192,96,48,192
 TR 116,11,25376
 MF 196,96,52,196
 TR 118,11,25632
 s_waitcnt lgkmcnt(8)
 MF 200,100,48,200
 TR 120,11,25408
 MF 204,100,52,204
 TR 122,11,25664
 buffer_load_dwordx4 v[40:43], v1, s[44:47], s58 offen offset:2048 sc1
 s_waitcnt lgkmcnt(8)
 MF 208,104,48,208
 TR 124,11,25440
 MF 212,104,52,212
 TR 126,11,25696
 s_waitcnt lgkmcnt(8)
 MF 216,108,48,216
 TR 96,9,33792
 MF 220,108,52,220
 TR 98,9,34048
 buffer_load_dwordx4 v[44:47], v1, s[44:47], s58 offen offset:3072 sc1
 s_waitcnt lgkmcnt(8)
 MF 224,112,48,224
 TR 100,9,33824
 MF 228,112,52,228
 TR 102,9,34080
 s_waitcnt lgkmcnt(8)
 MF 232,116,48,232
 TR 104,9,33856
 MF 236,116,52,236
 TR 106,9,34112
 s_waitcnt lgkmcnt(8)
 MF 240,120,48,240
 TR 108,9,33888
 MF 244,120,52,244
 TR 110,9,34144
 s_add_u32 s57, s61, 8192
 buffer_store_dwordx4 v[140:143], v1, s[44:47], s57 offen offset:1024 sc1
 s_waitcnt lgkmcnt(8)
 MF 248,124,48,248
 TR 112,9,33920
 MF 252,124,52,252
 TR 114,9,34176
 s_waitcnt lgkmcnt(8)
 MF 160,96,56,160
 TR 116,9,33952
 MF 164,96,60,164
 TR 118,9,34208
 s_add_u32 s57, s60, 16384
 buffer_store_dwordx4 v[80:83], v1, s[44:47], s57 offen sc1
 s_waitcnt lgkmcnt(8)
 MF 168,100,56,168
 TR 120,9,33984
 MF 172,100,60,172
 TR 122,9,34240
 s_waitcnt lgkmcnt(8)
 MF 176,104,56,176
 TR 124,9,34016
 MF 180,104,60,180
 TR 126,9,34272
 s_add_u32 s57, s61, 16384
 buffer_store_dwordx4 v[144:147], v1, s[44:47], s57 offen offset:0 sc1
 s_waitcnt lgkmcnt(8)
 MF 184,108,56,184
 TR 96,11,29568
 MF 188,108,60,188
 TR 98,11,29824
 s_waitcnt lgkmcnt(8)
 MF 192,112,56,192
 TR 100,11,29600
 MF 196,112,60,196
 TR 102,11,29856
 s_waitcnt lgkmcnt(8)
 MF 200,116,56,200
 TR 104,11,29632
 MF 204,116,60,204
 TR 106,11,29888
 s_waitcnt lgkmcnt(8)
 MF 208,120,56,208
 TR 108,11,29664
 MF 212,120,60,212
 TR 110,11,29920
 s_waitcnt lgkmcnt(8)
 MF 216,124,56,216
 s_waitcnt vmcnt(7)
 s_barrier
 TR 112,10,0
 MF 220,124,60,220
 TR 114,10,256
 s_mov_b32 s55, 0x200000
 s_add_u32 m0, s53, 87808
 s_nop 0
 buffer_load_dwordx4 v2, s[12:15], s55 offen  lds
 s_waitcnt lgkmcnt(8)
 MF 224,96,56,224
 TR 116,10,32
 MF 228,96,60,228
 TR 118,10,288
 s_mov_b32 s56, 0x240000
 s_add_u32 m0, s53, 96256
 s_nop 0
 buffer_load_dwordx4 v2, s[12:15], s56 offen  lds
 s_waitcnt lgkmcnt(8)
 MF 232,100,56,232
 TR 120,10,64
 MF 236,100,60,236
 TR 122,10,320
 s_mov_b32 s54, 0xd8000
 s_add_u32 m0, s53, 104704
 s_nop 0
 buffer_load_dwordx4 v3, s[28:31], s54 offen  lds
 s_waitcnt lgkmcnt(8)
 MF 240,104,56,240
 TR 124,10,96
 MF 244,104,60,244
 TR 126,10,352
 s_waitcnt lgkmcnt(8)
 MF 248,108,56,248
 TR 96,10,128
 MF 252,108,60,252
 TR 98,10,384
 s_waitcnt lgkmcnt(8)
 MF 160,112,16,160
 TR 100,10,160
 MF 164,112,20,164
 TR 102,10,416
 s_waitcnt lgkmcnt(8)
 MF 168,116,16,168
 TR 104,10,192
 MF 172,116,20,172
 TR 106,10,448
 s_add_u32 s58, s59, 20480
 buffer_load_dwordx4 v[48:51], v1, s[44:47], s58 offen offset:0 sc1
 s_waitcnt lgkmcnt(8)
 MF 176,120,16,176
 TR 108,10,224
 MF 180,120,20,180
 TR 110,10,480
 s_waitcnt lgkmcnt(8)
 MF 184,124,16,184
 TR 112,12,0
 MF 188,124,20,188
 TR 114,12,256
 buffer_load_dwordx4 v[52:55], v1, s[44:47], s58 offen offset:1024 sc1
 s_waitcnt lgkmcnt(8)
 MF 192,96,16,192
 TR 116,12,32
 MF 196,96,20,196
 TR 118,12,288
 s_waitcnt lgkmcnt(8)
 MF 200,100,16,200
 TR 120,12,64
 MF 204,100,20,204
 TR 122,12,320
 s_waitcnt lgkmcnt(8)
 MF 208,104,16,208
 TR 124,12,96
 MF 212,104,20,212
 TR 126,12,352
 buffer_load_dwordx4 v[56:59], v1, s[44:47], s58 offen offset:2048 sc1
 s_waitcnt lgkmcnt(8)
 MF 216,108,16,216
 TR 96,10,8448
 MF 220,108,20,220
 TR 98,10,8704
 s_waitcnt lgkmcnt(8)
 MF 224,112,16,224
 TR 100,10,8480
 MF 228,112,20,228
 TR 102,10,8736
 s_waitcnt lgkmcnt(8)
 MF 232,116,16,232
 TR 104,10,8512
 MF 236,116,20,236
 TR 106,10,8768
 buffer_load_dwordx4 v[60:63], v1, s[44:47], s58 offen offset:3072 sc1
 s_waitcnt lgkmcnt(8)
 MF 240,120,16,240
 TR 108,10,8544
 MF 244,120,20,244
 TR 110,10,8800
 s_waitcnt lgkmcnt(8)
 MF 248,124,16,248
 TR 112,10,8576
 MF 252,124,20,252
 TR 114,10,8832
 s_add_u32 s57, s60, 20480
 buffer_store_dwordx4 v[84:87], v1, s[44:47], s57 offen sc1
 s_waitcnt lgkmcnt(8)
 MF 160,96,24,160
 TR 116,10,8608
 MF 164,96,28,164
 TR 118,10,8864
 s_waitcnt lgkmcnt(8)
 MF 168,100,24,168
 TR 120,10,8640
 MF 172,100,28,172
 TR 122,10,8896
 s_waitcnt lgkmcnt(8)
 MF 176,104,24,176
 TR 124,10,8672
 MF 180,104,28,180
 TR 126,10,8928
 s_add_u32 s57, s61, 16384
 buffer_store_dwordx4 v[148:151], v1, s[44:47], s57 offen offset:1024 sc1
 s_waitcnt lgkmcnt(8)
 MF 184,108,24,184
 TR 96,12,4224
 MF 188,108,28,188
 TR 98,12,4480
 s_waitcnt lgkmcnt(8)
 MF 192,112,24,192
 TR 100,12,4256
 MF 196,112,28,196
 TR 102,12,4512
 s_waitcnt lgkmcnt(8)
 MF 200,116,24,200
 TR 104,12,4288
 MF 204,116,28,204
 TR 106,12,4544
 s_waitcnt lgkmcnt(8)
 MF 208,120,24,208
 TR 108,12,4320
 MF 212,120,28,212
 TR 110,12,4576
 s_waitcnt lgkmcnt(8)
 MF 216,124,24,216
 s_waitcnt vmcnt(6)
 s_barrier
 TR 112,9,0
 MF 220,124,28,220
 TR 114,9,256
 s_mov_b32 s55, 0x280000
 s_add_u32 m0, s53, 113152
 s_nop 0
 buffer_load_dwordx4 v2, s[12:15], s55 offen  lds
 s_waitcnt lgkmcnt(8)
 MF 224,96,24,224
 TR 116,9,32
 MF 228,96,28,228
 TR 118,9,288
 s_mov_b32 s56, 0x2c0000
 s_add_u32 m0, s53, 121600
 s_nop 0
 buffer_load_dwordx4 v2, s[12:15], s56 offen  lds
 s_waitcnt lgkmcnt(8)
 MF 232,100,24,232
 TR 120,9,64
 MF 236,100,28,236
 TR 122,9,320
 s_mov_b32 s54, 0x10e000
 s_add_u32 m0, s53, 130048
 s_nop 0
 buffer_load_dwordx4 v3, s[28:31], s54 offen  lds
 s_waitcnt lgkmcnt(8)
 MF 240,104,24,240
 TR 124,9,96
 MF 244,104,28,244
 TR 126,9,352
 s_waitcnt lgkmcnt(8)
 MF 248,108,24,248
 TR 96,9,128
 MF 252,108,28,252
 TR 98,9,384
 s_waitcnt lgkmcnt(8)
 MF 160,112,32,160
 TR 100,9,160
 MF 164,112,36,164
 TR 102,9,416
 s_waitcnt lgkmcnt(8)
 MF 168,116,32,168
 TR 104,9,192
 MF 172,116,36,172
 TR 106,9,448
 s_add_u32 s58, s59, 24576
 buffer_load_dwordx4 v[16:19], v1, s[44:47], s58 offen offset:0 sc1
 s_waitcnt lgkmcnt(8)
 MF 176,120,32,176
 TR 108,9,224
 MF 180,120,36,180
 TR 110,9,480
 s_waitcnt lgkmcnt(8)
 MF 184,124,32,184
 TR 112,11,0
 MF 188,124,36,188
 TR 114,11,256
 buffer_load_dwordx4 v[20:23], v1, s[44:47], s58 offen offset:1024 sc1
 s_waitcnt lgkmcnt(8)
 MF 192,96,32,192
 TR 116,11,32
 MF 196,96,36,196
 TR 118,11,288
 s_waitcnt lgkmcnt(8)
 MF 200,100,32,200
 TR 120,11,64
 MF 204,100,36,204
 TR 122,11,320
 s_waitcnt lgkmcnt(8)
 MF 208,104,32,208
 TR 124,11,96
 MF 212,104,36,212
 TR 126,11,352
 buffer_load_dwordx4 v[24:27], v1, s[44:47], s58 offen offset:2048 sc1
 s_waitcnt lgkmcnt(8)
 MF 216,108,32,216
 TR 96,9,8448
 MF 220,108,36,220
 TR 98,9,8704
 s_waitcnt lgkmcnt(8)
 MF 224,112,32,224
 TR 100,9,8480
 MF 228,112,36,228
 TR 102,9,8736
 s_waitcnt lgkmcnt(8)
 MF 232,116,32,232
 TR 104,9,8512
 MF 236,116,36,236
 TR 106,9,8768
 buffer_load_dwordx4 v[28:31], v1, s[44:47], s58 offen offset:3072 sc1
 s_waitcnt lgkmcnt(8)
 MF 240,120,32,240
 TR 108,9,8544
 MF 244,120,36,244
 TR 110,9,8800
 s_waitcnt lgkmcnt(8)
 MF 248,124,32,248
 TR 112,9,8576
 MF 252,124,36,252
 TR 114,9,8832
 s_add_u32 s57, s60, 24576
 buffer_store_dwordx4 v[88:91], v1, s[44:47], s57 offen sc1
 s_waitcnt lgkmcnt(8)
 MF 160,96,40,160
 TR 116,9,8608
 MF 164,96,44,164
 TR 118,9,8864
 s_waitcnt lgkmcnt(8)
 MF 168,100,40,168
 TR 120,9,8640
 MF 172,100,44,172
 TR 122,9,8896
 s_waitcnt lgkmcnt(8)
 MF 176,104,40,176
 TR 124,9,8672
 MF 180,104,44,180
 TR 126,9,8928
 s_add_u32 s57, s61, 24576
 buffer_store_dwordx4 v[152:155], v1, s[44:47], s57 offen offset:0 sc1
 s_waitcnt lgkmcnt(8)
 MF 184,108,40,184
 TR 96,11,4224
 MF 188,108,44,188
 TR 98,11,4480
 s_waitcnt lgkmcnt(8)
 MF 192,112,40,192
 TR 100,11,4256
 MF 196,112,44,196
 TR 102,11,4512
 s_waitcnt lgkmcnt(8)
 MF 200,116,40,200
 TR 104,11,4288
 MF 204,116,44,204
 TR 106,11,4544
 s_waitcnt lgkmcnt(8)
 MF 208,120,40,208
 TR 108,11,4320
 MF 212,120,44,212
 TR 110,11,4576
 s_waitcnt lgkmcnt(8)
 MF 216,124,40,216
 s_waitcnt vmcnt(6)
 s_barrier
 TR 112,9,25344
 MF 220,124,44,220
 TR 114,9,25600
 s_mov_b32 s55, 0x300000
 s_add_u32 m0, s53, 138496
 s_nop 0
 buffer_load_dwordx4 v2, s[12:15], s55 offen  lds
 s_waitcnt lgkmcnt(8)
 MF 224,96,40,224
 TR 116,9,25376
 MF 228,96,44,228
 TR 118,9,25632
 s_mov_b32 s56, 0x340000
 s_add_u32 m0, s53, 146944
 s_nop 0
 buffer_load_dwordx4 v2, s[12:15], s56 offen  lds
 s_waitcnt lgkmcnt(8)
 MF 232,100,40,232
 TR 120,9,25408
 MF 236,100,44,236
 TR 122,9,25664
 s_mov_b32 s54, 0x144000
 s_add_u32 m0, s53, 155392
 s_nop 0
 buffer_load_dwordx4 v3, s[28:31], s54 offen  lds
 s_waitcnt lgkmcnt(8)
 MF 240,104,40,240
 TR 124,9,25440
 MF 244,104,44,244
 TR 126,9,25696
 s_waitcnt lgkmcnt(8)
 MF 248,108,40,248
 TR 96,9,25472
 MF 252,108,44,252
 TR 98,9,25728
 s_waitcnt lgkmcnt(8)
 MF 160,112,48,160
 TR 100,9,25504
 MF 164,112,52,164
 TR 102,9,25760
 s_waitcnt lgkmcnt(8)
 MF 168,116,48,168
 TR 104,9,25536
 MF 172,116,52,172
 TR 106,9,25792
 s_add_u32 s58, s59, 28672
 buffer_load_dwordx4 v[32:35], v1, s[44:47], s58 offen offset:0 sc1
 s_waitcnt lgkmcnt(8)
 MF 176,120,48,176
 TR 108,9,25568
 MF 180,120,52,180
 TR 110,9,25824
 s_waitcnt lgkmcnt(8)
 MF 184,124,48,184
 TR 112,11,25344
 MF 188,124,52,188
 TR 114,11,25600
 buffer_load_dwordx4 v[36:39], v1, s[44:47], s58 offen offset:1024 sc1
 s_waitcnt lgkmcnt(8)
 MF 192,96,48,192
 TR 116,11,25376
 MF 196,96,52,196
 TR 118,11,25632
 s_waitcnt lgkmcnt(8)
 MF 200,100,48,200
 TR 120,11,25408
 MF 204,100,52,204
 TR 122,11,25664
 s_waitcnt lgkmcnt(8)
 MF 208,104,48,208
 TR 124,11,25440
 MF 212,104,52,212
 TR 126,11,25696
 buffer_load_dwordx4 v[40:43], v1, s[44:47], s58 offen offset:2048 sc1
 s_waitcnt lgkmcnt(8)
 MF 216,108,48,216
 TR 96,9,33792
 MF 220,108,52,220
 TR 98,9,34048
 s_waitcnt lgkmcnt(8)
 MF 224,112,48,224
 TR 100,9,33824
 MF 228,112,52,228
 TR 102,9,34080
 s_waitcnt lgkmcnt(8)
 MF 232,116,48,232
 TR 104,9,33856
 MF 236,116,52,236
 TR 106,9,34112
 buffer_load_dwordx4 v[44:47], v1, s[44:47], s58 offen offset:3072 sc1
 s_waitcnt lgkmcnt(8)
 MF 240,120,48,240
 TR 108,9,33888
 MF 244,120,52,244
 TR 110,9,34144
 s_waitcnt lgkmcnt(8)
 MF 248,124,48,248
 TR 112,9,33920
 MF 252,124,52,252
 TR 114,9,34176
 s_add_u32 s57, s60, 28672
 buffer_store_dwordx4 v[92:95], v1, s[44:47], s57 offen sc1
 s_waitcnt lgkmcnt(8)
 MF 160,96,56,160
 TR 116,9,33952
 MF 164,96,60,164
 TR 118,9,34208
 s_waitcnt lgkmcnt(8)
 MF 168,100,56,168
 TR 120,9,33984
 MF 172,100,60,172
 TR 122,9,34240
 s_waitcnt lgkmcnt(8)
 MF 176,104,56,176
 TR 124,9,34016
 MF 180,104,60,180
 TR 126,9,34272
 s_add_u32 s57, s61, 24576
 buffer_store_dwordx4 v[156:159], v1, s[44:47], s57 offen offset:1024 sc1
 s_waitcnt lgkmcnt(8)
 MF 184,108,56,184
 TR 96,11,29568
 MF 188,108,60,188
 TR 98,11,29824
 s_waitcnt lgkmcnt(8)
 MF 192,112,56,192
 TR 100,11,29600
 MF 196,112,60,196
 TR 102,11,29856
 s_waitcnt lgkmcnt(8)
 MF 200,116,56,200
 TR 104,11,29632
 MF 204,116,60,204
 TR 106,11,29888
 s_waitcnt lgkmcnt(8)
 MF 208,120,56,208
 TR 108,11,29664
 MF 212,120,60,212
 TR 110,11,29920
 s_waitcnt lgkmcnt(8)
 MF 216,124,56,216
 s_waitcnt vmcnt(6)
 s_barrier
 TR 112,10,0
 MF 220,124,60,220
 TR 114,10,256
 s_mov_b32 s55, 0x380000
 s_add_u32 m0, s53, 87808
 s_nop 0
 buffer_load_dwordx4 v2, s[12:15], s55 offen  lds
 s_waitcnt lgkmcnt(8)
 MF 224,96,56,224
 TR 116,10,32
 MF 228,96,60,228
 TR 118,10,288
 s_mov_b32 s56, 0x3c0000
 s_add_u32 m0, s53, 96256
 s_nop 0
 buffer_load_dwordx4 v2, s[12:15], s56 offen  lds
 s_waitcnt lgkmcnt(8)
 MF 232,100,56,232
 TR 120,10,64
 MF 236,100,60,236
 TR 122,10,320
 s_mov_b32 s54, 0x17a000
 s_add_u32 m0, s53, 104704
 s_nop 0
 buffer_load_dwordx4 v3, s[28:31], s54 offen  lds
 s_waitcnt lgkmcnt(8)
 MF 240,104,56,240
 TR 124,10,96
 MF 244,104,60,244
 TR 126,10,352
 s_waitcnt lgkmcnt(8)
 MF 248,108,56,248
 TR 96,10,128
 MF 252,108,60,252
 TR 98,10,384
 s_waitcnt lgkmcnt(8)
 MF 160,112,16,160
 TR 100,10,160
 MF 164,112,20,164
 TR 102,10,416
 s_waitcnt lgkmcnt(8)
 MF 168,116,16,168
 TR 104,10,192
 MF 172,116,20,172
 TR 106,10,448
 s_add_u32 s58, s59, 32768
 buffer_load_dwordx4 v[48:51], v1, s[44:47], s58 offen offset:0 sc1
 s_waitcnt lgkmcnt(8)
 MF 176,120,16,176
 TR 108,10,224
 MF 180,120,20,180
 TR 110,10,480
 s_waitcnt lgkmcnt(8)
 MF 184,124,16,184
 TR 112,12,0
 MF 188,124,20,188
 TR 114,12,256
 s_waitcnt lgkmcnt(8)
 MF 192,96,16,192
 TR 116,12,32
 MF 196,96,20,196
 TR 118,12,288
 s_waitcnt lgkmcnt(8)
 MF 200,100,16,200
 TR 120,12,64
 MF 204,100,20,204
 TR 122,12,320
 buffer_load_dwordx4 v[52:55], v1, s[44:47], s58 offen offset:1024 sc1
 s_waitcnt lgkmcnt(8)
 MF 208,104,16,208
 TR 124,12,96
 MF 212,104,20,212
 TR 126,12,352
 s_waitcnt lgkmcnt(8)
 MF 216,108,16,216
 TR 96,10,8448
 MF 220,108,20,220
 TR 98,10,8704
 s_waitcnt lgkmcnt(8)
 MF 224,112,16,224
 TR 100,10,8480
 MF 228,112,20,228
 TR 102,10,8736
 s_waitcnt lgkmcnt(8)
 MF 232,116,16,232
 TR 104,10,8512
 MF 236,116,20,236
 TR 106,10,8768
 buffer_load_dwordx4 v[56:59], v1, s[44:47], s58 offen offset:2048 sc1
 s_waitcnt lgkmcnt(8)
 MF 240,120,16,240
 TR 108,10,8544
 MF 244,120,20,244
 TR 110,10,8800
 s_waitcnt lgkmcnt(8)
 MF 248,124,16,248
 TR 112,10,8576
 MF 252,124,20,252
 TR 114,10,8832
 s_waitcnt lgkmcnt(8)
 MF 160,96,24,160
 TR 116,10,8608
 MF 164,96,28,164
 TR 118,10,8864
 s_waitcnt lgkmcnt(8)
 MF 168,100,24,168
 TR 120,10,8640
 MF 172,100,28,172
 TR 122,10,8896
 buffer_load_dwordx4 v[60:63], v1, s[44:47], s58 offen offset:3072 sc1
 s_waitcnt lgkmcnt(8)
 MF 176,104,24,176
 TR 124,10,8672
 MF 180,104,28,180
 TR 126,10,8928
 s_waitcnt lgkmcnt(8)
 MF 184,108,24,184
 TR 96,12,4224
 MF 188,108,28,188
 TR 98,12,4480
 s_waitcnt lgkmcnt(8)
 MF 192,112,24,192
 TR 100,12,4256
 MF 196,112,28,196
 TR 102,12,4512
 s_waitcnt lgkmcnt(8)
 MF 200,116,24,200
 TR 104,12,4288
 MF 204,116,28,204
 TR 106,12,4544
 s_waitcnt lgkmcnt(8)
 MF 208,120,24,208
 TR 108,12,4320
 MF 212,120,28,212
 TR 110,12,4576
 s_waitcnt lgkmcnt(8)
 MF 216,124,24,216
 s_waitcnt vmcnt(4)
 s_barrier
 TR 112,9,0
 MF 220,124,28,220
 TR 114,9,256
 s_mov_b32 s55, 0x400000
 s_add_u32 m0, s53, 113152
 s_nop 0
 buffer_load_dwordx4 v2, s[12:15], s55 offen  lds
 s_waitcnt lgkmcnt(8)
 MF 224,96,24,224
 TR 116,9,32
 MF 228,96,28,228
 TR 118,9,288
 s_mov_b32 s56, 0x440000
 s_add_u32 m0, s53, 121600
 s_nop 0
 buffer_load_dwordx4 v2, s[12:15], s56 offen  lds
 s_waitcnt lgkmcnt(8)
 MF 232,100,24,232
 TR 120,9,64
 MF 236,100,28,236
 TR 122,9,320
 s_mov_b32 s54, 0x1b0000
 s_add_u32 m0, s53, 130048
 s_nop 0
 buffer_load_dwordx4 v3, s[28:31], s54 offen  lds
 s_waitcnt lgkmcnt(8)
 MF 240,104,24,240
 TR 124,9,96
 MF 244,104,28,244
 TR 126,9,352
 s_waitcnt lgkmcnt(8)
 MF 248,108,24,248
 TR 96,9,128
 MF 252,108,28,252
 TR 98,9,384
 s_waitcnt lgkmcnt(8)
 MF 160,112,32,160
 TR 100,9,160
 MF 164,112,36,164
 TR 102,9,416
 s_lshl_b32 s57, s49, 7
 s_cmp_eq_u32 s48, 0
 s_cselect_b32 s57, s57, 0x10000000
 v_mov_b32 v5, 1
 s_mov_b64 exec, 1
 buffer_atomic_add v5, v4, s[44:47], s57 offen
 s_mov_b64 exec, -1
 s_waitcnt lgkmcnt(8)
 MF 168,116,32,168
 TR 104,9,192
 MF 172,116,36,172
 TR 106,9,448
 s_add_u32 s58, s59, 36864
 buffer_load_dwordx4 v[16:19], v1, s[44:47], s58 offen offset:0 sc1
 s_waitcnt lgkmcnt(8)
 MF 176,120,32,176
 TR 108,9,224
 MF 180,120,36,180
 TR 110,9,480
 s_waitcnt lgkmcnt(8)
 MF 184,124,32,184
 TR 112,11,0
 MF 188,124,36,188
 TR 114,11,256
 s_waitcnt lgkmcnt(8)
 MF 192,96,32,192
 TR 116,11,32
 MF 196,96,36,196
 TR 118,11,288
 s_waitcnt lgkmcnt(8)
 MF 200,100,32,200
 TR 120,11,64
 MF 204,100,36,204
 TR 122,11,320
 buffer_load_dwordx4 v[20:23], v1, s[44:47], s58 offen offset:1024 sc1
 s_waitcnt lgkmcnt(8)
 MF 208,104,32,208
 TR 124,11,96
 MF 212,104,36,212
 TR 126,11,352
 s_waitcnt lgkmcnt(8)
 MF 216,108,32,216
 TR 96,9,8448
 MF 220,108,36,220
 TR 98,9,8704
 s_waitcnt lgkmcnt(8)
 MF 224,112,32,224
 TR 100,9,8480
 MF 228,112,36,228
 TR 102,9,8736
 s_waitcnt lgkmcnt(8)
 MF 232,116,32,232
 TR 104,9,8512
 MF 236,116,36,236
 TR 106,9,8768
 buffer_load_dwordx4 v[24:27], v1, s[44:47], s58 offen offset:2048 sc1
 s_waitcnt lgkmcnt(8)
 MF 240,120,32,240
 TR 108,9,8544
 MF 244,120,36,244
 TR 110,9,8800
 s_waitcnt lgkmcnt(8)
 MF 248,124,32,248
 TR 112,9,8576
 MF 252,124,36,252
 TR 114,9,8832
 s_waitcnt lgkmcnt(8)
 MF 160,96,40,160
 TR 116,9,8608
 MF 164,96,44,164
 TR 118,9,8864
 s_waitcnt lgkmcnt(8)
 MF 168,100,40,168
 TR 120,9,8640
 MF 172,100,44,172
 TR 122,9,8896
 buffer_load_dwordx4 v[28:31], v1, s[44:47], s58 offen offset:3072 sc1
 s_waitcnt lgkmcnt(8)
 MF 176,104,40,176
 TR 124,9,8672
 MF 180,104,44,180
 TR 126,9,8928
 s_waitcnt lgkmcnt(8)
 MF 184,108,40,184
 TR 96,11,4224
 MF 188,108,44,188
 TR 98,11,4480
 s_waitcnt lgkmcnt(8)
 MF 192,112,40,192
 TR 100,11,4256
 MF 196,112,44,196
 TR 102,11,4512
 s_waitcnt lgkmcnt(8)
 MF 200,116,40,200
 TR 104,11,4288
 MF 204,116,44,204
 TR 106,11,4544
 s_waitcnt lgkmcnt(8)
 MF 208,120,40,208
 TR 108,11,4320
 MF 212,120,44,212
 TR 110,11,4576
 s_waitcnt lgkmcnt(8)
 MF 216,124,40,216
 s_waitcnt vmcnt(5)
 s_barrier
 s_cmp_lt_u32 s48, 4
 s_cbranch_scc1 Lpr_7
 s_setprio 1
Lpr_7:
 TR 112,9,25344
 MF 220,124,44,220
 TR 114,9,25600
 s_mov_b32 s55, 0x480000
 s_add_u32 m0, s53, 138496
 s_nop 0
 buffer_load_dwordx4 v2, s[12:15], s55 offen  lds
 s_waitcnt lgkmcnt(8)
 MF 224,96,40,224
 TR 116,9,25376
 MF 228,96,44,228
 TR 118,9,25632
 s_mov_b32 s56, 0x4c0000
 s_add_u32 m0, s53, 146944
 s_nop 0
 buffer_load_dwordx4 v2, s[12:15], s56 offen  lds
 s_waitcnt lgkmcnt(8)
 MF 232,100,40,232
 TR 120,9,25408
 MF 236,100,44,236
 TR 122,9,25664
 s_mov_b32 s54, 0x1e6000
 s_add_u32 m0, s53, 155392
 s_nop 0
 buffer_load_dwordx4 v3, s[28:31], s54 offen  lds
 s_waitcnt lgkmcnt(8)
 MF 240,104,40,240
 TR 124,9,25440
 MF 244,104,44,244
 TR 126,9,25696
 s_waitcnt lgkmcnt(8)
 MF 248,108,40,248
 TR 96,9,25472
 MF 252,108,44,252
 TR 98,9,25728
 s_waitcnt lgkmcnt(8)
 MF 160,112,48,160
 TR 100,9,25504
 MF 164,112,52,164
 TR 102,9,25760
 s_waitcnt lgkmcnt(8)
 MF 168,116,48,168
 TR 104,9,25536
 MF 172,116,52,172
 TR 106,9,25792
 s_waitcnt lgkmcnt(8)
 MF 176,120,48,176
 TR 108,9,25568
 MF 180,120,52,180
 TR 110,9,25824
 s_waitcnt lgkmcnt(8)
 MF 184,124,48,184
 TR 112,11,25344
 MF 188,124,52,188
 TR 114,11,25600
 s_waitcnt lgkmcnt(8)
 MF 192,96,48,192
 TR 116,11,25376
 MF 196,96,52,196
 TR 118,11,25632
 s_waitcnt lgkmcnt(8)
 MF 200,100,48,200
 TR 120,11,25408
 MF 204,100,52,204
 TR 122,11,25664
 s_waitcnt lgkmcnt(8)
 MF 208,104,48,208
 TR 124,11,25440
 MF 212,104,52,212
 TR 126,11,25696
 s_waitcnt lgkmcnt(8)
 MF 216,108,48,216
 TR 96,9,33792
 MF 220,108,52,220
 TR 98,9,34048
 s_waitcnt lgkmcnt(8)
 MF 224,112,48,224
 TR 100,9,33824
 MF 228,112,52,228
 TR 102,9,34080
 s_waitcnt lgkmcnt(8)
 MF 232,116,48,232
 TR 104,9,33856
 MF 236,116,52,236
 TR 106,9,34112
 s_waitcnt lgkmcnt(8)
 MF 240,120,48,240
 TR 108,9,33888
 MF 244,120,52,244
 TR 110,9,34144
 s_waitcnt lgkmcnt(8)
 MF 248,124,48,248
 TR 112,9,33920
 MF 252,124,52,252
 TR 114,9,34176
 s_waitcnt lgkmcnt(8)
 MF 160,96,56,160
 TR 116,9,33952
 MF 164,96,60,164
 TR 118,9,34208
 s_waitcnt lgkmcnt(8)
 MF 168,100,56,168
 TR 120,9,33984
 MF 172,100,60,172
 TR 122,9,34240
 s_waitcnt lgkmcnt(8)
 MF 176,104,56,176
 TR 124,9,34016
 MF 180,104,60,180
 TR 126,9,34272
 s_waitcnt lgkmcnt(8)
 MF 184,108,56,184
 TR 96,11,29568
 MF 188,108,60,188
 TR 98,11,29824
 s_waitcnt lgkmcnt(8)
 MF 192,112,56,192
 TR 100,11,29600
 MF 196,112,60,196
 TR 102,11,29856
 s_waitcnt lgkmcnt(8)
 MF 200,116,56,200
 TR 104,11,29632
 MF 204,116,60,204
 TR 106,11,29888
 s_waitcnt lgkmcnt(8)
 MF 208,120,56,208
 TR 108,11,29664
 MF 212,120,60,212
 TR 110,11,29920
 s_waitcnt lgkmcnt(8)
 MF 216,124,56,216
 s_cmp_lg_u32 s48, 4
 s_cbranch_scc1 Lh2_8
 s_lshl_b32 s58, s49, 7
 s_mov_b32 s66, 0x10000
Lpoll_9:
 buffer_load_dword v5, v4, s[44:47], s58 offen sc1
 s_waitcnt vmcnt(0)
 v_readfirstlane_b32 s57, v5
 s_cmp_ge_u32 s57, 8
 s_cbranch_scc1 Lpolld_10
 s_sleep 2
 s_sub_u32 s66, s66, 1
 s_cmp_lg_u32 s66, 0
 s_cbranch_scc1 Lpoll_9
Lpolld_10:
Lh2_8:
 s_waitcnt vmcnt(0)
 s_barrier
 s_mul_i32 s77, s49, 0x106000
 s_add_u32 s77, s77, 0x960000
 s_and_b32 s57, s48, 3
 s_lshl_b32 s57, s57, 12
 s_add_u32 s77, s77, s57
 s_add_u32 s71, s77, 0x81000
 s_add_u32 s70, s77, 8192
 s_mov_b32 s72, s57
 s_cmp_lt_u32 s57, 8192
 s_cselect_b32 s78, s77, s71
 s_sub_u32 s94, s77, s57
 s_lshl_b32 s57, s50, 15
 s_sub_u32 s94, s94, s57
 s_add_u32 s94, s94, 0x80000
 s_add_u32 s95, s94, 0x83000
 TR 112,10,0
 MF 220,124,60,220
 TR 114,10,256
 s_waitcnt lgkmcnt(8)
 MF 224,96,56,224
 TR 116,10,32
 MF 228,96,60,228
 TR 118,10,288
 s_waitcnt lgkmcnt(8)
 MF 232,100,56,232
 TR 120,10,64
 MF 236,100,60,236
 TR 122,10,320
 s_waitcnt lgkmcnt(8)
 MF 240,104,56,240
 TR 124,10,96
 MF 244,104,60,244
 TR 126,10,352
 s_waitcnt lgkmcnt(8)
 MF 248,108,56,248
 TR 96,10,128
 MF 252,108,60,252
 TR 98,10,384
 s_waitcnt lgkmcnt(8)
 MF 160,112,16,160
 TR 100,10,160
 MF 164,112,20,164
 TR 102,10,416
 v_mov_b32 v9, 0xff800000
 s_cmp_lt_u32 s48, 4
 s_cbranch_scc1 Lkvp_11
 s_add_u32 m0, s72, 0
 s_cmp_lt_u32 s70, s94
 s_cselect_b32 s96, s70, 0x10000000
 buffer_load_dwordx4 v1, s[44:47], s96 offen offset:0 sc1 lds
 buffer_load_dwordx4 v1, s[44:47], s96 offen offset:1024 sc1 lds
 buffer_load_dwordx4 v1, s[44:47], s96 offen offset:2048 sc1 lds
 buffer_load_dwordx4 v1, s[44:47], s96 offen offset:3072 sc1 lds
Lkvp_11:
 s_waitcnt lgkmcnt(8)
 MF 168,116,16,168
 TR 104,10,192
 MF 172,116,20,172
 TR 106,10,448
 v_mov_b32 v13, v1
 s_waitcnt lgkmcnt(8)
 MF 176,120,16,176
 TR 108,10,224
 MF 180,120,20,180
 TR 110,10,480
 v_and_b32 v11, 48, v0
 v_lshrrev_b32 v11, 2, v11
 s_cmp_lt_u32 s48, 4
 s_cbranch_scc1 Lkvp_12
 s_add_u32 m0, s72, 16384
 s_cmp_lt_u32 s78, s95
 s_cselect_b32 s96, s78, 0x10000000
 buffer_load_dwordx4 v1, s[44:47], s96 offen offset:0 sc1 lds
 buffer_load_dwordx4 v1, s[44:47], s96 offen offset:1024 sc1 lds
 buffer_load_dwordx4 v1, s[44:47], s96 offen offset:2048 sc1 lds
 buffer_load_dwordx4 v1, s[44:47], s96 offen offset:3072 sc1 lds
 s_add_u32 s70, s70, 16384
 s_add_u32 s71, s71, 16384
 s_add_u32 s72, s72, 32768
 s_and_b32 s72, s72, 0x1ffff
Lkvp_12:
 s_waitcnt lgkmcnt(8)
 MF 184,124,16,184
 TR 112,12,0
 MF 188,124,20,188
 TR 114,12,256
 v_and_b32 v156, 15, v0
 v_sub_u32 v11, v156, v11
 s_waitcnt lgkmcnt(8)
 MF 192,96,16,192
 TR 116,12,32
 MF 196,96,20,196
 TR 118,12,288
 v_mov_b64 v[128:129], 0
 s_cmp_lt_u32 s48, 4
 s_cbranch_scc1 Lkvp_13
 s_add_u32 m0, s72, 0
 s_cmp_lt_u32 s70, s94
 s_cselect_b32 s96, s70, 0x10000000
 buffer_load_dwordx4 v1, s[44:47], s96 offen offset:0 sc1 lds
 buffer_load_dwordx4 v1, s[44:47], s96 offen offset:1024 sc1 lds
 buffer_load_dwordx4 v1, s[44:47], s96 offen offset:2048 sc1 lds
 buffer_load_dwordx4 v1, s[44:47], s96 offen offset:3072 sc1 lds
Lkvp_13:
 s_waitcnt lgkmcnt(8)
 MF 200,100,16,200
 TR 120,12,64
 MF 204,100,20,204
 TR 122,12,320
 v_mov_b64 v[130:131], 0
 s_waitcnt lgkmcnt(8)
 MF 208,104,16,208
 TR 124,12,96
 MF 212,104,20,212
 TR 126,12,352
 v_mov_b64 v[132:133], 0
 s_cmp_lt_u32 s48, 4
 s_cbranch_scc1 Lkvp_14
 s_add_u32 m0, s72, 16384
 s_cmp_lt_u32 s71, s95
 s_cselect_b32 s96, s71, 0x10000000
 buffer_load_dwordx4 v1, s[44:47], s96 offen offset:0 sc1 lds
 buffer_load_dwordx4 v1, s[44:47], s96 offen offset:1024 sc1 lds
 buffer_load_dwordx4 v1, s[44:47], s96 offen offset:2048 sc1 lds
 buffer_load_dwordx4 v1, s[44:47], s96 offen offset:3072 sc1 lds
 s_add_u32 s70, s70, 16384
 s_add_u32 s71, s71, 16384
 s_add_u32 s72, s72, 32768
 s_and_b32 s72, s72, 0x1ffff
Lkvp_14:
 s_waitcnt lgkmcnt(8)
 MF 216,108,16,216
 TR 96,10,8448
 MF 220,108,20,220
 TR 98,10,8704
 s_waitcnt lgkmcnt(8)
 MF 224,112,16,224
 TR 100,10,8480
 MF 228,112,20,228
 TR 102,10,8736
 v_mov_b64 v[134:135], 0
 s_cmp_lt_u32 s48, 4
 s_cbranch_scc1 Lkvp_15
 s_add_u32 m0, s72, 0
 s_cmp_lt_u32 s70, s94
 s_cselect_b32 s96, s70, 0x10000000
 buffer_load_dwordx4 v1, s[44:47], s96 offen offset:0 sc1 lds
 buffer_load_dwordx4 v1, s[44:47], s96 offen offset:1024 sc1 lds
 buffer_load_dwordx4 v1, s[44:47], s96 offen offset:2048 sc1 lds
 buffer_load_dwordx4 v1, s[44:47], s96 offen offset:3072 sc1 lds
Lkvp_15:
 s_waitcnt lgkmcnt(8)
 MF 232,116,16,232
 TR 104,10,8512
 MF 236,116,20,236
 TR 106,10,8768
 v_mov_b64 v[136:137], 0
 s_waitcnt lgkmcnt(8)
 MF 240,120,16,240
 TR 108,10,8544
 MF 244,120,20,244
 TR 110,10,8800
 v_mov_b64 v[138:139], 0
 s_cmp_lt_u32 s48, 4
 s_cbranch_scc1 Lkvp_16
 s_add_u32 m0, s72, 16384
 s_cmp_lt_u32 s71, s95
 s_cselect_b32 s96, s71, 0x10000000
 buffer_load_dwordx4 v1, s[44:47], s96 offen offset:0 sc1 lds
 buffer_load_dwordx4 v1, s[44:47], s96 offen offset:1024 sc1 lds
 buffer_load_dwordx4 v1, s[44:47], s96 offen offset:2048 sc1 lds
 buffer_load_dwordx4 v1, s[44:47], s96 offen offset:3072 sc1 lds
 s_add_u32 s70, s70, 16384
 s_add_u32 s71, s71, 16384
 s_add_u32 s72, s72, 32768
 s_and_b32 s72, s72, 0x1ffff
Lkvp_16:
 s_waitcnt lgkmcnt(8)
 MF 248,124,16,248
 TR 112,10,8576
 MF 252,124,20,252
 TR 114,10,8832
 v_mov_b64 v[140:141], 0
 s_waitcnt lgkmcnt(8)
 MF 160,96,24,160
 TR 116,10,8608
 MF 164,96,28,164
 TR 118,10,8864
 v_mov_b64 v[142:143], 0
 s_waitcnt lgkmcnt(8)
 MF 168,100,24,168
 TR 120,10,8640
 MF 172,100,28,172
 TR 122,10,8896
 v_mov_b64 v[144:145], 0
 s_waitcnt lgkmcnt(8)
 MF 176,104,24,176
 TR 124,10,8672
 MF 180,104,28,180
 TR 126,10,8928
 v_mov_b64 v[146:147], 0
 s_waitcnt lgkmcnt(8)
 MF 184,108,24,184
 TR 96,12,4224
 MF 188,108,28,188
 TR 98,12,4480
 s_waitcnt lgkmcnt(8)
 MF 192,112,24,192
 TR 100,12,4256
 MF 196,112,28,196
 TR 102,12,4512
 v_mov_b64 v[148:149], 0
 s_waitcnt lgkmcnt(8)
 MF 200,116,24,200
 TR 104,12,4288
 MF 204,116,28,204
 TR 106,12,4544
 v_mov_b64 v[150:151], 0
 s_waitcnt lgkmcnt(8)
 MF 208,120,24,208
 TR 108,12,4320
 MF 212,120,28,212
 TR 110,12,4576
 v_mov_b32 v152, 0x3f803f80
 s_waitcnt lgkmcnt(8)
 MF 216,124,24,216
 MF 220,124,28,220
 v_mov_b32 v153, 0x3f803f80
 s_waitcnt lgkmcnt(6)
 MF 224,96,24,224
 MF 228,96,28,228
 v_mov_b32 v154, 0x3f803f80
 s_waitcnt lgkmcnt(4)
 MF 232,100,24,232
 MF 236,100,28,236
 v_mov_b32 v155, 0x3f803f80
 s_waitcnt lgkmcnt(2)
 MF 240,104,24,240
 MF 244,104,28,244
 s_waitcnt lgkmcnt(0)
 MF 248,108,24,248
 MF 252,108,28,252
 s_nop 7
 v_cvt_pk_bf16_f32 v48, v224, v225
 v_cvt_pk_bf16_f32 v49, v226, v227
 v_cvt_pk_bf16_f32 v50, v232, v233
 v_cvt_pk_bf16_f32 v51, v234, v235
 v_cvt_pk_bf16_f32 v56, v240, v241
 v_cvt_pk_bf16_f32 v57, v242, v243
 v_cvt_pk_bf16_f32 v58, v248, v249
 v_cvt_pk_bf16_f32 v59, v250, v251
 v_cvt_pk_bf16_f32 v52, v228, v229
 v_cvt_pk_bf16_f32 v53, v230, v231
 v_cvt_pk_bf16_f32 v54, v236, v237
 v_cvt_pk_bf16_f32 v55, v238, v239
 v_cvt_pk_bf16_f32 v60, v244, v245
 v_cvt_pk_bf16_f32 v61, v246, v247
 v_cvt_pk_bf16_f32 v62, v252, v253
 v_cvt_pk_bf16_f32 v63, v254, v255
 v_pk_max_i16 v48, v48, 0
 v_pk_max_i16 v49, v49, 0
 v_pk_max_i16 v50, v50, 0
 v_pk_max_i16 v51, v51, 0
 v_pk_max_i16 v52, v52, 0
 v_pk_max_i16 v53, v53, 0
 v_pk_max_i16 v54, v54, 0
 v_pk_max_i16 v55, v55, 0
 v_pk_max_i16 v56, v56, 0
 v_pk_max_i16 v57, v57, 0
 v_pk_max_i16 v58, v58, 0
 v_pk_max_i16 v59, v59, 0
 v_pk_max_i16 v60, v60, 0
 v_pk_max_i16 v61, v61, 0
 v_pk_max_i16 v62, v62, 0
 v_pk_max_i16 v63, v63, 0
 buffer_store_dwordx4 v[48:51], v1, s[44:47], s62 offen offset:0 sc1
 buffer_store_dwordx4 v[52:55], v1, s[44:47], s62 offen offset:1024 sc1
 buffer_store_dwordx4 v[56:59], v1, s[44:47], s62 offen offset:2048 sc1
 buffer_store_dwordx4 v[60:63], v1, s[44:47], s62 offen offset:3072 sc1
 v_pk_mul_f32 v[160:161], v[160:161], s[64:65]
 v_pk_mul_f32 v[162:163], v[162:163], s[64:65]
 v_pk_mul_f32 v[164:165], v[164:165], s[64:65]
 v_pk_mul_f32 v[166:167], v[166:167], s[64:65]
 v_pk_mul_f32 v[168:169], v[168:169], s[64:65]
 v_pk_mul_f32 v[170:171], v[170:171], s[64:65]
 v_pk_mul_f32 v[172:173], v[172:173], s[64:65]
 v_pk_mul_f32 v[174:175], v[174:175], s[64:65]
 v_pk_mul_f32 v[176:177], v[176:177], s[64:65]
 v_pk_mul_f32 v[178:179], v[178:179], s[64:65]
 v_pk_mul_f32 v[180:181], v[180:181], s[64:65]
 v_pk_mul_f32 v[182:183], v[182:183], s[64:65]
 v_pk_mul_f32 v[184:185], v[184:185], s[64:65]
 v_pk_mul_f32 v[186:187], v[186:187], s[64:65]
 v_pk_mul_f32 v[188:189], v[188:189], s[64:65]
 v_pk_mul_f32 v[190:191], v[190:191], s[64:65]
 v_pk_mul_f32 v[192:193], v[192:193], s[64:65]
 v_pk_mul_f32 v[194:195], v[194:195], s[64:65]
 v_pk_mul_f32 v[196:197], v[196:197], s[64:65]
 v_pk_mul_f32 v[198:199], v[198:199], s[64:65]
 v_pk_mul_f32 v[200:201], v[200:201], s[64:65]
 v_pk_mul_f32 v[202:203], v[202:203], s[64:65]
 v_pk_mul_f32 v[204:205], v[204:205], s[64:65]
 v_pk_mul_f32 v[206:207], v[206:207], s[64:65]
 v_pk_mul_f32 v[208:209], v[208:209], s[64:65]
 v_pk_mul_f32 v[210:211], v[210:211], s[64:65]
 v_pk_mul_f32 v[212:213], v[212:213], s[64:65]
 v_pk_mul_f32 v[214:215], v[214:215], s[64:65]
 v_pk_mul_f32 v[216:217], v[216:217], s[64:65]
 v_pk_mul_f32 v[218:219], v[218:219], s[64:65]
 v_pk_mul_f32 v[220:221], v[220:221], s[64:65]
 v_pk_mul_f32 v[222:223], v[222:223], s[64:65]
 v_cvt_pk_bf16_f32 v16, v160, v161
 v_cvt_pk_bf16_f32 v17, v162, v163
 v_cvt_pk_bf16_f32 v18, v168, v169
 v_cvt_pk_bf16_f32 v19, v170, v171
 v_cvt_pk_bf16_f32 v20, v176, v177
 v_cvt_pk_bf16_f32 v21, v178, v179
 v_cvt_pk_bf16_f32 v22, v184, v185
 v_cvt_pk_bf16_f32 v23, v186, v187
 v_cvt_pk_bf16_f32 v24, v192, v193
 v_cvt_pk_bf16_f32 v25, v194, v195
 v_cvt_pk_bf16_f32 v26, v200, v201
 v_cvt_pk_bf16_f32 v27, v202, v203
 v_cvt_pk_bf16_f32 v28, v208, v209
 v_cvt_pk_bf16_f32 v29, v210, v211
 v_cvt_pk_bf16_f32 v30, v216, v217
 v_cvt_pk_bf16_f32 v31, v218, v219
 v_cvt_pk_bf16_f32 v32, v164, v165
 v_cvt_pk_bf16_f32 v33, v166, v167
 v_cvt_pk_bf16_f32 v34, v172, v173
 v_cvt_pk_bf16_f32 v35, v174, v175
 v_cvt_pk_bf16_f32 v36, v180, v181
 v_cvt_pk_bf16_f32 v37, v182, v183
 v_cvt_pk_bf16_f32 v38, v188, v189
 v_cvt_pk_bf16_f32 v39, v190, v191
 v_cvt_pk_bf16_f32 v40, v196, v197
 v_cvt_pk_bf16_f32 v41, v198, v199
 v_cvt_pk_bf16_f32 v42, v204, v205
 v_cvt_pk_bf16_f32 v43, v206, v207
 v_cvt_pk_bf16_f32 v44, v212, v213
 v_cvt_pk_bf16_f32 v45, v214, v215
 v_cvt_pk_bf16_f32 v46, v220, v221
 v_cvt_pk_bf16_f32 v47, v222, v223
 s_branch L_q_done
L_q_noffn:
 s_waitcnt vmcnt(8)
 s_barrier
 s_mov_b32 s55, 0x80000
 s_add_u32 m0, s53, 87808
 s_nop 0
 buffer_load_dwordx4 v2, s[12:15], s55 offen  lds
 s_mov_b32 s56, 0xc0000
 s_add_u32 m0, s53, 96256
 s_nop 0
 buffer_load_dwordx4 v2, s[12:15], s56 offen  lds
 TR 112,10,0
 TR 114,10,256
 TR 116,10,32
 TR 118,10,288
 TR 120,10,64
 TR 122,10,320
 TR 124,10,96
 TR 126,10,352
 v_cvt_pk_bf16_f32 v64, v128, v129
 v_cvt_pk_bf16_f32 v65, v130, v131
 v_cvt_pk_bf16_f32 v66, v132, v133
 v_cvt_pk_bf16_f32 v67, v134, v135
 v_cvt_pk_bf16_f32 v68, v136, v137
 v_cvt_pk_bf16_f32 v69, v138, v139
 v_cvt_pk_bf16_f32 v70, v140, v141
 v_cvt_pk_bf16_f32 v71, v142, v143
 v_cvt_pk_bf16_f32 v72, v144, v145
 v_cvt_pk_bf16_f32 v73, v146, v147
 v_cvt_pk_bf16_f32 v74, v148, v149
 v_cvt_pk_bf16_f32 v75, v150, v151
 v_cvt_pk_bf16_f32 v76, v152, v153
 v_cvt_pk_bf16_f32 v77, v154, v155
 v_cvt_pk_bf16_f32 v78, v156, v157
 v_cvt_pk_bf16_f32 v79, v158, v159
 v_cvt_pk_bf16_f32 v80, v160, v161
 v_cvt_pk_bf16_f32 v81, v162, v163
 v_cvt_pk_bf16_f32 v82, v164, v165
 v_cvt_pk_bf16_f32 v83, v166, v167
 TR 96,10,128
 TR 98,10,384
 s_waitcnt lgkmcnt(8)
 s_waitcnt vmcnt(8)
 v_mfma_f32_16x16x32_bf16 v[160:163], v[112:115], v[16:19], 0
 TR 100,10,160
 v_mfma_f32_16x16x32_bf16 v[164:167], v[112:115], v[20:23], 0
 TR 102,10,416
 v_cvt_pk_bf16_f32 v84, v168, v169
 v_cvt_pk_bf16_f32 v85, v170, v171
 v_cvt_pk_bf16_f32 v86, v172, v173
 v_cvt_pk_bf16_f32 v87, v174, v175
 s_waitcnt lgkmcnt(8)
 v_mfma_f32_16x16x32_bf16 v[168:171], v[116:119], v[16:19], 0
 TR 104,10,192
 v_mfma_f32_16x16x32_bf16 v[172:175], v[116:119], v[20:23], 0
 TR 106,10,448
 v_cvt_pk_bf16_f32 v88, v176, v177
 v_cvt_pk_bf16_f32 v89, v178, v179
 v_cvt_pk_bf16_f32 v90, v180, v181
 v_cvt_pk_bf16_f32 v91, v182, v183
 s_waitcnt lgkmcnt(8)
 v_mfma_f32_16x16x32_bf16 v[176:179], v[120:123], v[16:19], 0
 TR 108,10,224
 v_mfma_f32_16x16x32_bf16 v[180:183], v[120:123], v[20:23], 0
 TR 110,10,480
 v_cvt_pk_bf16_f32 v92, v184, v185
 v_cvt_pk_bf16_f32 v93, v186, v187
 v_cvt_pk_bf16_f32 v94, v188, v189
 v_cvt_pk_bf16_f32 v95, v190, v191
 s_waitcnt lgkmcnt(8)
 v_mfma_f32_16x16x32_bf16 v[184:187], v[124:127], v[16:19], 0
 TR 112,10,8448
 v_mfma_f32_16x16x32_bf16 v[188:191], v[124:127], v[20:23], 0
 TR 114,10,8704
 v_cvt_pk_bf16_f32 v128, v192, v193
 v_cvt_pk_bf16_f32 v129, v194, v195
 v_cvt_pk_bf16_f32 v132, v196, v197
 v_cvt_pk_bf16_f32 v133, v198, v199
 s_waitcnt lgkmcnt(8)
 v_mfma_f32_16x16x32_bf16 v[192:195], v[96:99], v[16:19], 0
 TR 116,10,8480
 v_mfma_f32_16x16x32_bf16 v[196:199], v[96:99], v[20:23], 0
 TR 118,10,8736
 v_cvt_pk_bf16_f32 v130, v200, v201
 v_cvt_pk_bf16_f32 v131, v202, v203
 v_cvt_pk_bf16_f32 v134, v204, v205
 v_cvt_pk_bf16_f32 v135, v206, v207
 s_add_u32 s58, s59, 8192
 buffer_load_dwordx4 v[48:51], v1, s[44:47], s58 offen offset:0 sc1
 buffer_load_dwordx4 v[52:55], v1, s[44:47], s58 offen offset:1024 sc1
 s_waitcnt lgkmcnt(8)
 v_mfma_f32_16x16x32_bf16 v[200:203], v[100:103], v[16:19], 0
 TR 120,10,8512
 v_mfma_f32_16x16x32_bf16 v[204:207], v[100:103], v[20:23], 0
 TR 122,10,8768
 v_cvt_pk_bf16_f32 v136, v208, v209
 v_cvt_pk_bf16_f32 v137, v210, v211
 v_cvt_pk_bf16_f32 v140, v212, v213
 v_cvt_pk_bf16_f32 v141, v214, v215
 buffer_load_dwordx4 v[56:59], v1, s[44:47], s58 offen offset:2048 sc1
 buffer_load_dwordx4 v[60:63], v1, s[44:47], s58 offen offset:3072 sc1
 s_waitcnt lgkmcnt(8)
 v_mfma_f32_16x16x32_bf16 v[208:211], v[104:107], v[16:19], 0
 TR 124,10,8544
 v_mfma_f32_16x16x32_bf16 v[212:215], v[104:107], v[20:23], 0
 TR 126,10,8800
 v_cvt_pk_bf16_f32 v138, v216, v217
 v_cvt_pk_bf16_f32 v139, v218, v219
 v_cvt_pk_bf16_f32 v142, v220, v221
 v_cvt_pk_bf16_f32 v143, v222, v223
 s_add_u32 s57, s60, 0
 buffer_store_dwordx4 v[64:67], v1, s[44:47], s57 offen sc1
 s_waitcnt lgkmcnt(8)
 v_mfma_f32_16x16x32_bf16 v[216:219], v[108:111], v[16:19], 0
 TR 96,10,8576
 v_mfma_f32_16x16x32_bf16 v[220:223], v[108:111], v[20:23], 0
 TR 98,10,8832
 v_cvt_pk_bf16_f32 v144, v224, v225
 v_cvt_pk_bf16_f32 v145, v226, v227
 v_cvt_pk_bf16_f32 v148, v228, v229
 v_cvt_pk_bf16_f32 v149, v230, v231
 s_add_u32 s57, s61, 0
 buffer_store_dwordx4 v[128:131], v1, s[44:47], s57 offen offset:0 sc1
 s_add_u32 s57, s60, 4096
 buffer_store_dwordx4 v[68:71], v1, s[44:47], s57 offen sc1
 s_waitcnt lgkmcnt(8)
 s_waitcnt vmcnt(13)
 MF 160,112,24,160
 TR 100,10,8608
 MF 164,112,28,164
 TR 102,10,8864
 v_cvt_pk_bf16_f32 v146, v232, v233
 v_cvt_pk_bf16_f32 v147, v234, v235
 v_cvt_pk_bf16_f32 v150, v236, v237
 v_cvt_pk_bf16_f32 v151, v238, v239
 s_add_u32 s57, s61, 0
 buffer_store_dwordx4 v[132:135], v1, s[44:47], s57 offen offset:1024 sc1
 s_waitcnt lgkmcnt(8)
 MF 168,116,24,168
 TR 104,10,8640
 MF 172,116,28,172
 TR 106,10,8896
 v_cvt_pk_bf16_f32 v152, v240, v241
 v_cvt_pk_bf16_f32 v153, v242, v243
 v_cvt_pk_bf16_f32 v156, v244, v245
 v_cvt_pk_bf16_f32 v157, v246, v247
 s_waitcnt lgkmcnt(8)
 MF 176,120,24,176
 TR 108,10,8672
 MF 180,120,28,180
 TR 110,10,8928
 v_cvt_pk_bf16_f32 v154, v248, v249
 v_cvt_pk_bf16_f32 v155, v250, v251
 v_cvt_pk_bf16_f32 v158, v252, v253
 v_cvt_pk_bf16_f32 v159, v254, v255
 s_waitcnt lgkmcnt(8)
 MF 184,124,24,184
 s_waitcnt vmcnt(8)
 s_barrier
 TR 112,9,0
 MF 188,124,28,188
 TR 114,9,256
 s_mov_b32 s55, 0x100000
 s_add_u32 m0, s53, 113152
 s_nop 0
 buffer_load_dwordx4 v2, s[12:15], s55 offen  lds
 s_waitcnt lgkmcnt(8)
 MF 192,96,24,192
 TR 116,9,32
 MF 196,96,28,196
 TR 118,9,288
 s_mov_b32 s56, 0x140000
 s_add_u32 m0, s53, 121600
 s_nop 0
 buffer_load_dwordx4 v2, s[12:15], s56 offen  lds
 s_waitcnt lgkmcnt(8)
 MF 200,100,24,200
 TR 120,9,64
 MF 204,100,28,204
 TR 122,9,320
 s_waitcnt lgkmcnt(8)
 MF 208,104,24,208
 TR 124,9,96
 MF 212,104,28,212
 TR 126,9,352
 s_waitcnt lgkmcnt(8)
 MF 216,108,24,216
 TR 96,9,128
 MF 220,108,28,220
 TR 98,9,384
 s_waitcnt lgkmcnt(8)
 MF 160,112,32,160
 TR 100,9,160
 MF 164,112,36,164
 TR 102,9,416
 s_waitcnt lgkmcnt(8)
 MF 168,116,32,168
 TR 104,9,192
 MF 172,116,36,172
 TR 106,9,448
 s_add_u32 s58, s59, 12288
 buffer_load_dwordx4 v[16:19], v1, s[44:47], s58 offen offset:0 sc1
 s_waitcnt lgkmcnt(8)
 MF 176,120,32,176
 TR 108,9,224
 MF 180,120,36,180
 TR 110,9,480
 buffer_load_dwordx4 v[20:23], v1, s[44:47], s58 offen offset:1024 sc1
 s_waitcnt lgkmcnt(8)
 MF 184,124,32,184
 TR 112,9,8448
 MF 188,124,36,188
 TR 114,9,8704
 buffer_load_dwordx4 v[24:27], v1, s[44:47], s58 offen offset:2048 sc1
 s_waitcnt lgkmcnt(8)
 MF 192,96,32,192
 TR 116,9,8480
 MF 196,96,36,196
 TR 118,9,8736
 buffer_load_dwordx4 v[28:31], v1, s[44:47], s58 offen offset:3072 sc1
 s_waitcnt lgkmcnt(8)
 MF 200,100,32,200
 TR 120,9,8512
 MF 204,100,36,204
 TR 122,9,8768
 s_add_u32 s57, s60, 8192
 buffer_store_dwordx4 v[72:75], v1, s[44:47], s57 offen sc1
 s_waitcnt lgkmcnt(8)
 MF 208,104,32,208
 TR 124,9,8544
 MF 212,104,36,212
 TR 126,9,8800
 s_add_u32 s57, s61, 8192
 buffer_store_dwordx4 v[136:139], v1, s[44:47], s57 offen offset:0 sc1
 s_waitcnt lgkmcnt(8)
 MF 216,108,32,216
 TR 96,9,8576
 MF 220,108,36,220
 TR 98,9,8832
 s_add_u32 s57, s60, 12288
 buffer_store_dwordx4 v[76:79], v1, s[44:47], s57 offen sc1
 s_waitcnt lgkmcnt(8)
 MF 160,112,40,160
 TR 100,9,8608
 MF 164,112,44,164
 TR 102,9,8864
 s_waitcnt lgkmcnt(8)
 MF 168,116,40,168
 TR 104,9,8640
 MF 172,116,44,172
 TR 106,9,8896
 s_waitcnt lgkmcnt(8)
 MF 176,120,40,176
 TR 108,9,8672
 MF 180,120,44,180
 TR 110,9,8928
 s_waitcnt lgkmcnt(8)
 MF 184,124,40,184
 s_waitcnt vmcnt(7)
 s_barrier
 TR 112,9,25344
 MF 188,124,44,188
 TR 114,9,25600
 s_mov_b32 s55, 0x180000
 s_add_u32 m0, s53, 138496
 s_nop 0
 buffer_load_dwordx4 v2, s[12:15], s55 offen  lds
 s_waitcnt lgkmcnt(8)
 MF 192,96,40,192
 TR 116,9,25376
 MF 196,96,44,196
 TR 118,9,25632
 s_mov_b32 s56, 0x1c0000
 s_add_u32 m0, s53, 146944
 s_nop 0
 buffer_load_dwordx4 v2, s[12:15], s56 offen  lds
 s_waitcnt lgkmcnt(8)
 MF 200,100,40,200
 TR 120,9,25408
 MF 204,100,44,204
 TR 122,9,25664
 s_waitcnt lgkmcnt(8)
 MF 208,104,40,208
 TR 124,9,25440
 MF 212,104,44,212
 TR 126,9,25696
 s_waitcnt lgkmcnt(8)
 MF 216,108,40,216
 TR 96,9,25472
 MF 220,108,44,220
 TR 98,9,25728
 s_waitcnt lgkmcnt(8)
 MF 160,112,48,160
 TR 100,9,25504
 MF 164,112,52,164
 TR 102,9,25760
 s_waitcnt lgkmcnt(8)
 MF 168,116,48,168
 TR 104,9,25536
 MF 172,116,52,172
 TR 106,9,25792
 s_add_u32 s58, s59, 16384
 buffer_load_dwordx4 v[32:35], v1, s[44:47], s58 offen offset:0 sc1
 s_waitcnt lgkmcnt(8)
 MF 176,120,48,176
 TR 108,9,25568
 MF 180,120,52,180
 TR 110,9,25824
 buffer_load_dwordx4 v[36:39], v1, s[44:47], s58 offen offset:1024 sc1
 s_waitcnt lgkmcnt(8)
 MF 184,124,48,184
 TR 112,9,33792
 MF 188,124,52,188
 TR 114,9,34048
 buffer_load_dwordx4 v[40:43], v1, s[44:47], s58 offen offset:2048 sc1
 s_waitcnt lgkmcnt(8)
 MF 192,96,48,192
 TR 116,9,33824
 MF 196,96,52,196
 TR 118,9,34080
 buffer_load_dwordx4 v[44:47], v1, s[44:47], s58 offen offset:3072 sc1
 s_waitcnt lgkmcnt(8)
 MF 200,100,48,200
 TR 120,9,33856
 MF 204,100,52,204
 TR 122,9,34112
 s_add_u32 s57, s61, 8192
 buffer_store_dwordx4 v[140:143], v1, s[44:47], s57 offen offset:1024 sc1
 s_waitcnt lgkmcnt(8)
 MF 208,104,48,208
 TR 124,9,33888
 MF 212,104,52,212
 TR 126,9,34144
 s_add_u32 s57, s60, 16384
 buffer_store_dwordx4 v[80:83], v1, s[44:47], s57 offen sc1
 s_waitcnt lgkmcnt(8)
 MF 216,108,48,216
 TR 96,9,33920
 MF 220,108,52,220
 TR 98,9,34176
 s_add_u32 s57, s61, 16384
 buffer_store_dwordx4 v[144:147], v1, s[44:47], s57 offen offset:0 sc1
 s_waitcnt lgkmcnt(8)
 MF 160,112,56,160
 TR 100,9,33952
 MF 164,112,60,164
 TR 102,9,34208
 s_waitcnt lgkmcnt(8)
 MF 168,116,56,168
 TR 104,9,33984
 MF 172,116,60,172
 TR 106,9,34240
 s_waitcnt lgkmcnt(8)
 MF 176,120,56,176
 TR 108,9,34016
 MF 180,120,60,180
 TR 110,9,34272
 s_waitcnt lgkmcnt(8)
 MF 184,124,56,184
 s_waitcnt vmcnt(7)
 s_barrier
 TR 112,10,0
 MF 188,124,60,188
 TR 114,10,256
 s_mov_b32 s55, 0x200000
 s_add_u32 m0, s53, 87808
 s_nop 0
 buffer_load_dwordx4 v2, s[12:15], s55 offen  lds
 s_waitcnt lgkmcnt(8)
 MF 192,96,56,192
 TR 116,10,32
 MF 196,96,60,196
 TR 118,10,288
 s_mov_b32 s56, 0x240000
 s_add_u32 m0, s53, 96256
 s_nop 0
 buffer_load_dwordx4 v2, s[12:15], s56 offen  lds
 s_waitcnt lgkmcnt(8)
 MF 200,100,56,200
 TR 120,10,64
 MF 204,100,60,204
 TR 122,10,320
 s_waitcnt lgkmcnt(8)
 MF 208,104,56,208
 TR 124,10,96
 MF 212,104,60,212
 TR 126,10,352
 s_waitcnt lgkmcnt(8)
 MF 216,108,56,216
 TR 96,10,128
 MF 220,108,60,220
 TR 98,10,384
 s_waitcnt lgkmcnt(8)
 MF 160,112,16,160
 TR 100,10,160
 MF 164,112,20,164
 TR 102,10,416
 s_waitcnt lgkmcnt(8)
 MF 168,116,16,168
 TR 104,10,192
 MF 172,116,20,172
 TR 106,10,448
 s_add_u32 s58, s59, 20480
 buffer_load_dwordx4 v[48:51], v1, s[44:47], s58 offen offset:0 sc1
 s_waitcnt lgkmcnt(8)
 MF 176,120,16,176
 TR 108,10,224
 MF 180,120,20,180
 TR 110,10,480
 buffer_load_dwordx4 v[52:55], v1, s[44:47], s58 offen offset:1024 sc1
 s_waitcnt lgkmcnt(8)
 MF 184,124,16,184
 TR 112,10,8448
 MF 188,124,20,188
 TR 114,10,8704
 buffer_load_dwordx4 v[56:59], v1, s[44:47], s58 offen offset:2048 sc1
 s_waitcnt lgkmcnt(8)
 MF 192,96,16,192
 TR 116,10,8480
 MF 196,96,20,196
 TR 118,10,8736
 s_waitcnt lgkmcnt(8)
 MF 200,100,16,200
 TR 120,10,8512
 MF 204,100,20,204
 TR 122,10,8768
 buffer_load_dwordx4 v[60:63], v1, s[44:47], s58 offen offset:3072 sc1
 s_waitcnt lgkmcnt(8)
 MF 208,104,16,208
 TR 124,10,8544
 MF 212,104,20,212
 TR 126,10,8800
 s_add_u32 s57, s60, 20480
 buffer_store_dwordx4 v[84:87], v1, s[44:47], s57 offen sc1
 s_waitcnt lgkmcnt(8)
 MF 216,108,16,216
 TR 96,10,8576
 MF 220,108,20,220
 TR 98,10,8832
 s_add_u32 s57, s61, 16384
 buffer_store_dwordx4 v[148:151], v1, s[44:47], s57 offen offset:1024 sc1
 s_waitcnt lgkmcnt(8)
 MF 160,112,24,160
 TR 100,10,8608
 MF 164,112,28,164
 TR 102,10,8864
 s_waitcnt lgkmcnt(8)
 MF 168,116,24,168
 TR 104,10,8640
 MF 172,116,28,172
 TR 106,10,8896
 s_waitcnt lgkmcnt(8)
 MF 176,120,24,176
 TR 108,10,8672
 MF 180,120,28,180
 TR 110,10,8928
 s_waitcnt lgkmcnt(8)
 MF 184,124,24,184
 s_waitcnt vmcnt(6)
 s_barrier
 TR 112,9,0
 MF 188,124,28,188
 TR 114,9,256
 s_mov_b32 s55, 0x280000
 s_add_u32 m0, s53, 113152
 s_nop 0
 buffer_load_dwordx4 v2, s[12:15], s55 offen  lds
 s_waitcnt lgkmcnt(8)
 MF 192,96,24,192
 TR 116,9,32
 MF 196,96,28,196
 TR 118,9,288
 s_mov_b32 s56, 0x2c0000
 s_add_u32 m0, s53, 121600
 s_nop 0
 buffer_load_dwordx4 v2, s[12:15], s56 offen  lds
 s_waitcnt lgkmcnt(8)
 MF 200,100,24,200
 TR 120,9,64
 MF 204,100,28,204
 TR 122,9,320
 s_waitcnt lgkmcnt(8)
 MF 208,104,24,208
 TR 124,9,96
 MF 212,104,28,212
 TR 126,9,352
 s_waitcnt lgkmcnt(8)
 MF 216,108,24,216
 TR 96,9,128
 MF 220,108,28,220
 TR 98,9,384
 s_waitcnt lgkmcnt(8)
 MF 160,112,32,160
 TR 100,9,160
 MF 164,112,36,164
 TR 102,9,416
 s_waitcnt lgkmcnt(8)
 MF 168,116,32,168
 TR 104,9,192
 MF 172,116,36,172
 TR 106,9,448
 s_add_u32 s58, s59, 24576
 buffer_load_dwordx4 v[16:19], v1, s[44:47], s58 offen offset:0 sc1
 s_waitcnt lgkmcnt(8)
 MF 176,120,32,176
 TR 108,9,224
 MF 180,120,36,180
 TR 110,9,480
 buffer_load_dwordx4 v[20:23], v1, s[44:47], s58 offen offset:1024 sc1
 s_waitcnt lgkmcnt(8)
 MF 184,124,32,184
 TR 112,9,8448
 MF 188,124,36,188
 TR 114,9,8704
 buffer_load_dwordx4 v[24:27], v1, s[44:47], s58 offen offset:2048 sc1
 s_waitcnt lgkmcnt(8)
 MF 192,96,32,192
 TR 116,9,8480
 MF 196,96,36,196
 TR 118,9,8736
 s_waitcnt lgkmcnt(8)
 MF 200,100,32,200
 TR 120,9,8512
 MF 204,100,36,204
 TR 122,9,8768
 buffer_load_dwordx4 v[28:31], v1, s[44:47], s58 offen offset:3072 sc1
 s_waitcnt lgkmcnt(8)
 MF 208,104,32,208
 TR 124,9,8544
 MF 212,104,36,212
 TR 126,9,8800
 s_add_u32 s57, s60, 24576
 buffer_store_dwordx4 v[88:91], v1, s[44:47], s57 offen sc1
 s_waitcnt lgkmcnt(8)
 MF 216,108,32,216
 TR 96,9,8576
 MF 220,108,36,220
 TR 98,9,8832
 s_add_u32 s57, s61, 24576
 buffer_store_dwordx4 v[152:155], v1, s[44:47], s57 offen offset:0 sc1
 s_waitcnt lgkmcnt(8)
 MF 160,112,40,160
 TR 100,9,8608
 MF 164,112,44,164
 TR 102,9,8864
 s_waitcnt lgkmcnt(8)
 MF 168,116,40,168
 TR 104,9,8640
 MF 172,116,44,172
 TR 106,9,8896
 s_waitcnt lgkmcnt(8)
 MF 176,120,40,176
 TR 108,9,8672
 MF 180,120,44,180
 TR 110,9,8928
 s_waitcnt lgkmcnt(8)
 MF 184,124,40,184
 s_waitcnt vmcnt(6)
 s_barrier
 TR 112,9,25344
 MF 188,124,44,188
 TR 114,9,25600
 s_mov_b32 s55, 0x300000
 s_add_u32 m0, s53, 138496
 s_nop 0
 buffer_load_dwordx4 v2, s[12:15], s55 offen  lds
 s_waitcnt lgkmcnt(8)
 MF 192,96,40,192
 TR 116,9,25376
 MF 196,96,44,196
 TR 118,9,25632
 s_mov_b32 s56, 0x340000
 s_add_u32 m0, s53, 146944
 s_nop 0
 buffer_load_dwordx4 v2, s[12:15], s56 offen  lds
 s_waitcnt lgkmcnt(8)
 MF 200,100,40,200
 TR 120,9,25408
 MF 204,100,44,204
 TR 122,9,25664
 s_waitcnt lgkmcnt(8)
 MF 208,104,40,208
 TR 124,9,25440
 MF 212,104,44,212
 TR 126,9,25696
 s_waitcnt lgkmcnt(8)
 MF 216,108,40,216
 TR 96,9,25472
 MF 220,108,44,220
 TR 98,9,25728
 s_waitcnt lgkmcnt(8)
 MF 160,112,48,160
 TR 100,9,25504
 MF 164,112,52,164
 TR 102,9,25760
 s_waitcnt lgkmcnt(8)
 MF 168,116,48,168
 TR 104,9,25536
 MF 172,116,52,172
 TR 106,9,25792
 s_add_u32 s58, s59, 28672
 buffer_load_dwordx4 v[32:35], v1, s[44:47], s58 offen offset:0 sc1
 s_waitcnt lgkmcnt(8)
 MF 176,120,48,176
 TR 108,9,25568
 MF 180,120,52,180
 TR 110,9,25824
 buffer_load_dwordx4 v[36:39], v1, s[44:47], s58 offen offset:1024 sc1
 s_waitcnt lgkmcnt(8)
 MF 184,124,48,184
 TR 112,9,33792
 MF 188,124,52,188
 TR 114,9,34048
 buffer_load_dwordx4 v[40:43], v1, s[44:47], s58 offen offset:2048 sc1
 s_waitcnt lgkmcnt(8)
 MF 192,96,48,192
 TR 116,9,33824
 MF 196,96,52,196
 TR 118,9,34080
 s_waitcnt lgkmcnt(8)
 MF 200,100,48,200
 TR 120,9,33856
 MF 204,100,52,204
 TR 122,9,34112
 buffer_load_dwordx4 v[44:47], v1, s[44:47], s58 offen offset:3072 sc1
 s_waitcnt lgkmcnt(8)
 MF 208,104,48,208
 TR 124,9,33888
 MF 212,104,52,212
 TR 126,9,34144
 s_add_u32 s57, s60, 28672
 buffer_store_dwordx4 v[92:95], v1, s[44:47], s57 offen sc1
 s_waitcnt lgkmcnt(8)
 MF 216,108,48,216
 TR 96,9,33920
 MF 220,108,52,220
 TR 98,9,34176
 s_add_u32 s57, s61, 24576
 buffer_store_dwordx4 v[156:159], v1, s[44:47], s57 offen offset:1024 sc1
 s_waitcnt lgkmcnt(8)
 MF 160,112,56,160
 TR 100,9,33952
 MF 164,112,60,164
 TR 102,9,34208
 s_waitcnt lgkmcnt(8)
 MF 168,116,56,168
 TR 104,9,33984
 MF 172,116,60,172
 TR 106,9,34240
 s_waitcnt lgkmcnt(8)
 MF 176,120,56,176
 TR 108,9,34016
 MF 180,120,60,180
 TR 110,9,34272
 s_waitcnt lgkmcnt(8)
 MF 184,124,56,184
 s_waitcnt vmcnt(6)
 s_barrier
 TR 112,10,0
 MF 188,124,60,188
 TR 114,10,256
 s_mov_b32 s55, 0x380000
 s_add_u32 m0, s53, 87808
 s_nop 0
 buffer_load_dwordx4 v2, s[12:15], s55 offen  lds
 s_waitcnt lgkmcnt(8)
 MF 192,96,56,192
 TR 116,10,32
 MF 196,96,60,196
 TR 118,10,288
 s_mov_b32 s56, 0x3c0000
 s_add_u32 m0, s53, 96256
 s_nop 0
 buffer_load_dwordx4 v2, s[12:15], s56 offen  lds
 s_waitcnt lgkmcnt(8)
 MF 200,100,56,200
 TR 120,10,64
 MF 204,100,60,204
 TR 122,10,320
 s_waitcnt lgkmcnt(8)
 MF 208,104,56,208
 TR 124,10,96
 MF 212,104,60,212
 TR 126,10,352
 s_waitcnt lgkmcnt(8)
 MF 216,108,56,216
 TR 96,10,128
 MF 220,108,60,220
 TR 98,10,384
 s_waitcnt lgkmcnt(8)
 MF 160,112,16,160
 TR 100,10,160
 MF 164,112,20,164
 TR 102,10,416
 s_waitcnt lgkmcnt(8)
 MF 168,116,16,168
 TR 104,10,192
 MF 172,116,20,172
 TR 106,10,448
 s_add_u32 s58, s59, 32768
 buffer_load_dwordx4 v[48:51], v1, s[44:47], s58 offen offset:0 sc1
 s_waitcnt lgkmcnt(8)
 MF 176,120,16,176
 TR 108,10,224
 MF 180,120,20,180
 TR 110,10,480
 s_waitcnt lgkmcnt(8)
 MF 184,124,16,184
 TR 112,10,8448
 MF 188,124,20,188
 TR 114,10,8704
 buffer_load_dwordx4 v[52:55], v1, s[44:47], s58 offen offset:1024 sc1
 s_waitcnt lgkmcnt(8)
 MF 192,96,16,192
 TR 116,10,8480
 MF 196,96,20,196
 TR 118,10,8736
 s_waitcnt lgkmcnt(8)
 MF 200,100,16,200
 TR 120,10,8512
 MF 204,100,20,204
 TR 122,10,8768
 buffer_load_dwordx4 v[56:59], v1, s[44:47], s58 offen offset:2048 sc1
 s_waitcnt lgkmcnt(8)
 MF 208,104,16,208
 TR 124,10,8544
 MF 212,104,20,212
 TR 126,10,8800
 s_waitcnt lgkmcnt(8)
 MF 216,108,16,216
 TR 96,10,8576
 MF 220,108,20,220
 TR 98,10,8832
 buffer_load_dwordx4 v[60:63], v1, s[44:47], s58 offen offset:3072 sc1
 s_waitcnt lgkmcnt(8)
 MF 160,112,24,160
 TR 100,10,8608
 MF 164,112,28,164
 TR 102,10,8864
 s_waitcnt lgkmcnt(8)
 MF 168,116,24,168
 TR 104,10,8640
 MF 172,116,28,172
 TR 106,10,8896
 s_waitcnt lgkmcnt(8)
 MF 176,120,24,176
 TR 108,10,8672
 MF 180,120,28,180
 TR 110,10,8928
 s_waitcnt lgkmcnt(8)
 MF 184,124,24,184
 s_waitcnt vmcnt(4)
 s_barrier
 TR 112,9,0
 MF 188,124,28,188
 TR 114,9,256
 s_mov_b32 s55, 0x400000
 s_add_u32 m0, s53, 113152
 s_nop 0
 buffer_load_dwordx4 v2, s[12:15], s55 offen  lds
 s_waitcnt lgkmcnt(8)
 MF 192,96,24,192
 TR 116,9,32
 MF 196,96,28,196
 TR 118,9,288
 s_mov_b32 s56, 0x440000
 s_add_u32 m0, s53, 121600
 s_nop 0
 buffer_load_dwordx4 v2, s[12:15], s56 offen  lds
 s_waitcnt lgkmcnt(8)
 MF 200,100,24,200
 TR 120,9,64
 MF 204,100,28,204
 TR 122,9,320
 s_waitcnt lgkmcnt(8)
 MF 208,104,24,208
 TR 124,9,96
 MF 212,104,28,212
 TR 126,9,352
 s_waitcnt lgkmcnt(8)
 MF 216,108,24,216
 TR 96,9,128
 MF 220,108,28,220
 TR 98,9,384
 s_waitcnt lgkmcnt(8)
 MF 160,112,32,160
 TR 100,9,160
 MF 164,112,36,164
 TR 102,9,416
 s_lshl_b32 s57, s49, 7
 s_cmp_eq_u32 s48, 0
 s_cselect_b32 s57, s57, 0x10000000
 v_mov_b32 v5, 1
 s_mov_b64 exec, 1
 buffer_atomic_add v5, v4, s[44:47], s57 offen
 s_mov_b64 exec, -1
 s_waitcnt lgkmcnt(8)
 MF 168,116,32,168
 TR 104,9,192
 MF 172,116,36,172
 TR 106,9,448
 s_add_u32 s58, s59, 36864
 buffer_load_dwordx4 v[16:19], v1, s[44:47], s58 offen offset:0 sc1
 s_waitcnt lgkmcnt(8)
 MF 176,120,32,176
 TR 108,9,224
 MF 180,120,36,180
 TR 110,9,480
 s_waitcnt lgkmcnt(8)
 MF 184,124,32,184
 TR 112,9,8448
 MF 188,124,36,188
 TR 114,9,8704
 buffer_load_dwordx4 v[20:23], v1, s[44:47], s58 offen offset:1024 sc1
 s_waitcnt lgkmcnt(8)
 MF 192,96,32,192
 TR 116,9,8480
 MF 196,96,36,196
 TR 118,9,8736
 s_waitcnt lgkmcnt(8)
 MF 200,100,32,200
 TR 120,9,8512
 MF 204,100,36,204
 TR 122,9,8768
 buffer_load_dwordx4 v[24:27], v1, s[44:47], s58 offen offset:2048 sc1
 s_waitcnt lgkmcnt(8)
 MF 208,104,32,208
 TR 124,9,8544
 MF 212,104,36,212
 TR 126,9,8800
 s_waitcnt lgkmcnt(8)
 MF 216,108,32,216
 TR 96,9,8576
 MF 220,108,36,220
 TR 98,9,8832
 buffer_load_dwordx4 v[28:31], v1, s[44:47], s58 offen offset:3072 sc1
 s_waitcnt lgkmcnt(8)
 MF 160,112,40,160
 TR 100,9,8608
 MF 164,112,44,164
 TR 102,9,8864
 s_waitcnt lgkmcnt(8)
 MF 168,116,40,168
 TR 104,9,8640
 MF 172,116,44,172
 TR 106,9,8896
 s_waitcnt lgkmcnt(8)
 MF 176,120,40,176
 TR 108,9,8672
 MF 180,120,44,180
 TR 110,9,8928
 s_waitcnt lgkmcnt(8)
 MF 184,124,40,184
 s_waitcnt vmcnt(5)
 s_barrier
 s_cmp_lt_u32 s48, 4
 s_cbranch_scc1 Lpr_17
 s_setprio 1
Lpr_17:
 TR 112,9,25344
 MF 188,124,44,188
 TR 114,9,25600
 s_mov_b32 s55, 0x480000
 s_add_u32 m0, s53, 138496
 s_nop 0
 buffer_load_dwordx4 v2, s[12:15], s55 offen  lds
 s_waitcnt lgkmcnt(8)
 MF 192,96,40,192
 TR 116,9,25376
 MF 196,96,44,196
 TR 118,9,25632
 s_mov_b32 s56, 0x4c0000
 s_add_u32 m0, s53, 146944
 s_nop 0
 buffer_load_dwordx4 v2, s[12:15], s56 offen  lds
 s_waitcnt lgkmcnt(8)
 MF 200,100,40,200
 TR 120,9,25408
 MF 204,100,44,204
 TR 122,9,25664
 s_waitcnt lgkmcnt(8)
 MF 208,104,40,208
 TR 124,9,25440
 MF 212,104,44,212
 TR 126,9,25696
 s_waitcnt lgkmcnt(8)
 MF 216,108,40,216
 TR 96,9,25472
 MF 220,108,44,220
 TR 98,9,25728
 s_waitcnt lgkmcnt(8)
 MF 160,112,48,160
 TR 100,9,25504
 MF 164,112,52,164
 TR 102,9,25760
 s_waitcnt lgkmcnt(8)
 MF 168,116,48,168
 TR 104,9,25536
 MF 172,116,52,172
 TR 106,9,25792
 s_waitcnt lgkmcnt(8)
 MF 176,120,48,176
 TR 108,9,25568
 MF 180,120,52,180
 TR 110,9,25824
 s_waitcnt lgkmcnt(8)
 MF 184,124,48,184
 TR 112,9,33792
 MF 188,124,52,188
 TR 114,9,34048
 s_waitcnt lgkmcnt(8)
 MF 192,96,48,192
 TR 116,9,33824
 MF 196,96,52,196
 TR 118,9,34080
 s_waitcnt lgkmcnt(8)
 MF 200,100,48,200
 TR 120,9,33856
 MF 204,100,52,204
 TR 122,9,34112
 s_waitcnt lgkmcnt(8)
 MF 208,104,48,208
 TR 124,9,33888
 MF 212,104,52,212
 TR 126,9,34144
 s_waitcnt lgkmcnt(8)
 MF 216,108,48,216
 TR 96,9,33920
 MF 220,108,52,220
 TR 98,9,34176
 s_waitcnt lgkmcnt(8)
 MF 160,112,56,160
 TR 100,9,33952
 MF 164,112,60,164
 TR 102,9,34208
 s_waitcnt lgkmcnt(8)
 MF 168,116,56,168
 TR 104,9,33984
 MF 172,116,60,172
 TR 106,9,34240
 s_waitcnt lgkmcnt(8)
 MF 176,120,56,176
 TR 108,9,34016
 MF 180,120,60,180
 TR 110,9,34272
 s_waitcnt lgkmcnt(8)
 MF 184,124,56,184
 s_cmp_lg_u32 s48, 4
 s_cbranch_scc1 Lh2_18
 s_lshl_b32 s58, s49, 7
 s_mov_b32 s66, 0x10000
Lpoll_19:
 buffer_load_dword v5, v4, s[44:47], s58 offen sc1
 s_waitcnt vmcnt(0)
 v_readfirstlane_b32 s57, v5
 s_cmp_ge_u32 s57, 8
 s_cbranch_scc1 Lpolld_20
 s_sleep 2
 s_sub_u32 s66, s66, 1
 s_cmp_lg_u32 s66, 0
 s_cbranch_scc1 Lpoll_19
Lpolld_20:
Lh2_18:
 s_waitcnt vmcnt(0)
 s_barrier
 s_mul_i32 s77, s49, 0x106000
 s_add_u32 s77, s77, 0x960000
 s_and_b32 s57, s48, 3
 s_lshl_b32 s57, s57, 12
 s_add_u32 s77, s77, s57
 s_add_u32 s71, s77, 0x81000
 s_add_u32 s70, s77, 8192
 s_mov_b32 s72, s57
 s_cmp_lt_u32 s57, 8192
 s_cselect_b32 s78, s77, s71
 s_sub_u32 s94, s77, s57
 s_lshl_b32 s57, s50, 15
 s_sub_u32 s94, s94, s57
 s_add_u32 s94, s94, 0x80000
 s_add_u32 s95, s94, 0x83000
 TR 112,10,0
 MF 188,124,60,188
 TR 114,10,256
 s_waitcnt lgkmcnt(8)
 MF 192,96,56,192
 TR 116,10,32
 MF 196,96,60,196
 TR 118,10,288
 s_waitcnt lgkmcnt(8)
 MF 200,100,56,200
 TR 120,10,64
 MF 204,100,60,204
 TR 122,10,320
 s_waitcnt lgkmcnt(8)
 MF 208,104,56,208
 TR 124,10,96
 MF 212,104,60,212
 TR 126,10,352
 s_waitcnt lgkmcnt(8)
 MF 216,108,56,216
 TR 96,10,128
 MF 220,108,60,220
 TR 98,10,384
 s_waitcnt lgkmcnt(8)
 MF 160,112,16,160
 TR 100,10,160
 MF 164,112,20,164
 TR 102,10,416
 v_mov_b32 v9, 0xff800000
 v_mov_b32 v13, v1
 s_cmp_lt_u32 s48, 4
 s_cbranch_scc1 Lkvp_21
 s_add_u32 m0, s72, 0
 s_cmp_lt_u32 s70, s94
 s_cselect_b32 s96, s70, 0x10000000
 buffer_load_dwordx4 v1, s[44:47], s96 offen offset:0 sc1 lds
 buffer_load_dwordx4 v1, s[44:47], s96 offen offset:1024 sc1 lds
 buffer_load_dwordx4 v1, s[44:47], s96 offen offset:2048 sc1 lds
 buffer_load_dwordx4 v1, s[44:47], s96 offen offset:3072 sc1 lds
Lkvp_21:
 s_waitcnt lgkmcnt(8)
 MF 168,116,16,168
 TR 104,10,192
 MF 172,116,20,172
 TR 106,10,448
 v_and_b32 v11, 48, v0
 v_lshrrev_b32 v11, 2, v11
 s_waitcnt lgkmcnt(8)
 MF 176,120,16,176
 TR 108,10,224
 MF 180,120,20,180
 TR 110,10,480
 v_and_b32 v156, 15, v0
 v_sub_u32 v11, v156, v11
 s_cmp_lt_u32 s48, 4
 s_cbranch_scc1 Lkvp_22
 s_add_u32 m0, s72, 16384
 s_cmp_lt_u32 s78, s95
 s_cselect_b32 s96, s78, 0x10000000
 buffer_load_dwordx4 v1, s[44:47], s96 offen offset:0 sc1 lds
 buffer_load_dwordx4 v1, s[44:47], s96 offen offset:1024 sc1 lds
 buffer_load_dwordx4 v1, s[44:47], s96 offen offset:2048 sc1 lds
 buffer_load_dwordx4 v1, s[44:47], s96 offen offset:3072 sc1 lds
 s_add_u32 s70, s70, 16384
 s_add_u32 s71, s71, 16384
 s_add_u32 s72, s72, 32768
 s_and_b32 s72, s72, 0x1ffff
Lkvp_22:
 s_waitcnt lgkmcnt(8)
 MF 184,124,16,184
 TR 112,10,8448
 MF 188,124,20,188
 TR 114,10,8704
 v_mov_b64 v[128:129], 0
 v_mov_b64 v[130:131], 0
 s_waitcnt lgkmcnt(8)
 MF 192,96,16,192
 TR 116,10,8480
 MF 196,96,20,196
 TR 118,10,8736
 v_mov_b64 v[132:133], 0
 s_cmp_lt_u32 s48, 4
 s_cbranch_scc1 Lkvp_23
 s_add_u32 m0, s72, 0
 s_cmp_lt_u32 s70, s94
 s_cselect_b32 s96, s70, 0x10000000
 buffer_load_dwordx4 v1, s[44:47], s96 offen offset:0 sc1 lds
 buffer_load_dwordx4 v1, s[44:47], s96 offen offset:1024 sc1 lds
 buffer_load_dwordx4 v1, s[44:47], s96 offen offset:2048 sc1 lds
 buffer_load_dwordx4 v1, s[44:47], s96 offen offset:3072 sc1 lds
Lkvp_23:
 s_waitcnt lgkmcnt(8)
 MF 200,100,16,200
 TR 120,10,8512
 MF 204,100,20,204
 TR 122,10,8768
 v_mov_b64 v[134:135], 0
 s_waitcnt lgkmcnt(8)
 MF 208,104,16,208
 TR 124,10,8544
 MF 212,104,20,212
 TR 126,10,8800
 v_mov_b64 v[136:137], 0
 v_mov_b64 v[138:139], 0
 s_cmp_lt_u32 s48, 4
 s_cbranch_scc1 Lkvp_24
 s_add_u32 m0, s72, 16384
 s_cmp_lt_u32 s71, s95
 s_cselect_b32 s96, s71, 0x10000000
 buffer_load_dwordx4 v1, s[44:47], s96 offen offset:0 sc1 lds
 buffer_load_dwordx4 v1, s[44:47], s96 offen offset:1024 sc1 lds
 buffer_load_dwordx4 v1, s[44:47], s96 offen offset:2048 sc1 lds
 buffer_load_dwordx4 v1, s[44:47], s96 offen offset:3072 sc1 lds
 s_add_u32 s70, s70, 16384
 s_add_u32 s71, s71, 16384
 s_add_u32 s72, s72, 32768
 s_and_b32 s72, s72, 0x1ffff
Lkvp_24:
 s_waitcnt lgkmcnt(8)
 MF 216,108,16,216
 TR 96,10,8576
 MF 220,108,20,220
 TR 98,10,8832
 v_mov_b64 v[140:141], 0
 s_waitcnt lgkmcnt(8)
 MF 160,112,24,160
 TR 100,10,8608
 MF 164,112,28,164
 TR 102,10,8864
 v_mov_b64 v[142:143], 0
 s_cmp_lt_u32 s48, 4
 s_cbranch_scc1 Lkvp_25
 s_add_u32 m0, s72, 0
 s_cmp_lt_u32 s70, s94
 s_cselect_b32 s96, s70, 0x10000000
 buffer_load_dwordx4 v1, s[44:47], s96 offen offset:0 sc1 lds
 buffer_load_dwordx4 v1, s[44:47], s96 offen offset:1024 sc1 lds
 buffer_load_dwordx4 v1, s[44:47], s96 offen offset:2048 sc1 lds
 buffer_load_dwordx4 v1, s[44:47], s96 offen offset:3072 sc1 lds
Lkvp_25:
 s_waitcnt lgkmcnt(8)
 MF 168,116,24,168
 TR 104,10,8640
 MF 172,116,28,172
 TR 106,10,8896
 v_mov_b64 v[144:145], 0
 v_mov_b64 v[146:147], 0
 s_waitcnt lgkmcnt(8)
 MF 176,120,24,176
 TR 108,10,8672
 MF 180,120,28,180
 TR 110,10,8928
 v_mov_b64 v[148:149], 0
 s_cmp_lt_u32 s48, 4
 s_cbranch_scc1 Lkvp_26
 s_add_u32 m0, s72, 16384
 s_cmp_lt_u32 s71, s95
 s_cselect_b32 s96, s71, 0x10000000
 buffer_load_dwordx4 v1, s[44:47], s96 offen offset:0 sc1 lds
 buffer_load_dwordx4 v1, s[44:47], s96 offen offset:1024 sc1 lds
 buffer_load_dwordx4 v1, s[44:47], s96 offen offset:2048 sc1 lds
 buffer_load_dwordx4 v1, s[44:47], s96 offen offset:3072 sc1 lds
 s_add_u32 s70, s70, 16384
 s_add_u32 s71, s71, 16384
 s_add_u32 s72, s72, 32768
 s_and_b32 s72, s72, 0x1ffff
Lkvp_26:
 s_waitcnt lgkmcnt(8)
 MF 184,124,24,184
 MF 188,124,28,188
 v_mov_b64 v[150:151], 0
 s_waitcnt lgkmcnt(6)
 MF 192,96,24,192
 MF 196,96,28,196
 v_mov_b32 v152, 0x3f803f80
 v_mov_b32 v153, 0x3f803f80
 s_waitcnt lgkmcnt(4)
 MF 200,100,24,200
 MF 204,100,28,204
 v_mov_b32 v154, 0x3f803f80
 s_waitcnt lgkmcnt(2)
 MF 208,104,24,208
 MF 212,104,28,212
 v_mov_b32 v155, 0x3f803f80
 s_waitcnt lgkmcnt(0)
 MF 216,108,24,216
 MF 220,108,28,220
 s_nop 7
 v_pk_mul_f32 v[160:161], v[160:161], s[64:65]
 v_pk_mul_f32 v[162:163], v[162:163], s[64:65]
 v_pk_mul_f32 v[164:165], v[164:165], s[64:65]
 v_pk_mul_f32 v[166:167], v[166:167], s[64:65]
 v_pk_mul_f32 v[168:169], v[168:169], s[64:65]
 v_pk_mul_f32 v[170:171], v[170:171], s[64:65]
 v_pk_mul_f32 v[172:173], v[172:173], s[64:65]
 v_pk_mul_f32 v[174:175], v[174:175], s[64:65]
 v_pk_mul_f32 v[176:177], v[176:177], s[64:65]
 v_pk_mul_f32 v[178:179], v[178:179], s[64:65]
 v_pk_mul_f32 v[180:181], v[180:181], s[64:65]
 v_pk_mul_f32 v[182:183], v[182:183], s[64:65]
 v_pk_mul_f32 v[184:185], v[184:185], s[64:65]
 v_pk_mul_f32 v[186:187], v[186:187], s[64:65]
 v_pk_mul_f32 v[188:189], v[188:189], s[64:65]
 v_pk_mul_f32 v[190:191], v[190:191], s[64:65]
 v_pk_mul_f32 v[192:193], v[192:193], s[64:65]
 v_pk_mul_f32 v[194:195], v[194:195], s[64:65]
 v_pk_mul_f32 v[196:197], v[196:197], s[64:65]
 v_pk_mul_f32 v[198:199], v[198:199], s[64:65]
 v_pk_mul_f32 v[200:201], v[200:201], s[64:65]
 v_pk_mul_f32 v[202:203], v[202:203], s[64:65]
 v_pk_mul_f32 v[204:205], v[204:205], s[64:65]
 v_pk_mul_f32 v[206:207], v[206:207], s[64:65]
 v_pk_mul_f32 v[208:209], v[208:209], s[64:65]
 v_pk_mul_f32 v[210:211], v[210:211], s[64:65]
 v_pk_mul_f32 v[212:213], v[212:213], s[64:65]
 v_pk_mul_f32 v[214:215], v[214:215], s[64:65]
 v_pk_mul_f32 v[216:217], v[216:217], s[64:65]
 v_pk_mul_f32 v[218:219], v[218:219], s[64:65]
 v_pk_mul_f32 v[220:221], v[220:221], s[64:65]
 v_pk_mul_f32 v[222:223], v[222:223], s[64:65]
 v_cvt_pk_bf16_f32 v16, v160, v161
 v_cvt_pk_bf16_f32 v17, v162, v163
 v_cvt_pk_bf16_f32 v18, v168, v169
 v_cvt_pk_bf16_f32 v19, v170, v171
 v_cvt_pk_bf16_f32 v20, v176, v177
 v_cvt_pk_bf16_f32 v21, v178, v179
 v_cvt_pk_bf16_f32 v22, v184, v185
 v_cvt_pk_bf16_f32 v23, v186, v187
 v_cvt_pk_bf16_f32 v24, v192, v193
 v_cvt_pk_bf16_f32 v25, v194, v195
 v_cvt_pk_bf16_f32 v26, v200, v201
 v_cvt_pk_bf16_f32 v27, v202, v203
 v_cvt_pk_bf16_f32 v28, v208, v209
 v_cvt_pk_bf16_f32 v29, v210, v211
 v_cvt_pk_bf16_f32 v30, v216, v217
 v_cvt_pk_bf16_f32 v31, v218, v219
 v_cvt_pk_bf16_f32 v32, v164, v165
 v_cvt_pk_bf16_f32 v33, v166, v167
 v_cvt_pk_bf16_f32 v34, v172, v173
 v_cvt_pk_bf16_f32 v35, v174, v175
 v_cvt_pk_bf16_f32 v36, v180, v181
 v_cvt_pk_bf16_f32 v37, v182, v183
 v_cvt_pk_bf16_f32 v38, v188, v189
 v_cvt_pk_bf16_f32 v39, v190, v191
 v_cvt_pk_bf16_f32 v40, v196, v197
 v_cvt_pk_bf16_f32 v41, v198, v199
 v_cvt_pk_bf16_f32 v42, v204, v205
 v_cvt_pk_bf16_f32 v43, v206, v207
 v_cvt_pk_bf16_f32 v44, v212, v213
 v_cvt_pk_bf16_f32 v45, v214, v215
 v_cvt_pk_bf16_f32 v46, v220, v221
 v_cvt_pk_bf16_f32 v47, v222, v223
L_q_done:
 v_mov_b32 v5, 132128
 ds_write_b32 v5, v4
L_att_start:
 v_mov_b64 v[160:161], 0
 v_mov_b64 v[162:163], 0
 v_mov_b64 v[164:165], 0
 v_mov_b64 v[166:167], 0
 v_mov_b64 v[168:169], 0
 v_mov_b64 v[170:171], 0
 v_mov_b64 v[172:173], 0
 v_mov_b64 v[174:175], 0
 v_mov_b64 v[176:177], 0
 v_mov_b64 v[178:179], 0
 v_mov_b64 v[180:181], 0
 v_mov_b64 v[182:183], 0
 v_mov_b64 v[184:185], 0
 v_mov_b64 v[186:187], 0
 v_mov_b64 v[188:189], 0
 v_mov_b64 v[190:191], 0
 v_mov_b64 v[192:193], 0
 v_mov_b64 v[194:195], 0
 v_mov_b64 v[196:197], 0
 v_mov_b64 v[198:199], 0
 v_mov_b64 v[200:201], 0
 v_mov_b64 v[202:203], 0
 v_mov_b64 v[204:205], 0
 v_mov_b64 v[206:207], 0
 v_mov_b64 v[208:209], 0
 v_mov_b64 v[210:211], 0
 v_mov_b64 v[212:213], 0
 v_mov_b64 v[214:215], 0
 v_mov_b64 v[216:217], 0
 v_mov_b64 v[218:219], 0
 v_mov_b64 v[220:221], 0
 v_mov_b64 v[222:223], 0
 s_lshl_b32 s57, s50, 1
 s_sub_u32 s74, 32, s57
 s_add_u32 s57, s69, 1
 s_lshr_b32 s57, s57, 1
 s_sub_u32 s74, s74, s57
 s_cmp_lg_u32 s69, 0
 s_cbranch_scc1 Lm0_27
 v_cmp_le_i32 vcc, 0, v11
 v_mov_b32 v136, v9
 s_nop 0
 v_cndmask_b32 v128, v9, v128, vcc
 v_cndmask_b32 v140, v9, v140, vcc
 v_cmp_le_i32 vcc, 1, v11
 v_mov_b32 v137, v9
 s_nop 0
 v_cndmask_b32 v129, v9, v129, vcc
 v_cndmask_b32 v141, v9, v141, vcc
 v_cmp_le_i32 vcc, 2, v11
 v_mov_b32 v138, v9
 s_nop 0
 v_cndmask_b32 v130, v9, v130, vcc
 v_cndmask_b32 v142, v9, v142, vcc
 v_cmp_le_i32 vcc, 3, v11
 v_mov_b32 v139, v9
 s_nop 0
 v_cndmask_b32 v131, v9, v131, vcc
 v_cndmask_b32 v143, v9, v143, vcc
 s_nop 1
Lm0_27:
 s_waitcnt vmcnt(16) lgkmcnt(0)
 s_barrier
 RD 64,13,16384
 RD 68,13,17408
 RD 72,13,18432
 RD 76,13,19456
 RD 80,13,20480
 RD 84,13,21504
 RD 88,13,22528
 RD 92,13,23552
 v_mov_b32 v56, 0
 v_mov_b32 v57, 0
 v_mov_b32 v58, 0
 v_mov_b32 v59, 0
 v_mov_b32 v60, 0
 v_mov_b32 v61, 0
 v_mov_b32 v62, 0
 v_mov_b32 v63, 0
 s_waitcnt lgkmcnt(7)
 MF 96,64,16,128
 MF 100,64,32,132
 RD 64,13,0
 s_waitcnt lgkmcnt(7)
 MF 96,68,20,96
 MF 100,68,36,100
 RD 68,13,1024
 s_waitcnt lgkmcnt(7)
 MF 96,72,24,96
 MF 100,72,40,100
 RD 72,13,2048
 s_waitcnt lgkmcnt(7)
 MF 96,76,28,96
 MF 100,76,44,100
 RD 76,13,3072
 s_waitcnt lgkmcnt(7)
 MF 104,80,16,136
 MF 108,80,32,140
 RD 80,13,4096
 s_waitcnt lgkmcnt(7)
 MF 104,84,20,104
 MF 108,84,36,108
 RD 84,13,5120
 s_waitcnt lgkmcnt(7)
 MF 104,88,24,104
 MF 108,88,40,108
 s_waitcnt lgkmcnt(6)
 MF 104,92,28,104
 MF 108,92,44,108
 s_nop 7
 v_max3_f32 v156, v96, v97, v98
 v_max3_f32 v156, v156, v99, v104
 v_max3_f32 v156, v156, v105, v106
 v_max_f32 v156, v156, v107
 v_mov_b32 v158, v156
 s_nop 1
 v_permlane16_swap_b32 v156, v158
 v_max_f32 v156, v156, v158
 v_mov_b32 v158, v156
 s_nop 1
 v_permlane32_swap_b32 v156, v158
 v_max_f32 v156, v156, v158
 v_sub_f32 v96, v96, v156
 v_sub_f32 v128, 0, v156
 v_sub_f32 v97, v97, v156
 v_sub_f32 v129, 0, v156
 v_sub_f32 v98, v98, v156
 v_sub_f32 v130, 0, v156
 v_sub_f32 v99, v99, v156
 v_sub_f32 v131, 0, v156
 v_sub_f32 v104, v104, v156
 v_sub_f32 v136, 0, v156
 v_sub_f32 v105, v105, v156
 v_sub_f32 v137, 0, v156
 v_sub_f32 v106, v106, v156
 v_sub_f32 v138, 0, v156
 v_sub_f32 v107, v107, v156
 v_sub_f32 v139, 0, v156
 v_max3_f32 v157, v100, v101, v102
 v_max3_f32 v157, v157, v103, v108
 v_max3_f32 v157, v157, v109, v110
 v_max_f32 v157, v157, v111
 v_mov_b32 v158, v157
 s_nop 1
 v_permlane16_swap_b32 v157, v158
 v_max_f32 v157, v157, v158
 v_mov_b32 v158, v157
 s_nop 1
 v_permlane32_swap_b32 v157, v158
 v_max_f32 v157, v157, v158
 v_sub_f32 v100, v100, v157
 v_sub_f32 v132, 0, v157
 v_sub_f32 v101, v101, v157
 v_sub_f32 v133, 0, v157
 v_sub_f32 v102, v102, v157
 v_sub_f32 v134, 0, v157
 v_sub_f32 v103, v103, v157
 v_sub_f32 v135, 0, v157
 v_sub_f32 v108, v108, v157
 v_sub_f32 v140, 0, v157
 v_sub_f32 v109, v109, v157
 v_sub_f32 v141, 0, v157
 v_sub_f32 v110, v110, v157
 v_sub_f32 v142, 0, v157
 v_sub_f32 v111, v111, v157
 v_sub_f32 v143, 0, v157
 s_cmp_lg_u32 s92, 0
 s_cbranch_scc1 Lh3_28
 s_cmp_lg_u32 s73, 0
 s_cbranch_scc1 Lh3_28
 s_lshl_b32 s57, s51, 7
 s_add_u32 s57, s57, 4096
 s_waitcnt vmcnt(0)
 v_mov_b32 v5, 1
 s_mov_b64 exec, 1
 buffer_atomic_add v5, v4, s[44:47], s57 offen
 s_mov_b64 exec, -1
Lh3_28:
 s_cmp_ge_u32 s48, 4
 s_cbranch_scc1 Lpf3_29
 s_cmp_lt_u32 s50, 2
 s_cbranch_scc1 Lpf3_29
 s_sub_u32 s57, s2, 64
 s_lshl_b32 s57, s57, 2
 s_add_u32 s57, s57, s48
 s_mul_i32 s58, s57, 6912
 v_lshlrev_b32 v5, 7, v0
 v_min_u32 v5, 6784, v5
 buffer_load_dword v8, v5, s[24:27], s58 offen
 s_mul_i32 s58, s57, 2944
 v_min_u32 v5, 2816, v5
 buffer_load_dword v8, v5, s[32:35], s58 offen
Lpf3_29:
 s_sub_u32 s68, s69, 1
 s_mov_b32 s67, 0
 s_mov_b32 s63, 0
 s_cmp_lg_u32 s73, 0
 s_cbranch_scc1 Lns_30
 s_cmp_lt_u32 s69, 2
 s_cbranch_scc1 Lns_30
 s_mov_b32 s68, 1
 s_sub_u32 s67, s69, 2
 s_lshr_b32 s63, s67, 2
 s_and_b32 s67, s67, 3
Lns_30:
 s_cmp_lg_u32 s69, 1
 s_cbranch_scc1 Lm1_31
 v_cmp_le_i32 vcc, 0, v11
 v_mov_b32 v136, v9
 s_nop 0
 v_cndmask_b32 v128, v9, v128, vcc
 v_cndmask_b32 v140, v9, v140, vcc
 v_cmp_le_i32 vcc, 1, v11
 v_mov_b32 v137, v9
 s_nop 0
 v_cndmask_b32 v129, v9, v129, vcc
 v_cndmask_b32 v141, v9, v141, vcc
 v_cmp_le_i32 vcc, 2, v11
 v_mov_b32 v138, v9
 s_nop 0
 v_cndmask_b32 v130, v9, v130, vcc
 v_cndmask_b32 v142, v9, v142, vcc
 v_cmp_le_i32 vcc, 3, v11
 v_mov_b32 v139, v9
 s_nop 0
 v_cndmask_b32 v131, v9, v131, vcc
 v_cndmask_b32 v143, v9, v143, vcc
 s_nop 1
Lm1_31:
 s_cmp_ge_u32 s48, 4
 s_cbranch_scc1 L_S_entry
 s_sub_u32 s63, s63, 1
 s_cbranch_scc1 L_L_loop
 .p2align 6
L_L_fast:
 s_waitcnt lgkmcnt(4)
 MF 112,64,16,128
 v_exp_f32 v156, v96
 MF 116,64,32,132
 RD 88,13,6144
 MF 112,68,20,112
 v_exp_f32 v157, v97
 MF 116,68,36,116
 RD 92,13,7168
 s_waitcnt lgkmcnt(4)
 MF 112,72,24,112
 v_exp_f32 v158, v98
 MF 116,72,40,116
 RD 64,13,16384
 v_cvt_pk_bf16_f32 v48, v156, v157
 MF 112,76,28,112
 v_exp_f32 v159, v99
 MF 116,76,44,116
 RD 68,13,17408
 s_waitcnt lgkmcnt(4)
 MF 120,80,16,136
 v_exp_f32 v156, v104
 MF 124,80,32,140
 RD 72,13,18432
 v_cvt_pk_bf16_f32 v49, v158, v159
 MF 120,84,20,120
 v_exp_f32 v157, v105
 MF 124,84,36,124
 RD 76,13,19456
 s_waitcnt lgkmcnt(4)
 MF 120,88,24,120
 v_exp_f32 v158, v106
 MF 124,88,40,124
 RD 80,13,20480
 v_cvt_pk_bf16_f32 v50, v156, v157
 MF 120,92,28,120
 v_exp_f32 v159, v107
 MF 124,92,44,124
 RD 84,13,21504
 s_waitcnt lgkmcnt(4)
 MF 160,64,56,160
 v_exp_f32 v156, v100
 MF 164,64,60,164
 RD 88,13,22528
 v_cvt_pk_bf16_f32 v51, v158, v159
 MF 168,68,56,168
 v_exp_f32 v157, v101
 MF 172,68,60,172
 RD 92,13,23552
 s_waitcnt lgkmcnt(4)
 MF 176,72,56,176
 v_exp_f32 v158, v102
 MF 180,72,60,180
 RD 64,13,8192
 v_cvt_pk_bf16_f32 v52, v156, v157
 MF 184,76,56,184
 v_exp_f32 v159, v103
 MF 188,76,60,188
 RD 68,13,9216
 MF 144,152,56,144
 s_waitcnt lgkmcnt(4)
 MF 192,80,56,192
 v_exp_f32 v156, v108
 MF 196,80,60,196
 RD 72,13,10240
 v_cvt_pk_bf16_f32 v53, v158, v159
 MF 200,84,56,200
 v_exp_f32 v157, v109
 MF 204,84,60,204
 RD 76,13,11264
 s_waitcnt lgkmcnt(4)
 MF 208,88,56,208
 v_exp_f32 v158, v110
 MF 212,88,60,212
 RD 80,13,12288
 v_cvt_pk_bf16_f32 v54, v156, v157
 MF 216,92,56,216
 v_exp_f32 v159, v111
 MF 220,92,60,220
 RD 84,13,13312
 v_cvt_pk_bf16_f32 v55, v158, v159
 MF 148,152,60,148
 s_waitcnt lgkmcnt(4)
 MF 96,64,16,128
 v_exp_f32 v156, v112
 MF 100,64,32,132
 RD 88,13,14336
 MF 96,68,20,96
 v_exp_f32 v157, v113
 MF 100,68,36,100
 RD 92,13,15360
 s_waitcnt lgkmcnt(4)
 MF 96,72,24,96
 v_exp_f32 v158, v114
 MF 100,72,40,100
 RD 64,13,24576
 v_cvt_pk_bf16_f32 v56, v156, v157
 MF 96,76,28,96
 v_exp_f32 v159, v115
 MF 100,76,44,100
 RD 68,13,25600
 s_waitcnt lgkmcnt(4)
 MF 104,80,16,136
 v_exp_f32 v156, v120
 MF 108,80,32,140
 RD 72,13,26624
 v_cvt_pk_bf16_f32 v57, v158, v159
 MF 104,84,20,104
 v_exp_f32 v157, v121
 MF 108,84,36,108
 RD 76,13,27648
 s_waitcnt lgkmcnt(4)
 MF 104,88,24,104
 v_exp_f32 v158, v122
 MF 108,88,40,108
 RD 80,13,28672
 v_cvt_pk_bf16_f32 v58, v156, v157
 MF 104,92,28,104
 v_exp_f32 v159, v123
 MF 108,92,44,108
 RD 84,13,29696
 s_waitcnt lgkmcnt(4)
 MF 160,64,48,160
 v_exp_f32 v156, v116
 MF 164,64,52,164
 RD 88,13,30720
 v_cvt_pk_bf16_f32 v59, v158, v159
 MF 168,68,48,168
 v_exp_f32 v157, v117
 MF 172,68,52,172
 RD 92,13,31744
 s_waitcnt lgkmcnt(4)
 MF 176,72,48,176
 v_exp_f32 v158, v118
 MF 180,72,52,180
 s_barrier
 RD 64,13,32768
 v_cvt_pk_bf16_f32 v60, v156, v157
 MF 184,76,48,184
 v_exp_f32 v159, v119
 MF 188,76,52,188
 RD 68,13,33792
 MF 144,152,48,144
 s_waitcnt lgkmcnt(4)
 MF 192,80,48,192
 v_exp_f32 v156, v124
 MF 196,80,52,196
 RD 72,13,34816
 v_cvt_pk_bf16_f32 v61, v158, v159
 MF 200,84,48,200
 v_exp_f32 v157, v125
 MF 204,84,52,204
 RD 76,13,35840
 s_waitcnt lgkmcnt(4)
 MF 208,88,48,208
 v_exp_f32 v158, v126
 MF 212,88,52,212
 RD 80,13,36864
 v_cvt_pk_bf16_f32 v62, v156, v157
 MF 216,92,48,216
 v_exp_f32 v159, v127
 MF 220,92,52,220
 RD 84,13,37888
 v_cvt_pk_bf16_f32 v63, v158, v159
 MF 148,152,52,148
 s_waitcnt lgkmcnt(4)
 MF 112,64,16,128
 v_exp_f32 v156, v96
 MF 116,64,32,132
 RD 88,13,38912
 MF 112,68,20,112
 v_exp_f32 v157, v97
 MF 116,68,36,116
 RD 92,13,39936
 s_waitcnt lgkmcnt(4)
 MF 112,72,24,112
 v_exp_f32 v158, v98
 MF 116,72,40,116
 RD 64,13,49152
 v_cvt_pk_bf16_f32 v48, v156, v157
 MF 112,76,28,112
 v_exp_f32 v159, v99
 MF 116,76,44,116
 RD 68,13,50176
 s_waitcnt lgkmcnt(4)
 MF 120,80,16,136
 v_exp_f32 v156, v104
 MF 124,80,32,140
 RD 72,13,51200
 v_cvt_pk_bf16_f32 v49, v158, v159
 MF 120,84,20,120
 v_exp_f32 v157, v105
 MF 124,84,36,124
 RD 76,13,52224
 s_waitcnt lgkmcnt(4)
 MF 120,88,24,120
 v_exp_f32 v158, v106
 MF 124,88,40,124
 RD 80,13,53248
 v_cvt_pk_bf16_f32 v50, v156, v157
 MF 120,92,28,120
 v_exp_f32 v159, v107
 MF 124,92,44,124
 RD 84,13,54272
 s_waitcnt lgkmcnt(4)
 MF 160,64,56,160
 v_exp_f32 v156, v100
 MF 164,64,60,164
 RD 88,13,55296
 v_cvt_pk_bf16_f32 v51, v158, v159
 MF 168,68,56,168
 v_exp_f32 v157, v101
 MF 172,68,60,172
 RD 92,13,56320
 s_waitcnt lgkmcnt(4)
 MF 176,72,56,176
 v_exp_f32 v158, v102
 MF 180,72,60,180
 RD 64,13,40960
 v_cvt_pk_bf16_f32 v52, v156, v157
 MF 184,76,56,184
 v_exp_f32 v159, v103
 MF 188,76,60,188
 RD 68,13,41984
 MF 144,152,56,144
 s_waitcnt lgkmcnt(4)
 MF 192,80,56,192
 v_exp_f32 v156, v108
 MF 196,80,60,196
 RD 72,13,43008
 v_cvt_pk_bf16_f32 v53, v158, v159
 MF 200,84,56,200
 v_exp_f32 v157, v109
 MF 204,84,60,204
 RD 76,13,44032
 s_waitcnt lgkmcnt(4)
 MF 208,88,56,208
 v_exp_f32 v158, v110
 MF 212,88,60,212
 RD 80,13,45056
 v_cvt_pk_bf16_f32 v54, v156, v157
 MF 216,92,56,216
 v_exp_f32 v159, v111
 MF 220,92,60,220
 RD 84,13,46080
 v_cvt_pk_bf16_f32 v55, v158, v159
 MF 148,152,60,148
 s_waitcnt lgkmcnt(4)
 MF 96,64,16,128
 v_exp_f32 v156, v112
 MF 100,64,32,132
 RD 88,13,47104
 MF 96,68,20,96
 v_exp_f32 v157, v113
 MF 100,68,36,100
 RD 92,13,48128
 s_waitcnt lgkmcnt(4)
 MF 96,72,24,96
 v_exp_f32 v158, v114
 MF 100,72,40,100
 RD 64,13,57344
 v_cvt_pk_bf16_f32 v56, v156, v157
 MF 96,76,28,96
 v_exp_f32 v159, v115
 MF 100,76,44,100
 RD 68,13,58368
 s_waitcnt lgkmcnt(4)
 MF 104,80,16,136
 v_exp_f32 v156, v120
 MF 108,80,32,140
 RD 72,13,59392
 v_cvt_pk_bf16_f32 v57, v158, v159
 MF 104,84,20,104
 v_exp_f32 v157, v121
 MF 108,84,36,108
 RD 76,13,60416
 s_waitcnt lgkmcnt(4)
 MF 104,88,24,104
 v_exp_f32 v158, v122
 MF 108,88,40,108
 RD 80,13,61440
 v_cvt_pk_bf16_f32 v58, v156, v157
 MF 104,92,28,104
 v_exp_f32 v159, v123
 MF 108,92,44,108
 RD 84,13,62464
 s_waitcnt lgkmcnt(4)
 MF 160,64,48,160
 v_exp_f32 v156, v116
 MF 164,64,52,164
 RD 88,13,63488
 v_cvt_pk_bf16_f32 v59, v158, v159
 MF 168,68,48,168
 v_exp_f32 v157, v117
 MF 172,68,52,172
 RD 92,13,64512
 v_xor_b32 v13, 0x10000, v13
 s_waitcnt lgkmcnt(4)
 MF 176,72,48,176
 v_exp_f32 v158, v118
 MF 180,72,52,180
 s_barrier
 RD 64,13,0
 v_cvt_pk_bf16_f32 v60, v156, v157
 MF 184,76,48,184
 v_exp_f32 v159, v119
 MF 188,76,52,188
 RD 68,13,1024
 MF 144,152,48,144
 s_waitcnt lgkmcnt(4)
 MF 192,80,48,192
 v_exp_f32 v156, v124
 MF 196,80,52,196
 RD 72,13,2048
 v_cvt_pk_bf16_f32 v61, v158, v159
 MF 200,84,48,200
 v_exp_f32 v157, v125
 MF 204,84,52,204
 RD 76,13,3072
 s_waitcnt lgkmcnt(4)
 MF 208,88,48,208
 v_exp_f32 v158, v126
 MF 212,88,52,212
 RD 80,13,4096
 v_cvt_pk_bf16_f32 v62, v156, v157
 MF 216,92,48,216
 v_exp_f32 v159, v127
 MF 220,92,52,220
 RD 84,13,5120
 v_cvt_pk_bf16_f32 v63, v158, v159
 MF 148,152,52,148
 s_sub_u32 s63, s63, 1
 s_cbranch_scc0 L_L_fast
L_L_loop:
 s_waitcnt lgkmcnt(4)
 MF 112,64,16,128
 v_exp_f32 v156, v96
 MF 116,64,32,132
 RD 88,13,6144
 MF 112,68,20,112
 v_exp_f32 v157, v97
 MF 116,68,36,116
 RD 92,13,7168
 s_waitcnt lgkmcnt(4)
 MF 112,72,24,112
 v_exp_f32 v158, v98
 MF 116,72,40,116
 RD 64,13,16384
 v_cvt_pk_bf16_f32 v48, v156, v157
 MF 112,76,28,112
 v_exp_f32 v159, v99
 MF 116,76,44,116
 RD 68,13,17408
 s_waitcnt lgkmcnt(4)
 MF 120,80,16,136
 v_exp_f32 v156, v104
 MF 124,80,32,140
 RD 72,13,18432
 v_cvt_pk_bf16_f32 v49, v158, v159
 MF 120,84,20,120
 v_exp_f32 v157, v105
 MF 124,84,36,124
 RD 76,13,19456
 s_waitcnt lgkmcnt(4)
 MF 120,88,24,120
 v_exp_f32 v158, v106
 MF 124,88,40,124
 RD 80,13,20480
 v_cvt_pk_bf16_f32 v50, v156, v157
 MF 120,92,28,120
 v_exp_f32 v159, v107
 MF 124,92,44,124
 RD 84,13,21504
 s_waitcnt lgkmcnt(4)
 MF 160,64,56,160
 v_exp_f32 v156, v100
 MF 164,64,60,164
 RD 88,13,22528
 v_cvt_pk_bf16_f32 v51, v158, v159
 MF 168,68,56,168
 v_exp_f32 v157, v101
 MF 172,68,60,172
 RD 92,13,23552
 s_waitcnt lgkmcnt(4)
 MF 176,72,56,176
 v_exp_f32 v158, v102
 MF 180,72,60,180
 RD 64,13,8192
 v_cvt_pk_bf16_f32 v52, v156, v157
 MF 184,76,56,184
 v_exp_f32 v159, v103
 MF 188,76,60,188
 RD 68,13,9216
 MF 144,152,56,144
 s_waitcnt lgkmcnt(4)
 MF 192,80,56,192
 v_exp_f32 v156, v108
 MF 196,80,60,196
 RD 72,13,10240
 v_cvt_pk_bf16_f32 v53, v158, v159
 MF 200,84,56,200
 v_exp_f32 v157, v109
 MF 204,84,60,204
 RD 76,13,11264
 s_waitcnt lgkmcnt(4)
 MF 208,88,56,208
 v_exp_f32 v158, v110
 MF 212,88,60,212
 RD 80,13,12288
 v_cvt_pk_bf16_f32 v54, v156, v157
 MF 216,92,56,216
 v_exp_f32 v159, v111
 MF 220,92,60,220
 RD 84,13,13312
 v_cvt_pk_bf16_f32 v55, v158, v159
 MF 148,152,60,148
 s_sub_u32 s67, s67, 1
 s_cbranch_scc1 L_L_h0
L_L_c0:
 s_waitcnt lgkmcnt(4)
 MF 96,64,16,128
 v_exp_f32 v156, v112
 MF 100,64,32,132
 RD 88,13,14336
 MF 96,68,20,96
 v_exp_f32 v157, v113
 MF 100,68,36,100
 RD 92,13,15360
 s_waitcnt lgkmcnt(4)
 MF 96,72,24,96
 v_exp_f32 v158, v114
 MF 100,72,40,100
 RD 64,13,24576
 v_cvt_pk_bf16_f32 v56, v156, v157
 MF 96,76,28,96
 v_exp_f32 v159, v115
 MF 100,76,44,100
 RD 68,13,25600
 s_waitcnt lgkmcnt(4)
 MF 104,80,16,136
 v_exp_f32 v156, v120
 MF 108,80,32,140
 RD 72,13,26624
 v_cvt_pk_bf16_f32 v57, v158, v159
 MF 104,84,20,104
 v_exp_f32 v157, v121
 MF 108,84,36,108
 RD 76,13,27648
 s_waitcnt lgkmcnt(4)
 MF 104,88,24,104
 v_exp_f32 v158, v122
 MF 108,88,40,108
 RD 80,13,28672
 v_cvt_pk_bf16_f32 v58, v156, v157
 MF 104,92,28,104
 v_exp_f32 v159, v123
 MF 108,92,44,108
 RD 84,13,29696
 s_waitcnt lgkmcnt(4)
 MF 160,64,48,160
 v_exp_f32 v156, v116
 MF 164,64,52,164
 RD 88,13,30720
 v_cvt_pk_bf16_f32 v59, v158, v159
 MF 168,68,48,168
 v_exp_f32 v157, v117
 MF 172,68,52,172
 RD 92,13,31744
 s_waitcnt lgkmcnt(4)
 MF 176,72,48,176
 v_exp_f32 v158, v118
 MF 180,72,52,180
 v_add_u32 v13, 0x8000, v13
 v_and_b32 v13, 0x1ffff, v13
 s_barrier
 RD 64,13,0
 v_cvt_pk_bf16_f32 v60, v156, v157
 MF 184,76,48,184
 v_exp_f32 v159, v119
 MF 188,76,52,188
 RD 68,13,1024
 MF 144,152,48,144
 s_waitcnt lgkmcnt(4)
 MF 192,80,48,192
 v_exp_f32 v156, v124
 MF 196,80,52,196
 RD 72,13,2048
 v_cvt_pk_bf16_f32 v61, v158, v159
 MF 200,84,48,200
 v_exp_f32 v157, v125
 MF 204,84,52,204
 RD 76,13,3072
 s_waitcnt lgkmcnt(4)
 MF 208,88,48,208
 v_exp_f32 v158, v126
 MF 212,88,52,212
 RD 80,13,4096
 v_cvt_pk_bf16_f32 v62, v156, v157
 MF 216,92,48,216
 v_exp_f32 v159, v127
 MF 220,92,52,220
 RD 84,13,5120
 v_cvt_pk_bf16_f32 v63, v158, v159
 MF 148,152,52,148
 s_sub_u32 s67, s67, 1
 s_cbranch_scc0 L_L_loop
L_L_h1:
 s_cmp_eq_u32 s73, 0
 s_cbranch_scc1 Lnsafe_32
 s_nop 7
 v_max3_f32 v156, v96, v97, v98
 v_max3_f32 v156, v156, v99, v104
 v_max3_f32 v156, v156, v105, v106
 v_max_f32 v156, v156, v107
 v_mov_b32 v157, v156
 s_nop 1
 v_permlane16_swap_b32 v156, v157
 v_max_f32 v156, v156, v157
 v_mov_b32 v157, v156
 s_nop 1
 v_permlane32_swap_b32 v156, v157
 v_max_f32 v156, v156, v157
 v_max_f32 v156, 0, v156
 v_exp_f32 v158, -v156
 v_sub_f32 v96, v96, v156
 v_sub_f32 v128, v128, v156
 v_sub_f32 v97, v97, v156
 v_sub_f32 v129, v129, v156
 v_sub_f32 v98, v98, v156
 v_sub_f32 v130, v130, v156
 v_sub_f32 v99, v99, v156
 v_sub_f32 v131, v131, v156
 v_sub_f32 v104, v104, v156
 v_sub_f32 v136, v136, v156
 v_sub_f32 v105, v105, v156
 v_sub_f32 v137, v137, v156
 v_sub_f32 v106, v106, v156
 v_sub_f32 v138, v138, v156
 v_sub_f32 v107, v107, v156
 v_sub_f32 v139, v139, v156
 v_mul_f32 v160, v160, v158
 v_mul_f32 v161, v161, v158
 v_mul_f32 v162, v162, v158
 v_mul_f32 v163, v163, v158
 v_mul_f32 v168, v168, v158
 v_mul_f32 v169, v169, v158
 v_mul_f32 v170, v170, v158
 v_mul_f32 v171, v171, v158
 v_mul_f32 v176, v176, v158
 v_mul_f32 v177, v177, v158
 v_mul_f32 v178, v178, v158
 v_mul_f32 v179, v179, v158
 v_mul_f32 v184, v184, v158
 v_mul_f32 v185, v185, v158
 v_mul_f32 v186, v186, v158
 v_mul_f32 v187, v187, v158
 v_mul_f32 v192, v192, v158
 v_mul_f32 v193, v193, v158
 v_mul_f32 v194, v194, v158
 v_mul_f32 v195, v195, v158
 v_mul_f32 v200, v200, v158
 v_mul_f32 v201, v201, v158
 v_mul_f32 v202, v202, v158
 v_mul_f32 v203, v203, v158
 v_mul_f32 v208, v208, v158
 v_mul_f32 v209, v209, v158
 v_mul_f32 v210, v210, v158
 v_mul_f32 v211, v211, v158
 v_mul_f32 v216, v216, v158
 v_mul_f32 v217, v217, v158
 v_mul_f32 v218, v218, v158
 v_mul_f32 v219, v219, v158
 v_mul_f32 v144, v144, v158
 v_lshlrev_b32 v159, 16, v56
 v_and_b32 v157, 0xffff0000, v56
 v_mul_f32 v159, v159, v158
 v_mul_f32 v157, v157, v158
 v_cvt_pk_bf16_f32 v56, v159, v157
 v_mul_f32 v145, v145, v158
 v_lshlrev_b32 v159, 16, v57
 v_and_b32 v157, 0xffff0000, v57
 v_mul_f32 v159, v159, v158
 v_mul_f32 v157, v157, v158
 v_cvt_pk_bf16_f32 v57, v159, v157
 v_mul_f32 v146, v146, v158
 v_lshlrev_b32 v159, 16, v58
 v_and_b32 v157, 0xffff0000, v58
 v_mul_f32 v159, v159, v158
 v_mul_f32 v157, v157, v158
 v_cvt_pk_bf16_f32 v58, v159, v157
 v_mul_f32 v147, v147, v158
 v_lshlrev_b32 v159, 16, v59
 v_and_b32 v157, 0xffff0000, v59
 v_mul_f32 v159, v159, v158
 v_mul_f32 v157, v157, v158
 v_cvt_pk_bf16_f32 v59, v159, v157
 v_max3_f32 v156, v100, v101, v102
 v_max3_f32 v156, v156, v103, v108
 v_max3_f32 v156, v156, v109, v110
 v_max_f32 v156, v156, v111
 v_mov_b32 v157, v156
 s_nop 1
 v_permlane16_swap_b32 v156, v157
 v_max_f32 v156, v156, v157
 v_mov_b32 v157, v156
 s_nop 1
 v_permlane32_swap_b32 v156, v157
 v_max_f32 v156, v156, v157
 v_max_f32 v156, 0, v156
 v_exp_f32 v158, -v156
 v_sub_f32 v100, v100, v156
 v_sub_f32 v132, v132, v156
 v_sub_f32 v101, v101, v156
 v_sub_f32 v133, v133, v156
 v_sub_f32 v102, v102, v156
 v_sub_f32 v134, v134, v156
 v_sub_f32 v103, v103, v156
 v_sub_f32 v135, v135, v156
 v_sub_f32 v108, v108, v156
 v_sub_f32 v140, v140, v156
 v_sub_f32 v109, v109, v156
 v_sub_f32 v141, v141, v156
 v_sub_f32 v110, v110, v156
 v_sub_f32 v142, v142, v156
 v_sub_f32 v111, v111, v156
 v_sub_f32 v143, v143, v156
 v_mul_f32 v164, v164, v158
 v_mul_f32 v165, v165, v158
 v_mul_f32 v166, v166, v158
 v_mul_f32 v167, v167, v158
 v_mul_f32 v172, v172, v158
 v_mul_f32 v173, v173, v158
 v_mul_f32 v174, v174, v158
 v_mul_f32 v175, v175, v158
 v_mul_f32 v180, v180, v158
 v_mul_f32 v181, v181, v158
 v_mul_f32 v182, v182, v158
 v_mul_f32 v183, v183, v158
 v_mul_f32 v188, v188, v158
 v_mul_f32 v189, v189, v158
 v_mul_f32 v190, v190, v158
 v_mul_f32 v191, v191, v158
 v_mul_f32 v196, v196, v158
 v_mul_f32 v197, v197, v158
 v_mul_f32 v198, v198, v158
 v_mul_f32 v199, v199, v158
 v_mul_f32 v204, v204, v158
 v_mul_f32 v205, v205, v158
 v_mul_f32 v206, v206, v158
 v_mul_f32 v207, v207, v158
 v_mul_f32 v212, v212, v158
 v_mul_f32 v213, v213, v158
 v_mul_f32 v214, v214, v158
 v_mul_f32 v215, v215, v158
 v_mul_f32 v220, v220, v158
 v_mul_f32 v221, v221, v158
 v_mul_f32 v222, v222, v158
 v_mul_f32 v223, v223, v158
 v_mul_f32 v148, v148, v158
 v_lshlrev_b32 v159, 16, v60
 v_and_b32 v157, 0xffff0000, v60
 v_mul_f32 v159, v159, v158
 v_mul_f32 v157, v157, v158
 v_cvt_pk_bf16_f32 v60, v159, v157
 v_mul_f32 v149, v149, v158
 v_lshlrev_b32 v159, 16, v61
 v_and_b32 v157, 0xffff0000, v61
 v_mul_f32 v159, v159, v158
 v_mul_f32 v157, v157, v158
 v_cvt_pk_bf16_f32 v61, v159, v157
 v_mul_f32 v150, v150, v158
 v_lshlrev_b32 v159, 16, v62
 v_and_b32 v157, 0xffff0000, v62
 v_mul_f32 v159, v159, v158
 v_mul_f32 v157, v157, v158
 v_cvt_pk_bf16_f32 v62, v159, v157
 v_mul_f32 v151, v151, v158
 v_lshlrev_b32 v159, 16, v63
 v_and_b32 v157, 0xffff0000, v63
 v_mul_f32 v159, v159, v158
 v_mul_f32 v157, v157, v158
 v_cvt_pk_bf16_f32 v63, v159, v157
 s_nop 1
Lnsafe_32:
 s_cmp_eq_u32 s68, 0
 s_cbranch_scc1 L_L_tail0
 s_cmp_lg_u32 s68, 1
 s_cbranch_scc1 Lnmask_33
 v_cmp_le_i32 vcc, 0, v11
 v_mov_b32 v136, v9
 s_nop 0
 v_cndmask_b32 v128, v9, v128, vcc
 v_cndmask_b32 v140, v9, v140, vcc
 v_cmp_le_i32 vcc, 1, v11
 v_mov_b32 v137, v9
 s_nop 0
 v_cndmask_b32 v129, v9, v129, vcc
 v_cndmask_b32 v141, v9, v141, vcc
 v_cmp_le_i32 vcc, 2, v11
 v_mov_b32 v138, v9
 s_nop 0
 v_cndmask_b32 v130, v9, v130, vcc
 v_cndmask_b32 v142, v9, v142, vcc
 v_cmp_le_i32 vcc, 3, v11
 v_mov_b32 v139, v9
 s_nop 0
 v_cndmask_b32 v131, v9, v131, vcc
 v_cndmask_b32 v143, v9, v143, vcc
 s_nop 1
Lnmask_33:
 s_sub_u32 s68, s68, 1
 s_mov_b32 s67, 0
 s_branch L_L_loop
L_L_h0:
 s_cmp_eq_u32 s73, 0
 s_cbranch_scc1 Lnsafe_34
 s_nop 7
 v_max3_f32 v156, v112, v113, v114
 v_max3_f32 v156, v156, v115, v120
 v_max3_f32 v156, v156, v121, v122
 v_max_f32 v156, v156, v123
 v_mov_b32 v157, v156
 s_nop 1
 v_permlane16_swap_b32 v156, v157
 v_max_f32 v156, v156, v157
 v_mov_b32 v157, v156
 s_nop 1
 v_permlane32_swap_b32 v156, v157
 v_max_f32 v156, v156, v157
 v_max_f32 v156, 0, v156
 v_exp_f32 v158, -v156
 v_sub_f32 v112, v112, v156
 v_sub_f32 v128, v128, v156
 v_sub_f32 v113, v113, v156
 v_sub_f32 v129, v129, v156
 v_sub_f32 v114, v114, v156
 v_sub_f32 v130, v130, v156
 v_sub_f32 v115, v115, v156
 v_sub_f32 v131, v131, v156
 v_sub_f32 v120, v120, v156
 v_sub_f32 v136, v136, v156
 v_sub_f32 v121, v121, v156
 v_sub_f32 v137, v137, v156
 v_sub_f32 v122, v122, v156
 v_sub_f32 v138, v138, v156
 v_sub_f32 v123, v123, v156
 v_sub_f32 v139, v139, v156
 v_mul_f32 v160, v160, v158
 v_mul_f32 v161, v161, v158
 v_mul_f32 v162, v162, v158
 v_mul_f32 v163, v163, v158
 v_mul_f32 v168, v168, v158
 v_mul_f32 v169, v169, v158
 v_mul_f32 v170, v170, v158
 v_mul_f32 v171, v171, v158
 v_mul_f32 v176, v176, v158
 v_mul_f32 v177, v177, v158
 v_mul_f32 v178, v178, v158
 v_mul_f32 v179, v179, v158
 v_mul_f32 v184, v184, v158
 v_mul_f32 v185, v185, v158
 v_mul_f32 v186, v186, v158
 v_mul_f32 v187, v187, v158
 v_mul_f32 v192, v192, v158
 v_mul_f32 v193, v193, v158
 v_mul_f32 v194, v194, v158
 v_mul_f32 v195, v195, v158
 v_mul_f32 v200, v200, v158
 v_mul_f32 v201, v201, v158
 v_mul_f32 v202, v202, v158
 v_mul_f32 v203, v203, v158
 v_mul_f32 v208, v208, v158
 v_mul_f32 v209, v209, v158
 v_mul_f32 v210, v210, v158
 v_mul_f32 v211, v211, v158
 v_mul_f32 v216, v216, v158
 v_mul_f32 v217, v217, v158
 v_mul_f32 v218, v218, v158
 v_mul_f32 v219, v219, v158
 v_mul_f32 v144, v144, v158
 v_lshlrev_b32 v159, 16, v48
 v_and_b32 v157, 0xffff0000, v48
 v_mul_f32 v159, v159, v158
 v_mul_f32 v157, v157, v158
 v_cvt_pk_bf16_f32 v48, v159, v157
 v_mul_f32 v145, v145, v158
 v_lshlrev_b32 v159, 16, v49
 v_and_b32 v157, 0xffff0000, v49
 v_mul_f32 v159, v159, v158
 v_mul_f32 v157, v157, v158
 v_cvt_pk_bf16_f32 v49, v159, v157
 v_mul_f32 v146, v146, v158
 v_lshlrev_b32 v159, 16, v50
 v_and_b32 v157, 0xffff0000, v50
 v_mul_f32 v159, v159, v158
 v_mul_f32 v157, v157, v158
 v_cvt_pk_bf16_f32 v50, v159, v157
 v_mul_f32 v147, v147, v158
 v_lshlrev_b32 v159, 16, v51
 v_and_b32 v157, 0xffff0000, v51
 v_mul_f32 v159, v159, v158
 v_mul_f32 v157, v157, v158
 v_cvt_pk_bf16_f32 v51, v159, v157
 v_max3_f32 v156, v116, v117, v118
 v_max3_f32 v156, v156, v119, v124
 v_max3_f32 v156, v156, v125, v126
 v_max_f32 v156, v156, v127
 v_mov_b32 v157, v156
 s_nop 1
 v_permlane16_swap_b32 v156, v157
 v_max_f32 v156, v156, v157
 v_mov_b32 v157, v156
 s_nop 1
 v_permlane32_swap_b32 v156, v157
 v_max_f32 v156, v156, v157
 v_max_f32 v156, 0, v156
 v_exp_f32 v158, -v156
 v_sub_f32 v116, v116, v156
 v_sub_f32 v132, v132, v156
 v_sub_f32 v117, v117, v156
 v_sub_f32 v133, v133, v156
 v_sub_f32 v118, v118, v156
 v_sub_f32 v134, v134, v156
 v_sub_f32 v119, v119, v156
 v_sub_f32 v135, v135, v156
 v_sub_f32 v124, v124, v156
 v_sub_f32 v140, v140, v156
 v_sub_f32 v125, v125, v156
 v_sub_f32 v141, v141, v156
 v_sub_f32 v126, v126, v156
 v_sub_f32 v142, v142, v156
 v_sub_f32 v127, v127, v156
 v_sub_f32 v143, v143, v156
 v_mul_f32 v164, v164, v158
 v_mul_f32 v165, v165, v158
 v_mul_f32 v166, v166, v158
 v_mul_f32 v167, v167, v158
 v_mul_f32 v172, v172, v158
 v_mul_f32 v173, v173, v158
 v_mul_f32 v174, v174, v158
 v_mul_f32 v175, v175, v158
 v_mul_f32 v180, v180, v158
 v_mul_f32 v181, v181, v158
 v_mul_f32 v182, v182, v158
 v_mul_f32 v183, v183, v158
 v_mul_f32 v188, v188, v158
 v_mul_f32 v189, v189, v158
 v_mul_f32 v190, v190, v158
 v_mul_f32 v191, v191, v158
 v_mul_f32 v196, v196, v158
 v_mul_f32 v197, v197, v158
 v_mul_f32 v198, v198, v158
 v_mul_f32 v199, v199, v158
 v_mul_f32 v204, v204, v158
 v_mul_f32 v205, v205, v158
 v_mul_f32 v206, v206, v158
 v_mul_f32 v207, v207, v158
 v_mul_f32 v212, v212, v158
 v_mul_f32 v213, v213, v158
 v_mul_f32 v214, v214, v158
 v_mul_f32 v215, v215, v158
 v_mul_f32 v220, v220, v158
 v_mul_f32 v221, v221, v158
 v_mul_f32 v222, v222, v158
 v_mul_f32 v223, v223, v158
 v_mul_f32 v148, v148, v158
 v_lshlrev_b32 v159, 16, v52
 v_and_b32 v157, 0xffff0000, v52
 v_mul_f32 v159, v159, v158
 v_mul_f32 v157, v157, v158
 v_cvt_pk_bf16_f32 v52, v159, v157
 v_mul_f32 v149, v149, v158
 v_lshlrev_b32 v159, 16, v53
 v_and_b32 v157, 0xffff0000, v53
 v_mul_f32 v159, v159, v158
 v_mul_f32 v157, v157, v158
 v_cvt_pk_bf16_f32 v53, v159, v157
 v_mul_f32 v150, v150, v158
 v_lshlrev_b32 v159, 16, v54
 v_and_b32 v157, 0xffff0000, v54
 v_mul_f32 v159, v159, v158
 v_mul_f32 v157, v157, v158
 v_cvt_pk_bf16_f32 v54, v159, v157
 v_mul_f32 v151, v151, v158
 v_lshlrev_b32 v159, 16, v55
 v_and_b32 v157, 0xffff0000, v55
 v_mul_f32 v159, v159, v158
 v_mul_f32 v157, v157, v158
 v_cvt_pk_bf16_f32 v55, v159, v157
 s_nop 1
Lnsafe_34:
 s_cmp_eq_u32 s68, 0
 s_cbranch_scc1 L_L_tail1
 s_cmp_lg_u32 s68, 1
 s_cbranch_scc1 Lnmask_35
 v_cmp_le_i32 vcc, 0, v11
 v_mov_b32 v136, v9
 s_nop 0
 v_cndmask_b32 v128, v9, v128, vcc
 v_cndmask_b32 v140, v9, v140, vcc
 v_cmp_le_i32 vcc, 1, v11
 v_mov_b32 v137, v9
 s_nop 0
 v_cndmask_b32 v129, v9, v129, vcc
 v_cndmask_b32 v141, v9, v141, vcc
 v_cmp_le_i32 vcc, 2, v11
 v_mov_b32 v138, v9
 s_nop 0
 v_cndmask_b32 v130, v9, v130, vcc
 v_cndmask_b32 v142, v9, v142, vcc
 v_cmp_le_i32 vcc, 3, v11
 v_mov_b32 v139, v9
 s_nop 0
 v_cndmask_b32 v131, v9, v131, vcc
 v_cndmask_b32 v143, v9, v143, vcc
 s_nop 1
Lnmask_35:
 s_sub_u32 s68, s68, 1
 s_mov_b32 s67, 0
 s_branch L_L_c0
L_L_tail0:
 s_lshl_b32 s76, s79, 7
 s_add_u32 s76, s76, 4096
 buffer_load_dword v10, v4, s[44:47], s76 offen sc1
 s_waitcnt lgkmcnt(0)
 RD 64,13,16384
 RD 68,13,17408
 RD 72,13,18432
 RD 76,13,19456
 RD 80,13,20480
 RD 84,13,21504
 RD 88,13,22528
 RD 92,13,23552
 v_exp_f32 v156, v96
 v_exp_f32 v157, v97
 v_exp_f32 v158, v98
 v_cvt_pk_bf16_f32 v48, v156, v157
 v_exp_f32 v159, v99
 v_exp_f32 v156, v104
 v_cvt_pk_bf16_f32 v49, v158, v159
 v_exp_f32 v157, v105
 v_exp_f32 v158, v106
 v_cvt_pk_bf16_f32 v50, v156, v157
 v_exp_f32 v159, v107
 v_exp_f32 v156, v100
 v_cvt_pk_bf16_f32 v51, v158, v159
 v_exp_f32 v157, v101
 v_exp_f32 v158, v102
 v_cvt_pk_bf16_f32 v52, v156, v157
 v_exp_f32 v159, v103
 v_exp_f32 v156, v108
 v_cvt_pk_bf16_f32 v53, v158, v159
 v_exp_f32 v157, v109
 v_exp_f32 v158, v110
 v_cvt_pk_bf16_f32 v54, v156, v157
 v_exp_f32 v159, v111
 MF 144,152,56,144
 v_cvt_pk_bf16_f32 v55, v158, v159
 MF 148,152,60,148
 s_waitcnt lgkmcnt(7)
 MF 160,64,56,160
 MF 164,64,60,164
 RD 64,13,24576
 s_waitcnt lgkmcnt(7)
 MF 168,68,56,168
 MF 172,68,60,172
 RD 68,13,25600
 s_waitcnt lgkmcnt(7)
 MF 176,72,56,176
 MF 180,72,60,180
 RD 72,13,26624
 s_waitcnt lgkmcnt(7)
 MF 184,76,56,184
 MF 188,76,60,188
 RD 76,13,27648
 s_waitcnt lgkmcnt(7)
 MF 192,80,56,192
 MF 196,80,60,196
 RD 80,13,28672
 s_waitcnt lgkmcnt(7)
 MF 200,84,56,200
 MF 204,84,60,204
 RD 84,13,29696
 s_waitcnt lgkmcnt(7)
 MF 208,88,56,208
 MF 212,88,60,212
 RD 88,13,30720
 s_waitcnt lgkmcnt(7)
 MF 216,92,56,216
 MF 220,92,60,220
 RD 92,13,31744
 MF 144,152,48,144
 MF 148,152,52,148
 s_waitcnt lgkmcnt(7)
 MF 160,64,48,160
 MF 164,64,52,164
 s_waitcnt lgkmcnt(6)
 MF 168,68,48,168
 MF 172,68,52,172
 s_waitcnt lgkmcnt(5)
 MF 176,72,48,176
 MF 180,72,52,180
 s_waitcnt lgkmcnt(4)
 MF 184,76,48,184
 MF 188,76,52,188
 s_waitcnt lgkmcnt(3)
 MF 192,80,48,192
 MF 196,80,52,196
 s_waitcnt lgkmcnt(2)
 MF 200,84,48,200
 MF 204,84,52,204
 s_waitcnt lgkmcnt(1)
 MF 208,88,48,208
 MF 212,88,52,212
 s_waitcnt lgkmcnt(0)
 MF 216,92,48,216
 MF 220,92,52,220
 s_branch L_L_done
L_L_tail1:
 s_lshl_b32 s76, s79, 7
 s_add_u32 s76, s76, 4096
 buffer_load_dword v10, v4, s[44:47], s76 offen sc1
 s_waitcnt lgkmcnt(0)
 RD 64,13,24576
 RD 68,13,25600
 RD 72,13,26624
 RD 76,13,27648
 RD 80,13,28672
 RD 84,13,29696
 RD 88,13,30720
 RD 92,13,31744
 v_exp_f32 v156, v112
 v_exp_f32 v157, v113
 v_exp_f32 v158, v114
 v_cvt_pk_bf16_f32 v56, v156, v157
 v_exp_f32 v159, v115
 v_exp_f32 v156, v120
 v_cvt_pk_bf16_f32 v57, v158, v159
 v_exp_f32 v157, v121
 v_exp_f32 v158, v122
 v_cvt_pk_bf16_f32 v58, v156, v157
 v_exp_f32 v159, v123
 v_exp_f32 v156, v116
 v_cvt_pk_bf16_f32 v59, v158, v159
 v_exp_f32 v157, v117
 v_exp_f32 v158, v118
 v_cvt_pk_bf16_f32 v60, v156, v157
 v_exp_f32 v159, v119
 v_exp_f32 v156, v124
 v_cvt_pk_bf16_f32 v61, v158, v159
 v_exp_f32 v157, v125
 v_exp_f32 v158, v126
 v_cvt_pk_bf16_f32 v62, v156, v157
 v_exp_f32 v159, v127
 MF 144,152,48,144
 v_cvt_pk_bf16_f32 v63, v158, v159
 MF 148,152,52,148
 s_waitcnt lgkmcnt(0)
 v_add_u32 v13, 0x8000, v13
 v_and_b32 v13, 0x1ffff, v13
 s_barrier
 MF 160,64,48,160
 MF 164,64,52,164
 RD 64,13,16384
 MF 168,68,48,168
 MF 172,68,52,172
 RD 68,13,17408
 MF 176,72,48,176
 MF 180,72,52,180
 RD 72,13,18432
 MF 184,76,48,184
 MF 188,76,52,188
 RD 76,13,19456
 MF 192,80,48,192
 MF 196,80,52,196
 RD 80,13,20480
 MF 200,84,48,200
 MF 204,84,52,204
 RD 84,13,21504
 MF 208,88,48,208
 MF 212,88,52,212
 RD 88,13,22528
 MF 216,92,48,216
 MF 220,92,52,220
 RD 92,13,23552
 MF 144,152,56,144
 MF 148,152,60,148
 s_waitcnt lgkmcnt(7)
 MF 160,64,56,160
 MF 164,64,60,164
 s_waitcnt lgkmcnt(6)
 MF 168,68,56,168
 MF 172,68,60,172
 s_waitcnt lgkmcnt(5)
 MF 176,72,56,176
 MF 180,72,60,180
 s_waitcnt lgkmcnt(4)
 MF 184,76,56,184
 MF 188,76,60,188
 s_waitcnt lgkmcnt(3)
 MF 192,80,56,192
 MF 196,80,60,196
 s_waitcnt lgkmcnt(2)
 MF 200,84,56,200
 MF 204,84,60,204
 s_waitcnt lgkmcnt(1)
 MF 208,88,56,208
 MF 212,88,60,212
 s_waitcnt lgkmcnt(0)
 MF 216,92,56,216
 MF 220,92,60,220
L_L_done:
 s_nop 7
 v_add_f32 v156, v144, v148
 v_cmp_nge_f32 vcc, 0x4e800000, v156
 s_nop 4
 s_cbranch_vccz Lvote_36
 v_mov_b32 v156, 132128
 v_mov_b32 v157, 1
 ds_write_b32 v156, v157
 s_waitcnt lgkmcnt(0)
Lvote_36:
 s_cmp_lt_u32 s48, 2
 s_cselect_b32 s61, 1, 0
 s_sub_u32 s74, s74, s61
 s_cmp_eq_u32 s74, 0
 s_cbranch_scc1 L_att_end
Ldr_37:
 s_barrier
 s_sub_u32 s74, s74, 1
 s_cmp_lg_u32 s74, 0
 s_cbranch_scc1 Ldr_37
 s_branch L_att_end
L_S_entry:
 s_cmp_eq_u32 s69, 0
 s_cbranch_scc1 L_S_tail0
 s_sub_u32 s63, s63, 1
 s_cbranch_scc1 L_S_loop
 .p2align 6
L_S_fast:
 s_waitcnt lgkmcnt(4)
 MF 112,64,16,128
 v_exp_f32 v156, v96
 MF 116,64,32,132
 RD 88,13,6144
 MF 112,68,20,112
 v_exp_f32 v157, v97
 MF 116,68,36,116
 RD 92,13,7168
 s_waitcnt lgkmcnt(4)
 MF 112,72,24,112
 v_exp_f32 v158, v98
 MF 116,72,40,116
 RD 64,13,16384
 v_cvt_pk_bf16_f32 v48, v156, v157
 MF 112,76,28,112
 v_exp_f32 v159, v99
 MF 116,76,44,116
 RD 68,13,17408
 s_waitcnt lgkmcnt(4)
 MF 120,80,16,136
 v_exp_f32 v156, v104
 MF 124,80,32,140
 RD 72,13,18432
 v_cvt_pk_bf16_f32 v49, v158, v159
 MF 120,84,20,120
 v_exp_f32 v157, v105
 MF 124,84,36,124
 RD 76,13,19456
 s_waitcnt lgkmcnt(4)
 MF 120,88,24,120
 v_exp_f32 v158, v106
 MF 124,88,40,124
 RD 80,13,20480
 v_cvt_pk_bf16_f32 v50, v156, v157
 MF 120,92,28,120
 v_exp_f32 v159, v107
 MF 124,92,44,124
 RD 84,13,21504
 s_waitcnt lgkmcnt(4)
 MF 160,64,56,160
 v_exp_f32 v156, v100
 MF 164,64,60,164
 RD 88,13,22528
 v_cvt_pk_bf16_f32 v51, v158, v159
 MF 168,68,56,168
 v_exp_f32 v157, v101
 MF 172,68,60,172
 RD 92,13,23552
 s_waitcnt lgkmcnt(4)
 MF 176,72,56,176
 v_exp_f32 v158, v102
 MF 180,72,60,180
 RD 64,13,8192
 v_cvt_pk_bf16_f32 v52, v156, v157
 MF 184,76,56,184
 v_exp_f32 v159, v103
 MF 188,76,60,188
 RD 68,13,9216
 MF 144,152,56,144
 s_waitcnt lgkmcnt(4)
 MF 192,80,56,192
 v_exp_f32 v156, v108
 MF 196,80,60,196
 RD 72,13,10240
 v_cvt_pk_bf16_f32 v53, v158, v159
 MF 200,84,56,200
 v_exp_f32 v157, v109
 MF 204,84,60,204
 RD 76,13,11264
 s_waitcnt lgkmcnt(4)
 MF 208,88,56,208
 v_exp_f32 v158, v110
 MF 212,88,60,212
 RD 80,13,12288
 v_cvt_pk_bf16_f32 v54, v156, v157
 MF 216,92,56,216
 v_exp_f32 v159, v111
 MF 220,92,60,220
 RD 84,13,13312
 v_cvt_pk_bf16_f32 v55, v158, v159
 MF 148,152,60,148
 s_waitcnt lgkmcnt(4)
 MF 96,64,16,128
 v_exp_f32 v156, v112
 MF 100,64,32,132
 RD 88,13,14336
 MF 96,68,20,96
 v_exp_f32 v157, v113
 MF 100,68,36,100
 RD 92,13,15360
 s_waitcnt lgkmcnt(4)
 MF 96,72,24,96
 v_exp_f32 v158, v114
 MF 100,72,40,100
 RD 64,13,24576
 v_cvt_pk_bf16_f32 v56, v156, v157
 MF 96,76,28,96
 v_exp_f32 v159, v115
 MF 100,76,44,100
 RD 68,13,25600
 s_waitcnt lgkmcnt(4)
 MF 104,80,16,136
 v_exp_f32 v156, v120
 MF 108,80,32,140
 RD 72,13,26624
 v_cvt_pk_bf16_f32 v57, v158, v159
 MF 104,84,20,104
 v_exp_f32 v157, v121
 MF 108,84,36,108
 RD 76,13,27648
 s_waitcnt lgkmcnt(4)
 MF 104,88,24,104
 v_exp_f32 v158, v122
 MF 108,88,40,108
 RD 80,13,28672
 v_cvt_pk_bf16_f32 v58, v156, v157
 MF 104,92,28,104
 v_exp_f32 v159, v123
 MF 108,92,44,108
 RD 84,13,29696
 s_waitcnt lgkmcnt(4)
 MF 160,64,48,160
 v_exp_f32 v156, v116
 MF 164,64,52,164
 RD 88,13,30720
 v_cvt_pk_bf16_f32 v59, v158, v159
 MF 168,68,48,168
 v_exp_f32 v157, v117
 MF 172,68,52,172
 RD 92,13,31744
 s_waitcnt lgkmcnt(4)
 MF 176,72,48,176
 v_exp_f32 v158, v118
 MF 180,72,52,180
 s_waitcnt vmcnt(8)
 s_barrier
 RD 64,13,32768
 v_cvt_pk_bf16_f32 v60, v156, v157
 s_add_u32 m0, s72, 0
 s_cmp_lt_u32 s70, s94
 s_cselect_b32 s96, s70, 0x10000000
 buffer_load_dwordx4 v1, s[44:47], s96 offen offset:0 sc1 lds
 MF 184,76,48,184
 v_exp_f32 v159, v119
 MF 188,76,52,188
 RD 68,13,33792
 MF 144,152,48,144
 buffer_load_dwordx4 v1, s[44:47], s96 offen offset:1024 sc1 lds
 buffer_load_dwordx4 v1, s[44:47], s96 offen offset:2048 sc1 lds
 s_waitcnt lgkmcnt(4)
 MF 192,80,48,192
 v_exp_f32 v156, v124
 MF 196,80,52,196
 RD 72,13,34816
 v_cvt_pk_bf16_f32 v61, v158, v159
 buffer_load_dwordx4 v1, s[44:47], s96 offen offset:3072 sc1 lds
 MF 200,84,48,200
 v_exp_f32 v157, v125
 MF 204,84,52,204
 RD 76,13,35840
 s_add_u32 m0, s72, 16384
 s_cmp_lt_u32 s71, s95
 s_cselect_b32 s96, s71, 0x10000000
 buffer_load_dwordx4 v1, s[44:47], s96 offen offset:0 sc1 lds
 buffer_load_dwordx4 v1, s[44:47], s96 offen offset:1024 sc1 lds
 s_waitcnt lgkmcnt(4)
 MF 208,88,48,208
 v_exp_f32 v158, v126
 MF 212,88,52,212
 RD 80,13,36864
 v_cvt_pk_bf16_f32 v62, v156, v157
 buffer_load_dwordx4 v1, s[44:47], s96 offen offset:2048 sc1 lds
 MF 216,92,48,216
 v_exp_f32 v159, v127
 MF 220,92,52,220
 RD 84,13,37888
 v_cvt_pk_bf16_f32 v63, v158, v159
 MF 148,152,52,148
 buffer_load_dwordx4 v1, s[44:47], s96 offen offset:3072 sc1 lds
 s_add_u32 s70, s70, 16384
 s_add_u32 s71, s71, 16384
 s_add_u32 s72, s72, 32768
 s_and_b32 s72, s72, 0x1ffff
 s_waitcnt lgkmcnt(4)
 MF 112,64,16,128
 v_exp_f32 v156, v96
 MF 116,64,32,132
 RD 88,13,38912
 MF 112,68,20,112
 v_exp_f32 v157, v97
 MF 116,68,36,116
 RD 92,13,39936
 s_waitcnt lgkmcnt(4)
 MF 112,72,24,112
 v_exp_f32 v158, v98
 MF 116,72,40,116
 RD 64,13,49152
 v_cvt_pk_bf16_f32 v48, v156, v157
 MF 112,76,28,112
 v_exp_f32 v159, v99
 MF 116,76,44,116
 RD 68,13,50176
 s_waitcnt lgkmcnt(4)
 MF 120,80,16,136
 v_exp_f32 v156, v104
 MF 124,80,32,140
 RD 72,13,51200
 v_cvt_pk_bf16_f32 v49, v158, v159
 MF 120,84,20,120
 v_exp_f32 v157, v105
 MF 124,84,36,124
 RD 76,13,52224
 s_waitcnt lgkmcnt(4)
 MF 120,88,24,120
 v_exp_f32 v158, v106
 MF 124,88,40,124
 RD 80,13,53248
 v_cvt_pk_bf16_f32 v50, v156, v157
 MF 120,92,28,120
 v_exp_f32 v159, v107
 MF 124,92,44,124
 RD 84,13,54272
 s_waitcnt lgkmcnt(4)
 MF 160,64,56,160
 v_exp_f32 v156, v100
 MF 164,64,60,164
 RD 88,13,55296
 v_cvt_pk_bf16_f32 v51, v158, v159
 MF 168,68,56,168
 v_exp_f32 v157, v101
 MF 172,68,60,172
 RD 92,13,56320
 s_waitcnt lgkmcnt(4)
 MF 176,72,56,176
 v_exp_f32 v158, v102
 MF 180,72,60,180
 RD 64,13,40960
 v_cvt_pk_bf16_f32 v52, v156, v157
 MF 184,76,56,184
 v_exp_f32 v159, v103
 MF 188,76,60,188
 RD 68,13,41984
 MF 144,152,56,144
 s_waitcnt lgkmcnt(4)
 MF 192,80,56,192
 v_exp_f32 v156, v108
 MF 196,80,60,196
 RD 72,13,43008
 v_cvt_pk_bf16_f32 v53, v158, v159
 MF 200,84,56,200
 v_exp_f32 v157, v109
 MF 204,84,60,204
 RD 76,13,44032
 s_waitcnt lgkmcnt(4)
 MF 208,88,56,208
 v_exp_f32 v158, v110
 MF 212,88,60,212
 RD 80,13,45056
 v_cvt_pk_bf16_f32 v54, v156, v157
 MF 216,92,56,216
 v_exp_f32 v159, v111
 MF 220,92,60,220
 RD 84,13,46080
 v_cvt_pk_bf16_f32 v55, v158, v159
 MF 148,152,60,148
 s_waitcnt lgkmcnt(4)
 MF 96,64,16,128
 v_exp_f32 v156, v112
 MF 100,64,32,132
 RD 88,13,47104
 MF 96,68,20,96
 v_exp_f32 v157, v113
 MF 100,68,36,100
 RD 92,13,48128
 s_waitcnt lgkmcnt(4)
 MF 96,72,24,96
 v_exp_f32 v158, v114
 MF 100,72,40,100
 RD 64,13,57344
 v_cvt_pk_bf16_f32 v56, v156, v157
 MF 96,76,28,96
 v_exp_f32 v159, v115
 MF 100,76,44,100
 RD 68,13,58368
 s_waitcnt lgkmcnt(4)
 MF 104,80,16,136
 v_exp_f32 v156, v120
 MF 108,80,32,140
 RD 72,13,59392
 v_cvt_pk_bf16_f32 v57, v158, v159
 MF 104,84,20,104
 v_exp_f32 v157, v121
 MF 108,84,36,108
 RD 76,13,60416
 s_waitcnt lgkmcnt(4)
 MF 104,88,24,104
 v_exp_f32 v158, v122
 MF 108,88,40,108
 RD 80,13,61440
 v_cvt_pk_bf16_f32 v58, v156, v157
 MF 104,92,28,104
 v_exp_f32 v159, v123
 MF 108,92,44,108
 RD 84,13,62464
 s_waitcnt lgkmcnt(4)
 MF 160,64,48,160
 v_exp_f32 v156, v116
 MF 164,64,52,164
 RD 88,13,63488
 v_cvt_pk_bf16_f32 v59, v158, v159
 MF 168,68,48,168
 v_exp_f32 v157, v117
 MF 172,68,52,172
 RD 92,13,64512
 v_xor_b32 v13, 0x10000, v13
 s_waitcnt lgkmcnt(4)
 MF 176,72,48,176
 v_exp_f32 v158, v118
 MF 180,72,52,180
 s_waitcnt vmcnt(8)
 s_barrier
 RD 64,13,0
 v_cvt_pk_bf16_f32 v60, v156, v157
 s_add_u32 m0, s72, 0
 s_cmp_lt_u32 s70, s94
 s_cselect_b32 s96, s70, 0x10000000
 buffer_load_dwordx4 v1, s[44:47], s96 offen offset:0 sc1 lds
 MF 184,76,48,184
 v_exp_f32 v159, v119
 MF 188,76,52,188
 RD 68,13,1024
 MF 144,152,48,144
 buffer_load_dwordx4 v1, s[44:47], s96 offen offset:1024 sc1 lds
 buffer_load_dwordx4 v1, s[44:47], s96 offen offset:2048 sc1 lds
 s_waitcnt lgkmcnt(4)
 MF 192,80,48,192
 v_exp_f32 v156, v124
 MF 196,80,52,196
 RD 72,13,2048
 v_cvt_pk_bf16_f32 v61, v158, v159
 buffer_load_dwordx4 v1, s[44:47], s96 offen offset:3072 sc1 lds
 MF 200,84,48,200
 v_exp_f32 v157, v125
 MF 204,84,52,204
 RD 76,13,3072
 s_add_u32 m0, s72, 16384
 s_cmp_lt_u32 s71, s95
 s_cselect_b32 s96, s71, 0x10000000
 buffer_load_dwordx4 v1, s[44:47], s96 offen offset:0 sc1 lds
 buffer_load_dwordx4 v1, s[44:47], s96 offen offset:1024 sc1 lds
 s_waitcnt lgkmcnt(4)
 MF 208,88,48,208
 v_exp_f32 v158, v126
 MF 212,88,52,212
 RD 80,13,4096
 v_cvt_pk_bf16_f32 v62, v156, v157
 buffer_load_dwordx4 v1, s[44:47], s96 offen offset:2048 sc1 lds
 MF 216,92,48,216
 v_exp_f32 v159, v127
 MF 220,92,52,220
 RD 84,13,5120
 v_cvt_pk_bf16_f32 v63, v158, v159
 MF 148,152,52,148
 buffer_load_dwordx4 v1, s[44:47], s96 offen offset:3072 sc1 lds
 s_add_u32 s70, s70, 16384
 s_add_u32 s71, s71, 16384
 s_add_u32 s72, s72, 32768
 s_and_b32 s72, s72, 0x1ffff
 s_sub_u32 s63, s63, 1
 s_cbranch_scc0 L_S_fast
L_S_loop:
 s_waitcnt lgkmcnt(4)
 MF 112,64,16,128
 v_exp_f32 v156, v96
 MF 116,64,32,132
 RD 88,13,6144
 MF 112,68,20,112
 v_exp_f32 v157, v97
 MF 116,68,36,116
 RD 92,13,7168
 s_waitcnt lgkmcnt(4)
 MF 112,72,24,112
 v_exp_f32 v158, v98
 MF 116,72,40,116
 RD 64,13,16384
 v_cvt_pk_bf16_f32 v48, v156, v157
 MF 112,76,28,112
 v_exp_f32 v159, v99
 MF 116,76,44,116
 RD 68,13,17408
 s_waitcnt lgkmcnt(4)
 MF 120,80,16,136
 v_exp_f32 v156, v104
 MF 124,80,32,140
 RD 72,13,18432
 v_cvt_pk_bf16_f32 v49, v158, v159
 MF 120,84,20,120
 v_exp_f32 v157, v105
 MF 124,84,36,124
 RD 76,13,19456
 s_waitcnt lgkmcnt(4)
 MF 120,88,24,120
 v_exp_f32 v158, v106
 MF 124,88,40,124
 RD 80,13,20480
 v_cvt_pk_bf16_f32 v50, v156, v157
 MF 120,92,28,120
 v_exp_f32 v159, v107
 MF 124,92,44,124
 RD 84,13,21504
 s_waitcnt lgkmcnt(4)
 MF 160,64,56,160
 v_exp_f32 v156, v100
 MF 164,64,60,164
 RD 88,13,22528
 v_cvt_pk_bf16_f32 v51, v158, v159
 MF 168,68,56,168
 v_exp_f32 v157, v101
 MF 172,68,60,172
 RD 92,13,23552
 s_waitcnt lgkmcnt(4)
 MF 176,72,56,176
 v_exp_f32 v158, v102
 MF 180,72,60,180
 RD 64,13,8192
 v_cvt_pk_bf16_f32 v52, v156, v157
 MF 184,76,56,184
 v_exp_f32 v159, v103
 MF 188,76,60,188
 RD 68,13,9216
 MF 144,152,56,144
 s_waitcnt lgkmcnt(4)
 MF 192,80,56,192
 v_exp_f32 v156, v108
 MF 196,80,60,196
 RD 72,13,10240
 v_cvt_pk_bf16_f32 v53, v158, v159
 MF 200,84,56,200
 v_exp_f32 v157, v109
 MF 204,84,60,204
 RD 76,13,11264
 s_waitcnt lgkmcnt(4)
 MF 208,88,56,208
 v_exp_f32 v158, v110
 MF 212,88,60,212
 RD 80,13,12288
 v_cvt_pk_bf16_f32 v54, v156, v157
 MF 216,92,56,216
 v_exp_f32 v159, v111
 MF 220,92,60,220
 RD 84,13,13312
 v_cvt_pk_bf16_f32 v55, v158, v159
 MF 148,152,60,148
 s_sub_u32 s67, s67, 1
 s_cbranch_scc1 L_S_h0
L_S_c0:
 s_waitcnt lgkmcnt(4)
 MF 96,64,16,128
 v_exp_f32 v156, v112
 MF 100,64,32,132
 RD 88,13,14336
 MF 96,68,20,96
 v_exp_f32 v157, v113
 MF 100,68,36,100
 RD 92,13,15360
 s_waitcnt lgkmcnt(4)
 MF 96,72,24,96
 v_exp_f32 v158, v114
 MF 100,72,40,100
 RD 64,13,24576
 v_cvt_pk_bf16_f32 v56, v156, v157
 MF 96,76,28,96
 v_exp_f32 v159, v115
 MF 100,76,44,100
 RD 68,13,25600
 s_waitcnt lgkmcnt(4)
 MF 104,80,16,136
 v_exp_f32 v156, v120
 MF 108,80,32,140
 RD 72,13,26624
 v_cvt_pk_bf16_f32 v57, v158, v159
 MF 104,84,20,104
 v_exp_f32 v157, v121
 MF 108,84,36,108
 RD 76,13,27648
 s_waitcnt lgkmcnt(4)
 MF 104,88,24,104
 v_exp_f32 v158, v122
 MF 108,88,40,108
 RD 80,13,28672
 v_cvt_pk_bf16_f32 v58, v156, v157
 MF 104,92,28,104
 v_exp_f32 v159, v123
 MF 108,92,44,108
 RD 84,13,29696
 s_waitcnt lgkmcnt(4)
 MF 160,64,48,160
 v_exp_f32 v156, v116
 MF 164,64,52,164
 RD 88,13,30720
 v_cvt_pk_bf16_f32 v59, v158, v159
 MF 168,68,48,168
 v_exp_f32 v157, v117
 MF 172,68,52,172
 RD 92,13,31744
 s_waitcnt lgkmcnt(4)
 MF 176,72,48,176
 v_exp_f32 v158, v118
 MF 180,72,52,180
 v_add_u32 v13, 0x8000, v13
 v_and_b32 v13, 0x1ffff, v13
 s_waitcnt vmcnt(8)
 s_barrier
 RD 64,13,0
 v_cvt_pk_bf16_f32 v60, v156, v157
 s_add_u32 m0, s72, 0
 s_cmp_lt_u32 s70, s94
 s_cselect_b32 s96, s70, 0x10000000
 buffer_load_dwordx4 v1, s[44:47], s96 offen offset:0 sc1 lds
 MF 184,76,48,184
 v_exp_f32 v159, v119
 MF 188,76,52,188
 RD 68,13,1024
 MF 144,152,48,144
 buffer_load_dwordx4 v1, s[44:47], s96 offen offset:1024 sc1 lds
 buffer_load_dwordx4 v1, s[44:47], s96 offen offset:2048 sc1 lds
 s_waitcnt lgkmcnt(4)
 MF 192,80,48,192
 v_exp_f32 v156, v124
 MF 196,80,52,196
 RD 72,13,2048
 v_cvt_pk_bf16_f32 v61, v158, v159
 buffer_load_dwordx4 v1, s[44:47], s96 offen offset:3072 sc1 lds
 MF 200,84,48,200
 v_exp_f32 v157, v125
 MF 204,84,52,204
 RD 76,13,3072
 s_add_u32 m0, s72, 16384
 s_cmp_lt_u32 s71, s95
 s_cselect_b32 s96, s71, 0x10000000
 buffer_load_dwordx4 v1, s[44:47], s96 offen offset:0 sc1 lds
 buffer_load_dwordx4 v1, s[44:47], s96 offen offset:1024 sc1 lds
 s_waitcnt lgkmcnt(4)
 MF 208,88,48,208
 v_exp_f32 v158, v126
 MF 212,88,52,212
 RD 80,13,4096
 v_cvt_pk_bf16_f32 v62, v156, v157
 buffer_load_dwordx4 v1, s[44:47], s96 offen offset:2048 sc1 lds
 MF 216,92,48,216
 v_exp_f32 v159, v127
 MF 220,92,52,220
 RD 84,13,5120
 v_cvt_pk_bf16_f32 v63, v158, v159
 MF 148,152,52,148
 buffer_load_dwordx4 v1, s[44:47], s96 offen offset:3072 sc1 lds
 s_add_u32 s70, s70, 16384
 s_add_u32 s71, s71, 16384
 s_add_u32 s72, s72, 32768
 s_and_b32 s72, s72, 0x1ffff
 s_sub_u32 s67, s67, 1
 s_cbranch_scc0 L_S_loop
L_S_h1:
 s_cmp_eq_u32 s73, 0
 s_cbranch_scc1 Lnsafe_38
 s_nop 7
 v_max3_f32 v156, v96, v97, v98
 v_max3_f32 v156, v156, v99, v104
 v_max3_f32 v156, v156, v105, v106
 v_max_f32 v156, v156, v107
 v_mov_b32 v157, v156
 s_nop 1
 v_permlane16_swap_b32 v156, v157
 v_max_f32 v156, v156, v157
 v_mov_b32 v157, v156
 s_nop 1
 v_permlane32_swap_b32 v156, v157
 v_max_f32 v156, v156, v157
 v_max_f32 v156, 0, v156
 v_exp_f32 v158, -v156
 v_sub_f32 v96, v96, v156
 v_sub_f32 v128, v128, v156
 v_sub_f32 v97, v97, v156
 v_sub_f32 v129, v129, v156
 v_sub_f32 v98, v98, v156
 v_sub_f32 v130, v130, v156
 v_sub_f32 v99, v99, v156
 v_sub_f32 v131, v131, v156
 v_sub_f32 v104, v104, v156
 v_sub_f32 v136, v136, v156
 v_sub_f32 v105, v105, v156
 v_sub_f32 v137, v137, v156
 v_sub_f32 v106, v106, v156
 v_sub_f32 v138, v138, v156
 v_sub_f32 v107, v107, v156
 v_sub_f32 v139, v139, v156
 v_mul_f32 v160, v160, v158
 v_mul_f32 v161, v161, v158
 v_mul_f32 v162, v162, v158
 v_mul_f32 v163, v163, v158
 v_mul_f32 v168, v168, v158
 v_mul_f32 v169, v169, v158
 v_mul_f32 v170, v170, v158
 v_mul_f32 v171, v171, v158
 v_mul_f32 v176, v176, v158
 v_mul_f32 v177, v177, v158
 v_mul_f32 v178, v178, v158
 v_mul_f32 v179, v179, v158
 v_mul_f32 v184, v184, v158
 v_mul_f32 v185, v185, v158
 v_mul_f32 v186, v186, v158
 v_mul_f32 v187, v187, v158
 v_mul_f32 v192, v192, v158
 v_mul_f32 v193, v193, v158
 v_mul_f32 v194, v194, v158
 v_mul_f32 v195, v195, v158
 v_mul_f32 v200, v200, v158
 v_mul_f32 v201, v201, v158
 v_mul_f32 v202, v202, v158
 v_mul_f32 v203, v203, v158
 v_mul_f32 v208, v208, v158
 v_mul_f32 v209, v209, v158
 v_mul_f32 v210, v210, v158
 v_mul_f32 v211, v211, v158
 v_mul_f32 v216, v216, v158
 v_mul_f32 v217, v217, v158
 v_mul_f32 v218, v218, v158
 v_mul_f32 v219, v219, v158
 v_mul_f32 v144, v144, v158
 v_lshlrev_b32 v159, 16, v56
 v_and_b32 v157, 0xffff0000, v56
 v_mul_f32 v159, v159, v158
 v_mul_f32 v157, v157, v158
 v_cvt_pk_bf16_f32 v56, v159, v157
 v_mul_f32 v145, v145, v158
 v_lshlrev_b32 v159, 16, v57
 v_and_b32 v157, 0xffff0000, v57
 v_mul_f32 v159, v159, v158
 v_mul_f32 v157, v157, v158
 v_cvt_pk_bf16_f32 v57, v159, v157
 v_mul_f32 v146, v146, v158
 v_lshlrev_b32 v159, 16, v58
 v_and_b32 v157, 0xffff0000, v58
 v_mul_f32 v159, v159, v158
 v_mul_f32 v157, v157, v158
 v_cvt_pk_bf16_f32 v58, v159, v157
 v_mul_f32 v147, v147, v158
 v_lshlrev_b32 v159, 16, v59
 v_and_b32 v157, 0xffff0000, v59
 v_mul_f32 v159, v159, v158
 v_mul_f32 v157, v157, v158
 v_cvt_pk_bf16_f32 v59, v159, v157
 v_max3_f32 v156, v100, v101, v102
 v_max3_f32 v156, v156, v103, v108
 v_max3_f32 v156, v156, v109, v110
 v_max_f32 v156, v156, v111
 v_mov_b32 v157, v156
 s_nop 1
 v_permlane16_swap_b32 v156, v157
 v_max_f32 v156, v156, v157
 v_mov_b32 v157, v156
 s_nop 1
 v_permlane32_swap_b32 v156, v157
 v_max_f32 v156, v156, v157
 v_max_f32 v156, 0, v156
 v_exp_f32 v158, -v156
 v_sub_f32 v100, v100, v156
 v_sub_f32 v132, v132, v156
 v_sub_f32 v101, v101, v156
 v_sub_f32 v133, v133, v156
 v_sub_f32 v102, v102, v156
 v_sub_f32 v134, v134, v156
 v_sub_f32 v103, v103, v156
 v_sub_f32 v135, v135, v156
 v_sub_f32 v108, v108, v156
 v_sub_f32 v140, v140, v156
 v_sub_f32 v109, v109, v156
 v_sub_f32 v141, v141, v156
 v_sub_f32 v110, v110, v156
 v_sub_f32 v142, v142, v156
 v_sub_f32 v111, v111, v156
 v_sub_f32 v143, v143, v156
 v_mul_f32 v164, v164, v158
 v_mul_f32 v165, v165, v158
 v_mul_f32 v166, v166, v158
 v_mul_f32 v167, v167, v158
 v_mul_f32 v172, v172, v158
 v_mul_f32 v173, v173, v158
 v_mul_f32 v174, v174, v158
 v_mul_f32 v175, v175, v158
 v_mul_f32 v180, v180, v158
 v_mul_f32 v181, v181, v158
 v_mul_f32 v182, v182, v158
 v_mul_f32 v183, v183, v158
 v_mul_f32 v188, v188, v158
 v_mul_f32 v189, v189, v158
 v_mul_f32 v190, v190, v158
 v_mul_f32 v191, v191, v158
 v_mul_f32 v196, v196, v158
 v_mul_f32 v197, v197, v158
 v_mul_f32 v198, v198, v158
 v_mul_f32 v199, v199, v158
 v_mul_f32 v204, v204, v158
 v_mul_f32 v205, v205, v158
 v_mul_f32 v206, v206, v158
 v_mul_f32 v207, v207, v158
 v_mul_f32 v212, v212, v158
 v_mul_f32 v213, v213, v158
 v_mul_f32 v214, v214, v158
 v_mul_f32 v215, v215, v158
 v_mul_f32 v220, v220, v158
 v_mul_f32 v221, v221, v158
 v_mul_f32 v222, v222, v158
 v_mul_f32 v223, v223, v158
 v_mul_f32 v148, v148, v158
 v_lshlrev_b32 v159, 16, v60
 v_and_b32 v157, 0xffff0000, v60
 v_mul_f32 v159, v159, v158
 v_mul_f32 v157, v157, v158
 v_cvt_pk_bf16_f32 v60, v159, v157
 v_mul_f32 v149, v149, v158
 v_lshlrev_b32 v159, 16, v61
 v_and_b32 v157, 0xffff0000, v61
 v_mul_f32 v159, v159, v158
 v_mul_f32 v157, v157, v158
 v_cvt_pk_bf16_f32 v61, v159, v157
 v_mul_f32 v150, v150, v158
 v_lshlrev_b32 v159, 16, v62
 v_and_b32 v157, 0xffff0000, v62
 v_mul_f32 v159, v159, v158
 v_mul_f32 v157, v157, v158
 v_cvt_pk_bf16_f32 v62, v159, v157
 v_mul_f32 v151, v151, v158
 v_lshlrev_b32 v159, 16, v63
 v_and_b32 v157, 0xffff0000, v63
 v_mul_f32 v159, v159, v158
 v_mul_f32 v157, v157, v158
 v_cvt_pk_bf16_f32 v63, v159, v157
 s_nop 1
Lnsafe_38:
 s_cmp_eq_u32 s68, 0
 s_cbranch_scc1 L_S_tail0
 s_cmp_lg_u32 s68, 1
 s_cbranch_scc1 Lnmask_39
 v_cmp_le_i32 vcc, 0, v11
 v_mov_b32 v136, v9
 s_nop 0
 v_cndmask_b32 v128, v9, v128, vcc
 v_cndmask_b32 v140, v9, v140, vcc
 v_cmp_le_i32 vcc, 1, v11
 v_mov_b32 v137, v9
 s_nop 0
 v_cndmask_b32 v129, v9, v129, vcc
 v_cndmask_b32 v141, v9, v141, vcc
 v_cmp_le_i32 vcc, 2, v11
 v_mov_b32 v138, v9
 s_nop 0
 v_cndmask_b32 v130, v9, v130, vcc
 v_cndmask_b32 v142, v9, v142, vcc
 v_cmp_le_i32 vcc, 3, v11
 v_mov_b32 v139, v9
 s_nop 0
 v_cndmask_b32 v131, v9, v131, vcc
 v_cndmask_b32 v143, v9, v143, vcc
 s_nop 1
Lnmask_39:
 s_sub_u32 s68, s68, 1
 s_mov_b32 s67, 0
 s_branch L_S_loop
L_S_h0:
 s_cmp_eq_u32 s73, 0
 s_cbranch_scc1 Lnsafe_40
 s_nop 7
 v_max3_f32 v156, v112, v113, v114
 v_max3_f32 v156, v156, v115, v120
 v_max3_f32 v156, v156, v121, v122
 v_max_f32 v156, v156, v123
 v_mov_b32 v157, v156
 s_nop 1
 v_permlane16_swap_b32 v156, v157
 v_max_f32 v156, v156, v157
 v_mov_b32 v157, v156
 s_nop 1
 v_permlane32_swap_b32 v156, v157
 v_max_f32 v156, v156, v157
 v_max_f32 v156, 0, v156
 v_exp_f32 v158, -v156
 v_sub_f32 v112, v112, v156
 v_sub_f32 v128, v128, v156
 v_sub_f32 v113, v113, v156
 v_sub_f32 v129, v129, v156
 v_sub_f32 v114, v114, v156
 v_sub_f32 v130, v130, v156
 v_sub_f32 v115, v115, v156
 v_sub_f32 v131, v131, v156
 v_sub_f32 v120, v120, v156
 v_sub_f32 v136, v136, v156
 v_sub_f32 v121, v121, v156
 v_sub_f32 v137, v137, v156
 v_sub_f32 v122, v122, v156
 v_sub_f32 v138, v138, v156
 v_sub_f32 v123, v123, v156
 v_sub_f32 v139, v139, v156
 v_mul_f32 v160, v160, v158
 v_mul_f32 v161, v161, v158
 v_mul_f32 v162, v162, v158
 v_mul_f32 v163, v163, v158
 v_mul_f32 v168, v168, v158
 v_mul_f32 v169, v169, v158
 v_mul_f32 v170, v170, v158
 v_mul_f32 v171, v171, v158
 v_mul_f32 v176, v176, v158
 v_mul_f32 v177, v177, v158
 v_mul_f32 v178, v178, v158
 v_mul_f32 v179, v179, v158
 v_mul_f32 v184, v184, v158
 v_mul_f32 v185, v185, v158
 v_mul_f32 v186, v186, v158
 v_mul_f32 v187, v187, v158
 v_mul_f32 v192, v192, v158
 v_mul_f32 v193, v193, v158
 v_mul_f32 v194, v194, v158
 v_mul_f32 v195, v195, v158
 v_mul_f32 v200, v200, v158
 v_mul_f32 v201, v201, v158
 v_mul_f32 v202, v202, v158
 v_mul_f32 v203, v203, v158
 v_mul_f32 v208, v208, v158
 v_mul_f32 v209, v209, v158
 v_mul_f32 v210, v210, v158
 v_mul_f32 v211, v211, v158
 v_mul_f32 v216, v216, v158
 v_mul_f32 v217, v217, v158
 v_mul_f32 v218, v218, v158
 v_mul_f32 v219, v219, v158
 v_mul_f32 v144, v144, v158
 v_lshlrev_b32 v159, 16, v48
 v_and_b32 v157, 0xffff0000, v48
 v_mul_f32 v159, v159, v158
 v_mul_f32 v157, v157, v158
 v_cvt_pk_bf16_f32 v48, v159, v157
 v_mul_f32 v145, v145, v158
 v_lshlrev_b32 v159, 16, v49
 v_and_b32 v157, 0xffff0000, v49
 v_mul_f32 v159, v159, v158
 v_mul_f32 v157, v157, v158
 v_cvt_pk_bf16_f32 v49, v159, v157
 v_mul_f32 v146, v146, v158
 v_lshlrev_b32 v159, 16, v50
 v_and_b32 v157, 0xffff0000, v50
 v_mul_f32 v159, v159, v158
 v_mul_f32 v157, v157, v158
 v_cvt_pk_bf16_f32 v50, v159, v157
 v_mul_f32 v147, v147, v158
 v_lshlrev_b32 v159, 16, v51
 v_and_b32 v157, 0xffff0000, v51
 v_mul_f32 v159, v159, v158
 v_mul_f32 v157, v157, v158
 v_cvt_pk_bf16_f32 v51, v159, v157
 v_max3_f32 v156, v116, v117, v118
 v_max3_f32 v156, v156, v119, v124
 v_max3_f32 v156, v156, v125, v126
 v_max_f32 v156, v156, v127
 v_mov_b32 v157, v156
 s_nop 1
 v_permlane16_swap_b32 v156, v157
 v_max_f32 v156, v156, v157
 v_mov_b32 v157, v156
 s_nop 1
 v_permlane32_swap_b32 v156, v157
 v_max_f32 v156, v156, v157
 v_max_f32 v156, 0, v156
 v_exp_f32 v158, -v156
 v_sub_f32 v116, v116, v156
 v_sub_f32 v132, v132, v156
 v_sub_f32 v117, v117, v156
 v_sub_f32 v133, v133, v156
 v_sub_f32 v118, v118, v156
 v_sub_f32 v134, v134, v156
 v_sub_f32 v119, v119, v156
 v_sub_f32 v135, v135, v156
 v_sub_f32 v124, v124, v156
 v_sub_f32 v140, v140, v156
 v_sub_f32 v125, v125, v156
 v_sub_f32 v141, v141, v156
 v_sub_f32 v126, v126, v156
 v_sub_f32 v142, v142, v156
 v_sub_f32 v127, v127, v156
 v_sub_f32 v143, v143, v156
 v_mul_f32 v164, v164, v158
 v_mul_f32 v165, v165, v158
 v_mul_f32 v166, v166, v158
 v_mul_f32 v167, v167, v158
 v_mul_f32 v172, v172, v158
 v_mul_f32 v173, v173, v158
 v_mul_f32 v174, v174, v158
 v_mul_f32 v175, v175, v158
 v_mul_f32 v180, v180, v158
 v_mul_f32 v181, v181, v158
 v_mul_f32 v182, v182, v158
 v_mul_f32 v183, v183, v158
 v_mul_f32 v188, v188, v158
 v_mul_f32 v189, v189, v158
 v_mul_f32 v190, v190, v158
 v_mul_f32 v191, v191, v158
 v_mul_f32 v196, v196, v158
 v_mul_f32 v197, v197, v158
 v_mul_f32 v198, v198, v158
 v_mul_f32 v199, v199, v158
 v_mul_f32 v204, v204, v158
 v_mul_f32 v205, v205, v158
 v_mul_f32 v206, v206, v158
 v_mul_f32 v207, v207, v158
 v_mul_f32 v212, v212, v158
 v_mul_f32 v213, v213, v158
 v_mul_f32 v214, v214, v158
 v_mul_f32 v215, v215, v158
 v_mul_f32 v220, v220, v158
 v_mul_f32 v221, v221, v158
 v_mul_f32 v222, v222, v158
 v_mul_f32 v223, v223, v158
 v_mul_f32 v148, v148, v158
 v_lshlrev_b32 v159, 16, v52
 v_and_b32 v157, 0xffff0000, v52
 v_mul_f32 v159, v159, v158
 v_mul_f32 v157, v157, v158
 v_cvt_pk_bf16_f32 v52, v159, v157
 v_mul_f32 v149, v149, v158
 v_lshlrev_b32 v159, 16, v53
 v_and_b32 v157, 0xffff0000, v53
 v_mul_f32 v159, v159, v158
 v_mul_f32 v157, v157, v158
 v_cvt_pk_bf16_f32 v53, v159, v157
 v_mul_f32 v150, v150, v158
 v_lshlrev_b32 v159, 16, v54
 v_and_b32 v157, 0xffff0000, v54
 v_mul_f32 v159, v159, v158
 v_mul_f32 v157, v157, v158
 v_cvt_pk_bf16_f32 v54, v159, v157
 v_mul_f32 v151, v151, v158
 v_lshlrev_b32 v159, 16, v55
 v_and_b32 v157, 0xffff0000, v55
 v_mul_f32 v159, v159, v158
 v_mul_f32 v157, v157, v158
 v_cvt_pk_bf16_f32 v55, v159, v157
 s_nop 1
Lnsafe_40:
 s_cmp_eq_u32 s68, 0
 s_cbranch_scc1 L_S_tail1
 s_cmp_lg_u32 s68, 1
 s_cbranch_scc1 Lnmask_41
 v_cmp_le_i32 vcc, 0, v11
 v_mov_b32 v136, v9
 s_nop 0
 v_cndmask_b32 v128, v9, v128, vcc
 v_cndmask_b32 v140, v9, v140, vcc
 v_cmp_le_i32 vcc, 1, v11
 v_mov_b32 v137, v9
 s_nop 0
 v_cndmask_b32 v129, v9, v129, vcc
 v_cndmask_b32 v141, v9, v141, vcc
 v_cmp_le_i32 vcc, 2, v11
 v_mov_b32 v138, v9
 s_nop 0
 v_cndmask_b32 v130, v9, v130, vcc
 v_cndmask_b32 v142, v9, v142, vcc
 v_cmp_le_i32 vcc, 3, v11
 v_mov_b32 v139, v9
 s_nop 0
 v_cndmask_b32 v131, v9, v131, vcc
 v_cndmask_b32 v143, v9, v143, vcc
 s_nop 1
Lnmask_41:
 s_sub_u32 s68, s68, 1
 s_mov_b32 s67, 0
 s_branch L_S_c0
L_S_tail0:
 s_waitcnt lgkmcnt(0)
 RD 64,13,16384
 RD 68,13,17408
 RD 72,13,18432
 RD 76,13,19456
 RD 80,13,20480
 RD 84,13,21504
 RD 88,13,22528
 RD 92,13,23552
 v_exp_f32 v156, v96
 v_exp_f32 v157, v97
 v_exp_f32 v158, v98
 v_cvt_pk_bf16_f32 v48, v156, v157
 v_exp_f32 v159, v99
 v_exp_f32 v156, v104
 v_cvt_pk_bf16_f32 v49, v158, v159
 v_exp_f32 v157, v105
 v_exp_f32 v158, v106
 v_cvt_pk_bf16_f32 v50, v156, v157
 v_exp_f32 v159, v107
 v_exp_f32 v156, v100
 v_cvt_pk_bf16_f32 v51, v158, v159
 v_exp_f32 v157, v101
 v_exp_f32 v158, v102
 v_cvt_pk_bf16_f32 v52, v156, v157
 v_exp_f32 v159, v103
 v_exp_f32 v156, v108
 v_cvt_pk_bf16_f32 v53, v158, v159
 v_exp_f32 v157, v109
 v_exp_f32 v158, v110
 v_cvt_pk_bf16_f32 v54, v156, v157
 v_exp_f32 v159, v111
 MF 144,152,56,144
 v_cvt_pk_bf16_f32 v55, v158, v159
 MF 148,152,60,148
 s_waitcnt lgkmcnt(7)
 MF 160,64,56,160
 MF 164,64,60,164
 RD 64,13,24576
 s_waitcnt lgkmcnt(7)
 MF 168,68,56,168
 MF 172,68,60,172
 RD 68,13,25600
 s_waitcnt lgkmcnt(7)
 MF 176,72,56,176
 MF 180,72,60,180
 RD 72,13,26624
 s_waitcnt lgkmcnt(7)
 MF 184,76,56,184
 MF 188,76,60,188
 RD 76,13,27648
 s_waitcnt lgkmcnt(7)
 MF 192,80,56,192
 MF 196,80,60,196
 RD 80,13,28672
 s_waitcnt lgkmcnt(7)
 MF 200,84,56,200
 MF 204,84,60,204
 RD 84,13,29696
 s_waitcnt lgkmcnt(7)
 MF 208,88,56,208
 MF 212,88,60,212
 RD 88,13,30720
 s_waitcnt lgkmcnt(7)
 MF 216,92,56,216
 MF 220,92,60,220
 RD 92,13,31744
 MF 144,152,48,144
 MF 148,152,52,148
 s_waitcnt lgkmcnt(7)
 MF 160,64,48,160
 MF 164,64,52,164
 s_waitcnt lgkmcnt(6)
 MF 168,68,48,168
 MF 172,68,52,172
 s_waitcnt lgkmcnt(5)
 MF 176,72,48,176
 MF 180,72,52,180
 s_waitcnt lgkmcnt(4)
 MF 184,76,48,184
 MF 188,76,52,188
 s_waitcnt lgkmcnt(3)
 MF 192,80,48,192
 MF 196,80,52,196
 s_waitcnt lgkmcnt(2)
 MF 200,84,48,200
 MF 204,84,52,204
 s_waitcnt lgkmcnt(1)
 MF 208,88,48,208
 MF 212,88,52,212
 s_waitcnt lgkmcnt(0)
 MF 216,92,48,216
 MF 220,92,52,220
 s_branch L_S_done
L_S_tail1:
 s_waitcnt lgkmcnt(0)
 RD 64,13,24576
 RD 68,13,25600
 RD 72,13,26624
 RD 76,13,27648
 RD 80,13,28672
 RD 84,13,29696
 RD 88,13,30720
 RD 92,13,31744
 v_exp_f32 v156, v112
 v_exp_f32 v157, v113
 v_exp_f32 v158, v114
 v_cvt_pk_bf16_f32 v56, v156, v157
 v_exp_f32 v159, v115
 v_exp_f32 v156, v120
 v_cvt_pk_bf16_f32 v57, v158, v159
 v_exp_f32 v157, v121
 v_exp_f32 v158, v122
 v_cvt_pk_bf16_f32 v58, v156, v157
 v_exp_f32 v159, v123
 v_exp_f32 v156, v116
 v_cvt_pk_bf16_f32 v59, v158, v159
 v_exp_f32 v157, v117
 v_exp_f32 v158, v118
 v_cvt_pk_bf16_f32 v60, v156, v157
 v_exp_f32 v159, v119
 v_exp_f32 v156, v124
 v_cvt_pk_bf16_f32 v61, v158, v159
 v_exp_f32 v157, v125
 v_exp_f32 v158, v126
 v_cvt_pk_bf16_f32 v62, v156, v157
 v_exp_f32 v159, v127
 MF 144,152,48,144
 v_cvt_pk_bf16_f32 v63, v158, v159
 MF 148,152,52,148
 s_waitcnt lgkmcnt(0)
 v_add_u32 v13, 0x8000, v13
 v_and_b32 v13, 0x1ffff, v13
 s_waitcnt vmcnt(8)
 s_barrier
 MF 160,64,48,160
 MF 164,64,52,164
 RD 64,13,16384
 s_add_u32 m0, s72, 0
 s_cmp_lt_u32 s70, s94
 s_cselect_b32 s96, s70, 0x10000000
 buffer_load_dwordx4 v1, s[44:47], s96 offen offset:0 sc1 lds
 MF 168,68,48,168
 MF 172,68,52,172
 RD 68,13,17408
 buffer_load_dwordx4 v1, s[44:47], s96 offen offset:1024 sc1 lds
 MF 176,72,48,176
 MF 180,72,52,180
 RD 72,13,18432
 buffer_load_dwordx4 v1, s[44:47], s96 offen offset:2048 sc1 lds
 MF 184,76,48,184
 MF 188,76,52,188
 RD 76,13,19456
 buffer_load_dwordx4 v1, s[44:47], s96 offen offset:3072 sc1 lds
 MF 192,80,48,192
 MF 196,80,52,196
 RD 80,13,20480
 s_add_u32 m0, s72, 16384
 s_cmp_lt_u32 s71, s95
 s_cselect_b32 s96, s71, 0x10000000
 buffer_load_dwordx4 v1, s[44:47], s96 offen offset:0 sc1 lds
 MF 200,84,48,200
 MF 204,84,52,204
 RD 84,13,21504
 buffer_load_dwordx4 v1, s[44:47], s96 offen offset:1024 sc1 lds
 MF 208,88,48,208
 MF 212,88,52,212
 RD 88,13,22528
 buffer_load_dwordx4 v1, s[44:47], s96 offen offset:2048 sc1 lds
 MF 216,92,48,216
 MF 220,92,52,220
 RD 92,13,23552
 buffer_load_dwordx4 v1, s[44:47], s96 offen offset:3072 sc1 lds
 s_add_u32 s70, s70, 16384
 s_add_u32 s71, s71, 16384
 s_add_u32 s72, s72, 32768
 s_and_b32 s72, s72, 0x1ffff
 MF 144,152,56,144
 MF 148,152,60,148
 s_waitcnt lgkmcnt(7)
 MF 160,64,56,160
 MF 164,64,60,164
 s_waitcnt lgkmcnt(6)
 MF 168,68,56,168
 MF 172,68,60,172
 s_waitcnt lgkmcnt(5)
 MF 176,72,56,176
 MF 180,72,60,180
 s_waitcnt lgkmcnt(4)
 MF 184,76,56,184
 MF 188,76,60,188
 s_waitcnt lgkmcnt(3)
 MF 192,80,56,192
 MF 196,80,60,196
 s_waitcnt lgkmcnt(2)
 MF 200,84,56,200
 MF 204,84,60,204
 s_waitcnt lgkmcnt(1)
 MF 208,88,56,208
 MF 212,88,60,212
 s_waitcnt lgkmcnt(0)
 MF 216,92,56,216
 MF 220,92,60,220
L_S_done:
 s_nop 7
 v_add_f32 v156, v144, v148
 v_cmp_nge_f32 vcc, 0x4e800000, v156
 s_nop 4
 s_cbranch_vccz Lvote_42
 v_mov_b32 v156, 132128
 v_mov_b32 v157, 1
 ds_write_b32 v156, v157
 s_waitcnt lgkmcnt(0)
Lvote_42:
 s_setprio 0
 s_waitcnt vmcnt(8)
 s_barrier
 s_cmp_le_u32 s74, 2
 s_cbranch_scc1 Lnd_43
 s_add_u32 m0, s72, 0
 s_cmp_lt_u32 s70, s94
 s_cselect_b32 s96, s70, 0x10000000
 buffer_load_dwordx4 v1, s[44:47], s96 offen offset:0 sc1 lds
 buffer_load_dwordx4 v1, s[44:47], s96 offen offset:1024 sc1 lds
 buffer_load_dwordx4 v1, s[44:47], s96 offen offset:2048 sc1 lds
 buffer_load_dwordx4 v1, s[44:47], s96 offen offset:3072 sc1 lds
 s_add_u32 m0, s72, 16384
 s_cmp_lt_u32 s71, s95
 s_cselect_b32 s96, s71, 0x10000000
 buffer_load_dwordx4 v1, s[44:47], s96 offen offset:0 sc1 lds
 buffer_load_dwordx4 v1, s[44:47], s96 offen offset:1024 sc1 lds
 buffer_load_dwordx4 v1, s[44:47], s96 offen offset:2048 sc1 lds
 buffer_load_dwordx4 v1, s[44:47], s96 offen offset:3072 sc1 lds
 s_add_u32 s70, s70, 16384
 s_add_u32 s71, s71, 16384
 s_add_u32 s72, s72, 32768
 s_and_b32 s72, s72, 0x1ffff
Lnd_43:
 s_sub_u32 s74, s74, 1
 v_rcp_f32 v156, v144
 v_rcp_f32 v158, v148
 s_add_u32 s62, s75, 4096
 v_pk_mul_f32 v[160:161], v[160:161], v[156:157] op_sel_hi:[1,0]
 v_pk_mul_f32 v[162:163], v[162:163], v[156:157] op_sel_hi:[1,0]
 v_pk_mul_f32 v[168:169], v[168:169], v[156:157] op_sel_hi:[1,0]
 v_pk_mul_f32 v[170:171], v[170:171], v[156:157] op_sel_hi:[1,0]
 v_cvt_pk_bf16_f32 v224, v160, v161
 v_cvt_pk_bf16_f32 v225, v162, v163
 v_cvt_pk_bf16_f32 v226, v168, v169
 v_cvt_pk_bf16_f32 v227, v170, v171
 buffer_store_dwordx4 v[224:227], v1, s[44:47], s75 offen offset:0 sc1
 v_pk_mul_f32 v[164:165], v[164:165], v[158:159] op_sel_hi:[1,0]
 v_pk_mul_f32 v[166:167], v[166:167], v[158:159] op_sel_hi:[1,0]
 v_pk_mul_f32 v[172:173], v[172:173], v[158:159] op_sel_hi:[1,0]
 v_pk_mul_f32 v[174:175], v[174:175], v[158:159] op_sel_hi:[1,0]
 v_cvt_pk_bf16_f32 v228, v164, v165
 v_cvt_pk_bf16_f32 v229, v166, v167
 v_cvt_pk_bf16_f32 v230, v172, v173
 v_cvt_pk_bf16_f32 v231, v174, v175
 buffer_store_dwordx4 v[228:231], v1, s[44:47], s75 offen offset:1024 sc1
 v_pk_mul_f32 v[176:177], v[176:177], v[156:157] op_sel_hi:[1,0]
 v_pk_mul_f32 v[178:179], v[178:179], v[156:157] op_sel_hi:[1,0]
 v_pk_mul_f32 v[184:185], v[184:185], v[156:157] op_sel_hi:[1,0]
 v_pk_mul_f32 v[186:187], v[186:187], v[156:157] op_sel_hi:[1,0]
 v_cvt_pk_bf16_f32 v232, v176, v177
 v_cvt_pk_bf16_f32 v233, v178, v179
 v_cvt_pk_bf16_f32 v234, v184, v185
 v_cvt_pk_bf16_f32 v235, v186, v187
 buffer_store_dwordx4 v[232:235], v1, s[44:47], s75 offen offset:2048 sc1
 v_pk_mul_f32 v[180:181], v[180:181], v[158:159] op_sel_hi:[1,0]
 v_pk_mul_f32 v[182:183], v[182:183], v[158:159] op_sel_hi:[1,0]
 v_pk_mul_f32 v[188:189], v[188:189], v[158:159] op_sel_hi:[1,0]
 v_pk_mul_f32 v[190:191], v[190:191], v[158:159] op_sel_hi:[1,0]
 v_cvt_pk_bf16_f32 v236, v180, v181
 v_cvt_pk_bf16_f32 v237, v182, v183
 v_cvt_pk_bf16_f32 v238, v188, v189
 v_cvt_pk_bf16_f32 v239, v190, v191
 buffer_store_dwordx4 v[236:239], v1, s[44:47], s75 offen offset:3072 sc1
 v_pk_mul_f32 v[192:193], v[192:193], v[156:157] op_sel_hi:[1,0]
 v_pk_mul_f32 v[194:195], v[194:195], v[156:157] op_sel_hi:[1,0]
 v_pk_mul_f32 v[200:201], v[200:201], v[156:157] op_sel_hi:[1,0]
 v_pk_mul_f32 v[202:203], v[202:203], v[156:157] op_sel_hi:[1,0]
 v_cvt_pk_bf16_f32 v240, v192, v193
 v_cvt_pk_bf16_f32 v241, v194, v195
 v_cvt_pk_bf16_f32 v242, v200, v201
 v_cvt_pk_bf16_f32 v243, v202, v203
 buffer_store_dwordx4 v[240:243], v1, s[44:47], s62 offen offset:0 sc1
 v_pk_mul_f32 v[196:197], v[196:197], v[158:159] op_sel_hi:[1,0]
 v_pk_mul_f32 v[198:199], v[198:199], v[158:159] op_sel_hi:[1,0]
 v_pk_mul_f32 v[204:205], v[204:205], v[158:159] op_sel_hi:[1,0]
 v_pk_mul_f32 v[206:207], v[206:207], v[158:159] op_sel_hi:[1,0]
 v_cvt_pk_bf16_f32 v244, v196, v197
 v_cvt_pk_bf16_f32 v245, v198, v199
 v_cvt_pk_bf16_f32 v246, v204, v205
 v_cvt_pk_bf16_f32 v247, v206, v207
 buffer_store_dwordx4 v[244:247], v1, s[44:47], s62 offen offset:1024 sc1
 v_pk_mul_f32 v[208:209], v[208:209], v[156:157] op_sel_hi:[1,0]
 v_pk_mul_f32 v[210:211], v[210:211], v[156:157] op_sel_hi:[1,0]
 v_pk_mul_f32 v[216:217], v[216:217], v[156:157] op_sel_hi:[1,0]
 v_pk_mul_f32 v[218:219], v[218:219], v[156:157] op_sel_hi:[1,0]
 v_cvt_pk_bf16_f32 v248, v208, v209
 v_cvt_pk_bf16_f32 v249, v210, v211
 v_cvt_pk_bf16_f32 v250, v216, v217
 v_cvt_pk_bf16_f32 v251, v218, v219
 buffer_store_dwordx4 v[248:251], v1, s[44:47], s62 offen offset:2048 sc1
 v_pk_mul_f32 v[212:213], v[212:213], v[158:159] op_sel_hi:[1,0]
 v_pk_mul_f32 v[214:215], v[214:215], v[158:159] op_sel_hi:[1,0]
 v_pk_mul_f32 v[220:221], v[220:221], v[158:159] op_sel_hi:[1,0]
 v_pk_mul_f32 v[222:223], v[222:223], v[158:159] op_sel_hi:[1,0]
 v_cvt_pk_bf16_f32 v252, v212, v213
 v_cvt_pk_bf16_f32 v253, v214, v215
 v_cvt_pk_bf16_f32 v254, v220, v221
 v_cvt_pk_bf16_f32 v255, v222, v223
 buffer_store_dwordx4 v[252:255], v1, s[44:47], s62 offen offset:3072 sc1
 s_sub_u32 s93, s2, 0
 s_min_u32 s93, s93, 0x1000
 s_lshl_b32 s93, s93, 2
 s_and_b32 s57, s48, 3
 s_add_u32 s93, s93, s57
 s_cmp_ge_u32 s93, 364
 s_cbranch_scc1 L_norepack
 s_cmp_lg_u32 s73, 0
 s_cbranch_scc1 L_norepack
 s_mul_i32 s93, s93, 4
 v_add_u32 v156, 0, v0
 v_mul_u32_u24 v157, 6554, v156
 v_lshrrev_b32 v157, 16, v157
 v_mul_u32_u24 v157, 1120, v157
 v_lshl_add_u32 v128, v156, 4, v157
 v_add_u32 v156, 64, v0
 v_mul_u32_u24 v157, 6554, v156
 v_lshrrev_b32 v157, 16, v157
 v_mul_u32_u24 v157, 1120, v157
 v_lshl_add_u32 v129, v156, 4, v157
 v_add_u32 v156, 128, v0
 v_mul_u32_u24 v157, 6554, v156
 v_lshrrev_b32 v157, 16, v157
 v_mul_u32_u24 v157, 1120, v157
 v_lshl_add_u32 v130, v156, 4, v157
 v_add_u32 v156, 192, v0
 v_mul_u32_u24 v157, 6554, v156
 v_lshrrev_b32 v157, 16, v157
 v_mul_u32_u24 v157, 1120, v157
 v_lshl_add_u32 v131, v156, 4, v157
 v_add_u32 v156, 256, v0
 v_mul_u32_u24 v157, 6554, v156
 v_lshrrev_b32 v157, 16, v157
 v_mul_u32_u24 v157, 1120, v157
 v_lshl_add_u32 v132, v156, 4, v157
 s_mov_b32 s91, 0x20000
 s_waitcnt vmcnt(16)
 s_barrier
 s_cmp_le_u32 s74, 2
 s_cbranch_scc1 Lnd_44
 s_add_u32 m0, s72, 0
 s_cmp_lt_u32 s70, s94
 s_cselect_b32 s96, s70, 0x10000000
 buffer_load_dwordx4 v1, s[44:47], s96 offen offset:0 sc1 lds
 buffer_load_dwordx4 v1, s[44:47], s96 offen offset:1024 sc1 lds
 buffer_load_dwordx4 v1, s[44:47], s96 offen offset:2048 sc1 lds
 buffer_load_dwordx4 v1, s[44:47], s96 offen offset:3072 sc1 lds
 s_add_u32 m0, s72, 16384
 s_cmp_lt_u32 s71, s95
 s_cselect_b32 s96, s71, 0x10000000
 buffer_load_dwordx4 v1, s[44:47], s96 offen offset:0 sc1 lds
 buffer_load_dwordx4 v1, s[44:47], s96 offen offset:1024 sc1 lds
 buffer_load_dwordx4 v1, s[44:47], s96 offen offset:2048 sc1 lds
 buffer_load_dwordx4 v1, s[44:47], s96 offen offset:3072 sc1 lds
 s_add_u32 s70, s70, 16384
 s_add_u32 s71, s71, 16384
 s_add_u32 s72, s72, 32768
 s_and_b32 s72, s72, 0x1ffff
Lnd_44:
 s_sub_u32 s74, s74, 1
 s_add_u32 s57, s93, 0
 s_and_b32 s58, s57, 7
 s_lshr_b32 s57, s57, 3
 s_mul_i32 s58, s58, 160
 s_cmp_lt_u32 s57, 54
 s_cselect_b32 s88, s32, s24
 s_cselect_b32 s89, s33, s25
 s_cselect_b32 s90, s34, s26
 s_cselect_b32 s54, 0, 54
 s_sub_u32 s57, s57, s54
 s_mul_i32 s57, s57, 40960
 s_add_u32 s57, s57, s58
 buffer_load_dwordx4 v[48:51], v128, s[88:91], s57 offen
 buffer_load_dwordx4 v[52:55], v129, s[88:91], s57 offen
 buffer_load_dwordx4 v[56:59], v130, s[88:91], s57 offen
 buffer_load_dwordx4 v[60:63], v131, s[88:91], s57 offen
 buffer_load_dwordx4 v[64:67], v132, s[88:91], s57 offen
 s_add_u32 s57, s93, 1
 s_and_b32 s58, s57, 7
 s_lshr_b32 s57, s57, 3
 s_mul_i32 s58, s58, 160
 s_cmp_lt_u32 s57, 54
 s_cselect_b32 s88, s32, s24
 s_cselect_b32 s89, s33, s25
 s_cselect_b32 s90, s34, s26
 s_cselect_b32 s54, 0, 54
 s_sub_u32 s57, s57, s54
 s_mul_i32 s57, s57, 40960
 s_add_u32 s57, s57, s58
 buffer_load_dwordx4 v[68:71], v128, s[88:91], s57 offen
 buffer_load_dwordx4 v[72:75], v129, s[88:91], s57 offen
 buffer_load_dwordx4 v[76:79], v130, s[88:91], s57 offen
 buffer_load_dwordx4 v[80:83], v131, s[88:91], s57 offen
 buffer_load_dwordx4 v[84:87], v132, s[88:91], s57 offen
 s_add_u32 s57, s93, 2
 s_and_b32 s58, s57, 7
 s_lshr_b32 s57, s57, 3
 s_mul_i32 s58, s58, 160
 s_cmp_lt_u32 s57, 54
 s_cselect_b32 s88, s32, s24
 s_cselect_b32 s89, s33, s25
 s_cselect_b32 s90, s34, s26
 s_cselect_b32 s54, 0, 54
 s_sub_u32 s57, s57, s54
 s_mul_i32 s57, s57, 40960
 s_add_u32 s57, s57, s58
 buffer_load_dwordx4 v[88:91], v128, s[88:91], s57 offen
 buffer_load_dwordx4 v[92:95], v129, s[88:91], s57 offen
 buffer_load_dwordx4 v[96:99], v130, s[88:91], s57 offen
 buffer_load_dwordx4 v[100:103], v131, s[88:91], s57 offen
 buffer_load_dwordx4 v[104:107], v132, s[88:91], s57 offen
 s_add_u32 s57, s93, 3
 s_and_b32 s58, s57, 7
 s_lshr_b32 s57, s57, 3
 s_mul_i32 s58, s58, 160
 s_cmp_lt_u32 s57, 54
 s_cselect_b32 s88, s32, s24
 s_cselect_b32 s89, s33, s25
 s_cselect_b32 s90, s34, s26
 s_cselect_b32 s54, 0, 54
 s_sub_u32 s57, s57, s54
 s_mul_i32 s57, s57, 40960
 s_add_u32 s57, s57, s58
 buffer_load_dwordx4 v[108:111], v128, s[88:91], s57 offen
 buffer_load_dwordx4 v[112:115], v129, s[88:91], s57 offen
 buffer_load_dwordx4 v[116:119], v130, s[88:91], s57 offen
 buffer_load_dwordx4 v[120:123], v131, s[88:91], s57 offen
 buffer_load_dwordx4 v[124:127], v132, s[88:91], s57 offen
 s_waitcnt vmcnt(36)
 s_barrier
 s_cmp_le_u32 s74, 2
 s_cbranch_scc1 Lnd_45
 s_add_u32 m0, s72, 0
 s_cmp_lt_u32 s70, s94
 s_cselect_b32 s96, s70, 0x10000000
 buffer_load_dwordx4 v1, s[44:47], s96 offen offset:0 sc1 lds
 buffer_load_dwordx4 v1, s[44:47], s96 offen offset:1024 sc1 lds
 buffer_load_dwordx4 v1, s[44:47], s96 offen offset:2048 sc1 lds
 buffer_load_dwordx4 v1, s[44:47], s96 offen offset:3072 sc1 lds
 s_add_u32 m0, s72, 16384
 s_cmp_lt_u32 s71, s95
 s_cselect_b32 s96, s71, 0x10000000
 buffer_load_dwordx4 v1, s[44:47], s96 offen offset:0 sc1 lds
 buffer_load_dwordx4 v1, s[44:47], s96 offen offset:1024 sc1 lds
 buffer_load_dwordx4 v1, s[44:47], s96 offen offset:2048 sc1 lds
 buffer_load_dwordx4 v1, s[44:47], s96 offen offset:3072 sc1 lds
 s_add_u32 s70, s70, 16384
 s_add_u32 s71, s71, 16384
 s_add_u32 s72, s72, 32768
 s_and_b32 s72, s72, 0x1ffff
Lnd_45:
 s_sub_u32 s74, s74, 1
 s_waitcnt vmcnt(28)
 s_barrier
 s_cmp_le_u32 s74, 2
 s_cbranch_scc1 Lnd_46
 s_add_u32 m0, s72, 0
 s_cmp_lt_u32 s70, s94
 s_cselect_b32 s96, s70, 0x10000000
 buffer_load_dwordx4 v1, s[44:47], s96 offen offset:0 sc1 lds
 buffer_load_dwordx4 v1, s[44:47], s96 offen offset:1024 sc1 lds
 buffer_load_dwordx4 v1, s[44:47], s96 offen offset:2048 sc1 lds
 buffer_load_dwordx4 v1, s[44:47], s96 offen offset:3072 sc1 lds
 s_add_u32 m0, s72, 16384
 s_cmp_lt_u32 s71, s95
 s_cselect_b32 s96, s71, 0x10000000
 buffer_load_dwordx4 v1, s[44:47], s96 offen offset:0 sc1 lds
 buffer_load_dwordx4 v1, s[44:47], s96 offen offset:1024 sc1 lds
 buffer_load_dwordx4 v1, s[44:47], s96 offen offset:2048 sc1 lds
 buffer_load_dwordx4 v1, s[44:47], s96 offen offset:3072 sc1 lds
 s_add_u32 s70, s70, 16384
 s_add_u32 s71, s71, 16384
 s_add_u32 s72, s72, 32768
 s_and_b32 s72, s72, 0x1ffff
Lnd_46:
 s_sub_u32 s74, s74, 1
 s_waitcnt vmcnt(8)
 s_barrier
 s_cmp_le_u32 s74, 2
 s_cbranch_scc1 Lnd_47
 s_add_u32 m0, s72, 0
 s_cmp_lt_u32 s70, s94
 s_cselect_b32 s96, s70, 0x10000000
 buffer_load_dwordx4 v1, s[44:47], s96 offen offset:0 sc1 lds
 buffer_load_dwordx4 v1, s[44:47], s96 offen offset:1024 sc1 lds
 buffer_load_dwordx4 v1, s[44:47], s96 offen offset:2048 sc1 lds
 buffer_load_dwordx4 v1, s[44:47], s96 offen offset:3072 sc1 lds
 s_add_u32 m0, s72, 16384
 s_cmp_lt_u32 s71, s95
 s_cselect_b32 s96, s71, 0x10000000
 buffer_load_dwordx4 v1, s[44:47], s96 offen offset:0 sc1 lds
 buffer_load_dwordx4 v1, s[44:47], s96 offen offset:1024 sc1 lds
 buffer_load_dwordx4 v1, s[44:47], s96 offen offset:2048 sc1 lds
 buffer_load_dwordx4 v1, s[44:47], s96 offen offset:3072 sc1 lds
 s_add_u32 s70, s70, 16384
 s_add_u32 s71, s71, 16384
 s_add_u32 s72, s72, 32768
 s_and_b32 s72, s72, 0x1ffff
Lnd_47:
 s_sub_u32 s74, s74, 1
 s_add_u32 s55, s93, 0
 s_and_b32 s56, s55, 7
 s_lshr_b32 s55, s55, 3
 s_mul_i32 s56, s56, 0xe5800
 s_mul_i32 s55, s55, 5120
 s_add_u32 s55, s55, s56
 s_add_u32 s55, s55, 0x45a0000
 s_add_u32 s56, s55, 4096
 buffer_store_dwordx4 v[48:51], v1, s[44:47], s55 offen offset:0 sc1
 buffer_store_dwordx4 v[52:55], v1, s[44:47], s55 offen offset:1024 sc1
 buffer_store_dwordx4 v[56:59], v1, s[44:47], s55 offen offset:2048 sc1
 buffer_store_dwordx4 v[60:63], v1, s[44:47], s55 offen offset:3072 sc1
 buffer_store_dwordx4 v[64:67], v1, s[44:47], s56 offen offset:0 sc1
 s_add_u32 s55, s93, 1
 s_and_b32 s56, s55, 7
 s_lshr_b32 s55, s55, 3
 s_mul_i32 s56, s56, 0xe5800
 s_mul_i32 s55, s55, 5120
 s_add_u32 s55, s55, s56
 s_add_u32 s55, s55, 0x45a0000
 s_add_u32 s56, s55, 4096
 buffer_store_dwordx4 v[68:71], v1, s[44:47], s55 offen offset:0 sc1
 buffer_store_dwordx4 v[72:75], v1, s[44:47], s55 offen offset:1024 sc1
 buffer_store_dwordx4 v[76:79], v1, s[44:47], s55 offen offset:2048 sc1
 buffer_store_dwordx4 v[80:83], v1, s[44:47], s55 offen offset:3072 sc1
 buffer_store_dwordx4 v[84:87], v1, s[44:47], s56 offen offset:0 sc1
 s_add_u32 s55, s93, 2
 s_and_b32 s56, s55, 7
 s_lshr_b32 s55, s55, 3
 s_mul_i32 s56, s56, 0xe5800
 s_mul_i32 s55, s55, 5120
 s_add_u32 s55, s55, s56
 s_add_u32 s55, s55, 0x45a0000
 s_add_u32 s56, s55, 4096
 buffer_store_dwordx4 v[88:91], v1, s[44:47], s55 offen offset:0 sc1
 buffer_store_dwordx4 v[92:95], v1, s[44:47], s55 offen offset:1024 sc1
 buffer_store_dwordx4 v[96:99], v1, s[44:47], s55 offen offset:2048 sc1
 buffer_store_dwordx4 v[100:103], v1, s[44:47], s55 offen offset:3072 sc1
 buffer_store_dwordx4 v[104:107], v1, s[44:47], s56 offen offset:0 sc1
 s_add_u32 s55, s93, 3
 s_and_b32 s56, s55, 7
 s_lshr_b32 s55, s55, 3
 s_mul_i32 s56, s56, 0xe5800
 s_mul_i32 s55, s55, 5120
 s_add_u32 s55, s55, s56
 s_add_u32 s55, s55, 0x45a0000
 s_add_u32 s56, s55, 4096
 buffer_store_dwordx4 v[108:111], v1, s[44:47], s55 offen offset:0 sc1
 buffer_store_dwordx4 v[112:115], v1, s[44:47], s55 offen offset:1024 sc1
 buffer_store_dwordx4 v[116:119], v1, s[44:47], s55 offen offset:2048 sc1
 buffer_store_dwordx4 v[120:123], v1, s[44:47], s55 offen offset:3072 sc1
 buffer_store_dwordx4 v[124:127], v1, s[44:47], s56 offen offset:0 sc1
 s_waitcnt vmcnt(28)
 s_barrier
 s_cmp_le_u32 s74, 2
 s_cbranch_scc1 Lnd_48
 s_add_u32 m0, s72, 0
 s_cmp_lt_u32 s70, s94
 s_cselect_b32 s96, s70, 0x10000000
 buffer_load_dwordx4 v1, s[44:47], s96 offen offset:0 sc1 lds
 buffer_load_dwordx4 v1, s[44:47], s96 offen offset:1024 sc1 lds
 buffer_load_dwordx4 v1, s[44:47], s96 offen offset:2048 sc1 lds
 buffer_load_dwordx4 v1, s[44:47], s96 offen offset:3072 sc1 lds
 s_add_u32 m0, s72, 16384
 s_cmp_lt_u32 s71, s95
 s_cselect_b32 s96, s71, 0x10000000
 buffer_load_dwordx4 v1, s[44:47], s96 offen offset:0 sc1 lds
 buffer_load_dwordx4 v1, s[44:47], s96 offen offset:1024 sc1 lds
 buffer_load_dwordx4 v1, s[44:47], s96 offen offset:2048 sc1 lds
 buffer_load_dwordx4 v1, s[44:47], s96 offen offset:3072 sc1 lds
 s_add_u32 s70, s70, 16384
 s_add_u32 s71, s71, 16384
 s_add_u32 s72, s72, 32768
 s_and_b32 s72, s72, 0x1ffff
Lnd_48:
 s_sub_u32 s74, s74, 1
 s_waitcnt vmcnt(28)
 s_barrier
 s_cmp_le_u32 s74, 2
 s_cbranch_scc1 Lnd_49
 s_add_u32 m0, s72, 0
 s_cmp_lt_u32 s70, s94
 s_cselect_b32 s96, s70, 0x10000000
 buffer_load_dwordx4 v1, s[44:47], s96 offen offset:0 sc1 lds
 buffer_load_dwordx4 v1, s[44:47], s96 offen offset:1024 sc1 lds
 buffer_load_dwordx4 v1, s[44:47], s96 offen offset:2048 sc1 lds
 buffer_load_dwordx4 v1, s[44:47], s96 offen offset:3072 sc1 lds
 s_add_u32 m0, s72, 16384
 s_cmp_lt_u32 s71, s95
 s_cselect_b32 s96, s71, 0x10000000
 buffer_load_dwordx4 v1, s[44:47], s96 offen offset:0 sc1 lds
 buffer_load_dwordx4 v1, s[44:47], s96 offen offset:1024 sc1 lds
 buffer_load_dwordx4 v1, s[44:47], s96 offen offset:2048 sc1 lds
 buffer_load_dwordx4 v1, s[44:47], s96 offen offset:3072 sc1 lds
 s_add_u32 s70, s70, 16384
 s_add_u32 s71, s71, 16384
 s_add_u32 s72, s72, 32768
 s_and_b32 s72, s72, 0x1ffff
Lnd_49:
 s_sub_u32 s74, s74, 1
 s_waitcnt vmcnt(8)
 s_barrier
 s_cmp_le_u32 s74, 2
 s_cbranch_scc1 Lnd_50
 s_add_u32 m0, s72, 0
 s_cmp_lt_u32 s70, s94
 s_cselect_b32 s96, s70, 0x10000000
 buffer_load_dwordx4 v1, s[44:47], s96 offen offset:0 sc1 lds
 buffer_load_dwordx4 v1, s[44:47], s96 offen offset:1024 sc1 lds
 buffer_load_dwordx4 v1, s[44:47], s96 offen offset:2048 sc1 lds
 buffer_load_dwordx4 v1, s[44:47], s96 offen offset:3072 sc1 lds
 s_add_u32 m0, s72, 16384
 s_cmp_lt_u32 s71, s95
 s_cselect_b32 s96, s71, 0x10000000
 buffer_load_dwordx4 v1, s[44:47], s96 offen offset:0 sc1 lds
 buffer_load_dwordx4 v1, s[44:47], s96 offen offset:1024 sc1 lds
 buffer_load_dwordx4 v1, s[44:47], s96 offen offset:2048 sc1 lds
 buffer_load_dwordx4 v1, s[44:47], s96 offen offset:3072 sc1 lds
 s_add_u32 s70, s70, 16384
 s_add_u32 s71, s71, 16384
 s_add_u32 s72, s72, 32768
 s_and_b32 s72, s72, 0x1ffff
Lnd_50:
 s_sub_u32 s74, s74, 1
 s_mov_b32 s57, 77824
 v_mov_b32 v5, 1
 s_mov_b64 exec, 1
 buffer_atomic_add v5, v4, s[44:47], s57 offen
 s_mov_b64 exec, -1
 s_branch L_S_drain
L_norepack:
 s_cmp_eq_u32 s74, 1
 s_cbranch_scc1 L_S_late
 s_cmp_eq_u32 s74, 2
 s_cbranch_scc1 L_S_final
 s_waitcnt vmcnt(16)
 s_barrier
 s_cmp_le_u32 s74, 2
 s_cbranch_scc1 Lnd_51
 s_add_u32 m0, s72, 0
 s_cmp_lt_u32 s70, s94
 s_cselect_b32 s96, s70, 0x10000000
 buffer_load_dwordx4 v1, s[44:47], s96 offen offset:0 sc1 lds
 buffer_load_dwordx4 v1, s[44:47], s96 offen offset:1024 sc1 lds
 buffer_load_dwordx4 v1, s[44:47], s96 offen offset:2048 sc1 lds
 buffer_load_dwordx4 v1, s[44:47], s96 offen offset:3072 sc1 lds
 s_add_u32 m0, s72, 16384
 s_cmp_lt_u32 s71, s95
 s_cselect_b32 s96, s71, 0x10000000
 buffer_load_dwordx4 v1, s[44:47], s96 offen offset:0 sc1 lds
 buffer_load_dwordx4 v1, s[44:47], s96 offen offset:1024 sc1 lds
 buffer_load_dwordx4 v1, s[44:47], s96 offen offset:2048 sc1 lds
 buffer_load_dwordx4 v1, s[44:47], s96 offen offset:3072 sc1 lds
 s_add_u32 s70, s70, 16384
 s_add_u32 s71, s71, 16384
 s_add_u32 s72, s72, 32768
 s_and_b32 s72, s72, 0x1ffff
Lnd_51:
 s_sub_u32 s74, s74, 1
 s_cmp_eq_u32 s74, 2
 s_cbranch_scc1 L_S_final
 s_waitcnt vmcnt(16)
 s_barrier
 s_cmp_le_u32 s74, 2
 s_cbranch_scc1 Lnd_52
 s_add_u32 m0, s72, 0
 s_cmp_lt_u32 s70, s94
 s_cselect_b32 s96, s70, 0x10000000
 buffer_load_dwordx4 v1, s[44:47], s96 offen offset:0 sc1 lds
 buffer_load_dwordx4 v1, s[44:47], s96 offen offset:1024 sc1 lds
 buffer_load_dwordx4 v1, s[44:47], s96 offen offset:2048 sc1 lds
 buffer_load_dwordx4 v1, s[44:47], s96 offen offset:3072 sc1 lds
 s_add_u32 m0, s72, 16384
 s_cmp_lt_u32 s71, s95
 s_cselect_b32 s96, s71, 0x10000000
 buffer_load_dwordx4 v1, s[44:47], s96 offen offset:0 sc1 lds
 buffer_load_dwordx4 v1, s[44:47], s96 offen offset:1024 sc1 lds
 buffer_load_dwordx4 v1, s[44:47], s96 offen offset:2048 sc1 lds
 buffer_load_dwordx4 v1, s[44:47], s96 offen offset:3072 sc1 lds
 s_add_u32 s70, s70, 16384
 s_add_u32 s71, s71, 16384
 s_add_u32 s72, s72, 32768
 s_and_b32 s72, s72, 0x1ffff
Lnd_52:
 s_sub_u32 s74, s74, 1
L_S_drain:
 s_cmp_eq_u32 s74, 2
 s_cbranch_scc1 L_S_final
 s_waitcnt vmcnt(8)
 s_barrier
 s_cmp_le_u32 s74, 2
 s_cbranch_scc1 Lnd_53
 s_add_u32 m0, s72, 0
 s_cmp_lt_u32 s70, s94
 s_cselect_b32 s96, s70, 0x10000000
 buffer_load_dwordx4 v1, s[44:47], s96 offen offset:0 sc1 lds
 buffer_load_dwordx4 v1, s[44:47], s96 offen offset:1024 sc1 lds
 buffer_load_dwordx4 v1, s[44:47], s96 offen offset:2048 sc1 lds
 buffer_load_dwordx4 v1, s[44:47], s96 offen offset:3072 sc1 lds
 s_add_u32 m0, s72, 16384
 s_cmp_lt_u32 s71, s95
 s_cselect_b32 s96, s71, 0x10000000
 buffer_load_dwordx4 v1, s[44:47], s96 offen offset:0 sc1 lds
 buffer_load_dwordx4 v1, s[44:47], s96 offen offset:1024 sc1 lds
 buffer_load_dwordx4 v1, s[44:47], s96 offen offset:2048 sc1 lds
 buffer_load_dwordx4 v1, s[44:47], s96 offen offset:3072 sc1 lds
 s_add_u32 s70, s70, 16384
 s_add_u32 s71, s71, 16384
 s_add_u32 s72, s72, 32768
 s_and_b32 s72, s72, 0x1ffff
Lnd_53:
 s_sub_u32 s74, s74, 1
 s_cmp_lg_u32 s74, 5
 s_cbranch_scc1 L_S_drain
 s_mov_b32 s58, 77824
 buffer_load_dword v10, v4, s[44:47], s58 offen sc1
 s_waitcnt vmcnt(0)
 v_readfirstlane_b32 s57, v10
 s_cmp_lt_u32 s57, 364
 s_cbranch_scc1 L_S_drain
 s_lshl_b32 s76, s79, 7
 s_add_u32 s76, s76, 4096
 buffer_load_dword v10, v4, s[44:47], s76 offen sc1
 s_waitcnt vmcnt(0)
 v_readfirstlane_b32 s57, v10
 s_cmp_ge_u32 s57, 27
 s_cbranch_scc1 Lpok_54
 s_mov_b32 s66, 0x10000
Lpoll_55:
 buffer_load_dword v10, v4, s[44:47], s76 offen sc1
 s_waitcnt vmcnt(0)
 v_readfirstlane_b32 s57, v10
 s_cmp_ge_u32 s57, 27
 s_cbranch_scc1 Lpolld_56
 s_sleep 2
 s_sub_u32 s66, s66, 1
 s_cmp_lg_u32 s66, 0
 s_cbranch_scc1 Lpoll_55
Lpolld_56:
Lpok_54:
 s_waitcnt vmcnt(0)
 s_barrier
 s_cmp_le_u32 s74, 2
 s_cbranch_scc1 Lnd_57
 s_add_u32 m0, s72, 0
 s_cmp_lt_u32 s70, s94
 s_cselect_b32 s96, s70, 0x10000000
 buffer_load_dwordx4 v1, s[44:47], s96 offen offset:0 sc1 lds
 buffer_load_dwordx4 v1, s[44:47], s96 offen offset:1024 sc1 lds
 buffer_load_dwordx4 v1, s[44:47], s96 offen offset:2048 sc1 lds
 buffer_load_dwordx4 v1, s[44:47], s96 offen offset:3072 sc1 lds
 s_add_u32 m0, s72, 16384
 s_cmp_lt_u32 s71, s95
 s_cselect_b32 s96, s71, 0x10000000
 buffer_load_dwordx4 v1, s[44:47], s96 offen offset:0 sc1 lds
 buffer_load_dwordx4 v1, s[44:47], s96 offen offset:1024 sc1 lds
 buffer_load_dwordx4 v1, s[44:47], s96 offen offset:2048 sc1 lds
 buffer_load_dwordx4 v1, s[44:47], s96 offen offset:3072 sc1 lds
 s_add_u32 s70, s70, 16384
 s_add_u32 s71, s71, 16384
 s_add_u32 s72, s72, 32768
 s_and_b32 s72, s72, 0x1ffff
Lnd_57:
 s_sub_u32 s74, s74, 1
 s_and_b32 s57, s48, 3
 s_mul_i32 s57, s57, 5120
 s_add_u32 s54, s83, s57
 s_add_u32 m0, s57, 143360
 s_nop 0
 buffer_load_dwordx4 v1, s[44:47], s54 offen offset:0 sc1 lds
 buffer_load_dwordx4 v1, s[44:47], s54 offen offset:1024 sc1 lds
 buffer_load_dwordx4 v1, s[44:47], s54 offen offset:2048 sc1 lds
 buffer_load_dwordx4 v1, s[44:47], s54 offen offset:3072 sc1 lds
 s_add_u32 m0, s57, 147456
 s_nop 0
 buffer_load_dwordx4 v15, s[44:47], s54 offen offset:0 sc1 lds
 s_mov_b32 s97, s54
 s_add_u32 s55, s81, 0
 buffer_load_dwordx4 v[48:51], v1, s[44:47], s55 offen offset:0 sc1
 buffer_load_dwordx4 v[52:55], v1, s[44:47], s55 offen offset:1024 sc1
 buffer_load_dwordx4 v[56:59], v1, s[44:47], s55 offen offset:2048 sc1
 buffer_load_dwordx4 v[60:63], v1, s[44:47], s55 offen offset:3072 sc1
 s_bfe_u32 s56, s48, 0x10001
 s_cmp_eq_u32 s56, s80
 s_cselect_b32 s56, 0, 0x10000000
 v_subrev_u32 v5, 20480, v6
 buffer_load_dwordx2 v[200:201], v5, s[4:7], s56 offen offset:0
 buffer_load_dwordx2 v[202:203], v6, s[4:7], s56 offen offset:0
 buffer_load_dwordx2 v[204:205], v5, s[4:7], s56 offen offset:32
 buffer_load_dwordx2 v[206:207], v6, s[4:7], s56 offen offset:32
 buffer_load_dwordx2 v[208:209], v5, s[4:7], s56 offen offset:64
 buffer_load_dwordx2 v[210:211], v6, s[4:7], s56 offen offset:64
 buffer_load_dwordx2 v[212:213], v5, s[4:7], s56 offen offset:96
 buffer_load_dwordx2 v[214:215], v6, s[4:7], s56 offen offset:96
 buffer_load_dwordx2 v[216:217], v5, s[4:7], s56 offen offset:128
 buffer_load_dwordx2 v[218:219], v6, s[4:7], s56 offen offset:128
 s_mov_b32 s98, 1
 s_add_u32 s55, s81, 8192
 buffer_load_dwordx4 v[64:67], v1, s[44:47], s55 offen offset:0 sc1
 buffer_load_dwordx4 v[68:71], v1, s[44:47], s55 offen offset:1024 sc1
 buffer_load_dwordx4 v[72:75], v1, s[44:47], s55 offen offset:2048 sc1
 buffer_load_dwordx4 v[76:79], v1, s[44:47], s55 offen offset:3072 sc1
 s_add_u32 s55, s81, 16384
 buffer_load_dwordx4 v[80:83], v1, s[44:47], s55 offen offset:0 sc1
 buffer_load_dwordx4 v[84:87], v1, s[44:47], s55 offen offset:1024 sc1
 buffer_load_dwordx4 v[88:91], v1, s[44:47], s55 offen offset:2048 sc1
 buffer_load_dwordx4 v[92:95], v1, s[44:47], s55 offen offset:3072 sc1
 s_waitcnt vmcnt(35)
 s_barrier
 s_cmp_le_u32 s74, 2
 s_cbranch_scc1 Lnd_58
 s_add_u32 m0, s72, 0
 s_cmp_lt_u32 s70, s94
 s_cselect_b32 s96, s70, 0x10000000
 buffer_load_dwordx4 v1, s[44:47], s96 offen offset:0 sc1 lds
 buffer_load_dwordx4 v1, s[44:47], s96 offen offset:1024 sc1 lds
 buffer_load_dwordx4 v1, s[44:47], s96 offen offset:2048 sc1 lds
 buffer_load_dwordx4 v1, s[44:47], s96 offen offset:3072 sc1 lds
 s_add_u32 m0, s72, 16384
 s_cmp_lt_u32 s71, s95
 s_cselect_b32 s96, s71, 0x10000000
 buffer_load_dwordx4 v1, s[44:47], s96 offen offset:0 sc1 lds
 buffer_load_dwordx4 v1, s[44:47], s96 offen offset:1024 sc1 lds
 buffer_load_dwordx4 v1, s[44:47], s96 offen offset:2048 sc1 lds
 buffer_load_dwordx4 v1, s[44:47], s96 offen offset:3072 sc1 lds
 s_add_u32 s70, s70, 16384
 s_add_u32 s71, s71, 16384
 s_add_u32 s72, s72, 32768
 s_and_b32 s72, s72, 0x1ffff
Lnd_58:
 s_sub_u32 s74, s74, 1
 s_add_u32 s55, s81, 24576
 buffer_load_dwordx4 v[96:99], v1, s[44:47], s55 offen offset:0 sc1
 buffer_load_dwordx4 v[100:103], v1, s[44:47], s55 offen offset:1024 sc1
 buffer_load_dwordx4 v[104:107], v1, s[44:47], s55 offen offset:2048 sc1
 buffer_load_dwordx4 v[108:111], v1, s[44:47], s55 offen offset:3072 sc1
 s_add_u32 s55, s81, 32768
 buffer_load_dwordx4 v[112:115], v1, s[44:47], s55 offen offset:0 sc1
 buffer_load_dwordx4 v[116:119], v1, s[44:47], s55 offen offset:1024 sc1
 buffer_load_dwordx4 v[120:123], v1, s[44:47], s55 offen offset:2048 sc1
 buffer_load_dwordx4 v[124:127], v1, s[44:47], s55 offen offset:3072 sc1
 s_add_u32 s55, s81, 40960
 buffer_load_dwordx4 v[128:131], v1, s[44:47], s55 offen offset:0 sc1
 buffer_load_dwordx4 v[132:135], v1, s[44:47], s55 offen offset:1024 sc1
 buffer_load_dwordx4 v[136:139], v1, s[44:47], s55 offen offset:2048 sc1
 buffer_load_dwordx4 v[140:143], v1, s[44:47], s55 offen offset:3072 sc1
 s_waitcnt vmcnt(47)
 s_barrier
 s_cmp_le_u32 s74, 2
 s_cbranch_scc1 Lnd_59
 s_add_u32 m0, s72, 0
 s_cmp_lt_u32 s70, s94
 s_cselect_b32 s96, s70, 0x10000000
 buffer_load_dwordx4 v1, s[44:47], s96 offen offset:0 sc1 lds
 buffer_load_dwordx4 v1, s[44:47], s96 offen offset:1024 sc1 lds
 buffer_load_dwordx4 v1, s[44:47], s96 offen offset:2048 sc1 lds
 buffer_load_dwordx4 v1, s[44:47], s96 offen offset:3072 sc1 lds
 s_add_u32 m0, s72, 16384
 s_cmp_lt_u32 s71, s95
 s_cselect_b32 s96, s71, 0x10000000
 buffer_load_dwordx4 v1, s[44:47], s96 offen offset:0 sc1 lds
 buffer_load_dwordx4 v1, s[44:47], s96 offen offset:1024 sc1 lds
 buffer_load_dwordx4 v1, s[44:47], s96 offen offset:2048 sc1 lds
 buffer_load_dwordx4 v1, s[44:47], s96 offen offset:3072 sc1 lds
 s_add_u32 s70, s70, 16384
 s_add_u32 s71, s71, 16384
 s_add_u32 s72, s72, 32768
 s_and_b32 s72, s72, 0x1ffff
Lnd_59:
 s_sub_u32 s74, s74, 1
L_S_drain2:
 s_cmp_eq_u32 s74, 1
 s_cbranch_scc1 L_S_fin2
 s_waitcnt vmcnt(8)
 s_barrier
 s_cmp_le_u32 s74, 2
 s_cbranch_scc1 Lnd_60
 s_add_u32 m0, s72, 0
 s_cmp_lt_u32 s70, s94
 s_cselect_b32 s96, s70, 0x10000000
 buffer_load_dwordx4 v1, s[44:47], s96 offen offset:0 sc1 lds
 buffer_load_dwordx4 v1, s[44:47], s96 offen offset:1024 sc1 lds
 buffer_load_dwordx4 v1, s[44:47], s96 offen offset:2048 sc1 lds
 buffer_load_dwordx4 v1, s[44:47], s96 offen offset:3072 sc1 lds
 s_add_u32 m0, s72, 16384
 s_cmp_lt_u32 s71, s95
 s_cselect_b32 s96, s71, 0x10000000
 buffer_load_dwordx4 v1, s[44:47], s96 offen offset:0 sc1 lds
 buffer_load_dwordx4 v1, s[44:47], s96 offen offset:1024 sc1 lds
 buffer_load_dwordx4 v1, s[44:47], s96 offen offset:2048 sc1 lds
 buffer_load_dwordx4 v1, s[44:47], s96 offen offset:3072 sc1 lds
 s_add_u32 s70, s70, 16384
 s_add_u32 s71, s71, 16384
 s_add_u32 s72, s72, 32768
 s_and_b32 s72, s72, 0x1ffff
Lnd_60:
 s_sub_u32 s74, s74, 1
 s_branch L_S_drain2
L_S_fin2:
 s_waitcnt vmcnt(0)
 s_barrier
 s_branch L_att_end2
 s_branch L_S_drain
L_S_late:
 s_waitcnt vmcnt(0)
 s_barrier
 s_lshl_b32 s76, s79, 7
 s_add_u32 s76, s76, 4096
 buffer_load_dword v10, v4, s[44:47], s76 offen sc1
 s_mov_b32 s58, 77824
 s_mov_b32 s66, 0x10000
Lpoll_61:
 buffer_load_dword v5, v4, s[44:47], s58 offen sc1
 s_waitcnt vmcnt(0)
 v_readfirstlane_b32 s57, v5
 s_cmp_ge_u32 s57, 364
 s_cbranch_scc1 Lpolld_62
 s_sleep 2
 s_sub_u32 s66, s66, 1
 s_cmp_lg_u32 s66, 0
 s_cbranch_scc1 Lpoll_61
Lpolld_62:
 s_waitcnt vmcnt(0)
 v_readfirstlane_b32 s57, v10
 s_cmp_ge_u32 s57, 27
 s_cbranch_scc1 Lpok_63
 s_mov_b32 s66, 0x10000
Lpoll_64:
 buffer_load_dword v10, v4, s[44:47], s76 offen sc1
 s_waitcnt vmcnt(0)
 v_readfirstlane_b32 s57, v10
 s_cmp_ge_u32 s57, 27
 s_cbranch_scc1 Lpolld_65
 s_sleep 2
 s_sub_u32 s66, s66, 1
 s_cmp_lg_u32 s66, 0
 s_cbranch_scc1 Lpoll_64
Lpolld_65:
Lpok_63:
 s_and_b32 s57, s48, 3
 s_mul_i32 s57, s57, 5120
 s_add_u32 s54, s83, s57
 s_add_u32 m0, s57, 143360
 s_nop 0
 buffer_load_dwordx4 v1, s[44:47], s54 offen offset:0 sc1 lds
 buffer_load_dwordx4 v1, s[44:47], s54 offen offset:1024 sc1 lds
 buffer_load_dwordx4 v1, s[44:47], s54 offen offset:2048 sc1 lds
 buffer_load_dwordx4 v1, s[44:47], s54 offen offset:3072 sc1 lds
 s_add_u32 m0, s57, 147456
 s_nop 0
 buffer_load_dwordx4 v15, s[44:47], s54 offen offset:0 sc1 lds
 s_mov_b32 s97, s54
 s_add_u32 s55, s81, 0
 buffer_load_dwordx4 v[48:51], v1, s[44:47], s55 offen offset:0 sc1
 buffer_load_dwordx4 v[52:55], v1, s[44:47], s55 offen offset:1024 sc1
 buffer_load_dwordx4 v[56:59], v1, s[44:47], s55 offen offset:2048 sc1
 buffer_load_dwordx4 v[60:63], v1, s[44:47], s55 offen offset:3072 sc1
 s_bfe_u32 s56, s48, 0x10001
 s_cmp_eq_u32 s56, s80
 s_cselect_b32 s56, 0, 0x10000000
 v_subrev_u32 v5, 20480, v6
 buffer_load_dwordx2 v[200:201], v5, s[4:7], s56 offen offset:0
 buffer_load_dwordx2 v[202:203], v6, s[4:7], s56 offen offset:0
 buffer_load_dwordx2 v[204:205], v5, s[4:7], s56 offen offset:32
 buffer_load_dwordx2 v[206:207], v6, s[4:7], s56 offen offset:32
 buffer_load_dwordx2 v[208:209], v5, s[4:7], s56 offen offset:64
 buffer_load_dwordx2 v[210:211], v6, s[4:7], s56 offen offset:64
 buffer_load_dwordx2 v[212:213], v5, s[4:7], s56 offen offset:96
 buffer_load_dwordx2 v[214:215], v6, s[4:7], s56 offen offset:96
 buffer_load_dwordx2 v[216:217], v5, s[4:7], s56 offen offset:128
 buffer_load_dwordx2 v[218:219], v6, s[4:7], s56 offen offset:128
 s_mov_b32 s98, 0
 s_add_u32 s55, s81, 8192
 buffer_load_dwordx4 v[64:67], v1, s[44:47], s55 offen offset:0 sc1
 buffer_load_dwordx4 v[68:71], v1, s[44:47], s55 offen offset:1024 sc1
 buffer_load_dwordx4 v[72:75], v1, s[44:47], s55 offen offset:2048 sc1
 buffer_load_dwordx4 v[76:79], v1, s[44:47], s55 offen offset:3072 sc1
 s_add_u32 s55, s81, 16384
 buffer_load_dwordx4 v[80:83], v1, s[44:47], s55 offen offset:0 sc1
 buffer_load_dwordx4 v[84:87], v1, s[44:47], s55 offen offset:1024 sc1
 buffer_load_dwordx4 v[88:91], v1, s[44:47], s55 offen offset:2048 sc1
 buffer_load_dwordx4 v[92:95], v1, s[44:47], s55 offen offset:3072 sc1
 s_add_u32 s55, s81, 24576
 buffer_load_dwordx4 v[96:99], v1, s[44:47], s55 offen offset:0 sc1
 buffer_load_dwordx4 v[100:103], v1, s[44:47], s55 offen offset:1024 sc1
 buffer_load_dwordx4 v[104:107], v1, s[44:47], s55 offen offset:2048 sc1
 buffer_load_dwordx4 v[108:111], v1, s[44:47], s55 offen offset:3072 sc1
 s_branch L_att_end2
L_S_final:
 s_mov_b32 s58, 77824
 buffer_load_dword v10, v4, s[44:47], s58 offen sc1
 s_waitcnt vmcnt(0)
 v_readfirstlane_b32 s57, v10
 s_cmp_ge_u32 s57, 364
 s_cbranch_scc1 L_S_early
 s_barrier
 s_barrier
 s_lshl_b32 s76, s79, 7
 s_add_u32 s76, s76, 4096
 buffer_load_dword v10, v4, s[44:47], s76 offen sc1
 s_mov_b32 s58, 77824
 s_mov_b32 s66, 0x10000
Lpoll_66:
 buffer_load_dword v5, v4, s[44:47], s58 offen sc1
 s_waitcnt vmcnt(0)
 v_readfirstlane_b32 s57, v5
 s_cmp_ge_u32 s57, 364
 s_cbranch_scc1 Lpolld_67
 s_sleep 2
 s_sub_u32 s66, s66, 1
 s_cmp_lg_u32 s66, 0
 s_cbranch_scc1 Lpoll_66
Lpolld_67:
 s_waitcnt vmcnt(0)
 v_readfirstlane_b32 s57, v10
 s_cmp_ge_u32 s57, 27
 s_cbranch_scc1 Lpok_68
 s_mov_b32 s66, 0x10000
Lpoll_69:
 buffer_load_dword v10, v4, s[44:47], s76 offen sc1
 s_waitcnt vmcnt(0)
 v_readfirstlane_b32 s57, v10
 s_cmp_ge_u32 s57, 27
 s_cbranch_scc1 Lpolld_70
 s_sleep 2
 s_sub_u32 s66, s66, 1
 s_cmp_lg_u32 s66, 0
 s_cbranch_scc1 Lpoll_69
Lpolld_70:
Lpok_68:
 s_and_b32 s57, s48, 3
 s_mul_i32 s57, s57, 5120
 s_add_u32 s54, s83, s57
 s_add_u32 m0, s57, 143360
 s_nop 0
 buffer_load_dwordx4 v1, s[44:47], s54 offen offset:0 sc1 lds
 buffer_load_dwordx4 v1, s[44:47], s54 offen offset:1024 sc1 lds
 buffer_load_dwordx4 v1, s[44:47], s54 offen offset:2048 sc1 lds
 buffer_load_dwordx4 v1, s[44:47], s54 offen offset:3072 sc1 lds
 s_add_u32 m0, s57, 147456
 s_nop 0
 buffer_load_dwordx4 v15, s[44:47], s54 offen offset:0 sc1 lds
 s_mov_b32 s97, s54
 s_add_u32 s55, s81, 0
 buffer_load_dwordx4 v[48:51], v1, s[44:47], s55 offen offset:0 sc1
 buffer_load_dwordx4 v[52:55], v1, s[44:47], s55 offen offset:1024 sc1
 buffer_load_dwordx4 v[56:59], v1, s[44:47], s55 offen offset:2048 sc1
 buffer_load_dwordx4 v[60:63], v1, s[44:47], s55 offen offset:3072 sc1
 s_bfe_u32 s56, s48, 0x10001
 s_cmp_eq_u32 s56, s80
 s_cselect_b32 s56, 0, 0x10000000
 v_subrev_u32 v5, 20480, v6
 buffer_load_dwordx2 v[200:201], v5, s[4:7], s56 offen offset:0
 buffer_load_dwordx2 v[202:203], v6, s[4:7], s56 offen offset:0
 buffer_load_dwordx2 v[204:205], v5, s[4:7], s56 offen offset:32
 buffer_load_dwordx2 v[206:207], v6, s[4:7], s56 offen offset:32
 buffer_load_dwordx2 v[208:209], v5, s[4:7], s56 offen offset:64
 buffer_load_dwordx2 v[210:211], v6, s[4:7], s56 offen offset:64
 buffer_load_dwordx2 v[212:213], v5, s[4:7], s56 offen offset:96
 buffer_load_dwordx2 v[214:215], v6, s[4:7], s56 offen offset:96
 buffer_load_dwordx2 v[216:217], v5, s[4:7], s56 offen offset:128
 buffer_load_dwordx2 v[218:219], v6, s[4:7], s56 offen offset:128
 s_mov_b32 s98, 0
 s_add_u32 s55, s81, 8192
 buffer_load_dwordx4 v[64:67], v1, s[44:47], s55 offen offset:0 sc1
 buffer_load_dwordx4 v[68:71], v1, s[44:47], s55 offen offset:1024 sc1
 buffer_load_dwordx4 v[72:75], v1, s[44:47], s55 offen offset:2048 sc1
 buffer_load_dwordx4 v[76:79], v1, s[44:47], s55 offen offset:3072 sc1
 s_add_u32 s55, s81, 16384
 buffer_load_dwordx4 v[80:83], v1, s[44:47], s55 offen offset:0 sc1
 buffer_load_dwordx4 v[84:87], v1, s[44:47], s55 offen offset:1024 sc1
 buffer_load_dwordx4 v[88:91], v1, s[44:47], s55 offen offset:2048 sc1
 buffer_load_dwordx4 v[92:95], v1, s[44:47], s55 offen offset:3072 sc1
 s_add_u32 s55, s81, 24576
 buffer_load_dwordx4 v[96:99], v1, s[44:47], s55 offen offset:0 sc1
 buffer_load_dwordx4 v[100:103], v1, s[44:47], s55 offen offset:1024 sc1
 buffer_load_dwordx4 v[104:107], v1, s[44:47], s55 offen offset:2048 sc1
 buffer_load_dwordx4 v[108:111], v1, s[44:47], s55 offen offset:3072 sc1
 s_branch L_att_end2
L_S_early:
 s_lshl_b32 s76, s79, 7
 s_add_u32 s76, s76, 4096
 buffer_load_dword v10, v4, s[44:47], s76 offen sc1
 s_waitcnt vmcnt(0)
 v_readfirstlane_b32 s57, v10
 s_cmp_ge_u32 s57, 27
 s_cbranch_scc1 Lpok_71
 s_mov_b32 s66, 0x10000
Lpoll_72:
 buffer_load_dword v10, v4, s[44:47], s76 offen sc1
 s_waitcnt vmcnt(0)
 v_readfirstlane_b32 s57, v10
 s_cmp_ge_u32 s57, 27
 s_cbranch_scc1 Lpolld_73
 s_sleep 2
 s_sub_u32 s66, s66, 1
 s_cmp_lg_u32 s66, 0
 s_cbranch_scc1 Lpoll_72
Lpolld_73:
Lpok_71:
 s_barrier
 s_and_b32 s57, s48, 3
 s_mul_i32 s57, s57, 5120
 s_add_u32 s54, s83, s57
 s_add_u32 m0, s57, 143360
 s_nop 0
 buffer_load_dwordx4 v1, s[44:47], s54 offen offset:0 sc1 lds
 buffer_load_dwordx4 v1, s[44:47], s54 offen offset:1024 sc1 lds
 buffer_load_dwordx4 v1, s[44:47], s54 offen offset:2048 sc1 lds
 buffer_load_dwordx4 v1, s[44:47], s54 offen offset:3072 sc1 lds
 s_add_u32 m0, s57, 147456
 s_nop 0
 buffer_load_dwordx4 v15, s[44:47], s54 offen offset:0 sc1 lds
 s_mov_b32 s97, s54
 s_add_u32 s55, s81, 0
 buffer_load_dwordx4 v[48:51], v1, s[44:47], s55 offen offset:0 sc1
 buffer_load_dwordx4 v[52:55], v1, s[44:47], s55 offen offset:1024 sc1
 buffer_load_dwordx4 v[56:59], v1, s[44:47], s55 offen offset:2048 sc1
 buffer_load_dwordx4 v[60:63], v1, s[44:47], s55 offen offset:3072 sc1
 s_bfe_u32 s56, s48, 0x10001
 s_cmp_eq_u32 s56, s80
 s_cselect_b32 s56, 0, 0x10000000
 v_subrev_u32 v5, 20480, v6
 buffer_load_dwordx2 v[200:201], v5, s[4:7], s56 offen offset:0
 buffer_load_dwordx2 v[202:203], v6, s[4:7], s56 offen offset:0
 buffer_load_dwordx2 v[204:205], v5, s[4:7], s56 offen offset:32
 buffer_load_dwordx2 v[206:207], v6, s[4:7], s56 offen offset:32
 buffer_load_dwordx2 v[208:209], v5, s[4:7], s56 offen offset:64
 buffer_load_dwordx2 v[210:211], v6, s[4:7], s56 offen offset:64
 buffer_load_dwordx2 v[212:213], v5, s[4:7], s56 offen offset:96
 buffer_load_dwordx2 v[214:215], v6, s[4:7], s56 offen offset:96
 buffer_load_dwordx2 v[216:217], v5, s[4:7], s56 offen offset:128
 buffer_load_dwordx2 v[218:219], v6, s[4:7], s56 offen offset:128
 s_mov_b32 s98, 0
 s_add_u32 s55, s81, 8192
 buffer_load_dwordx4 v[64:67], v1, s[44:47], s55 offen offset:0 sc1
 buffer_load_dwordx4 v[68:71], v1, s[44:47], s55 offen offset:1024 sc1
 buffer_load_dwordx4 v[72:75], v1, s[44:47], s55 offen offset:2048 sc1
 buffer_load_dwordx4 v[76:79], v1, s[44:47], s55 offen offset:3072 sc1
 s_barrier
 s_add_u32 s55, s81, 16384
 buffer_load_dwordx4 v[80:83], v1, s[44:47], s55 offen offset:0 sc1
 buffer_load_dwordx4 v[84:87], v1, s[44:47], s55 offen offset:1024 sc1
 buffer_load_dwordx4 v[88:91], v1, s[44:47], s55 offen offset:2048 sc1
 buffer_load_dwordx4 v[92:95], v1, s[44:47], s55 offen offset:3072 sc1
 s_add_u32 s55, s81, 24576
 buffer_load_dwordx4 v[96:99], v1, s[44:47], s55 offen offset:0 sc1
 buffer_load_dwordx4 v[100:103], v1, s[44:47], s55 offen offset:1024 sc1
 buffer_load_dwordx4 v[104:107], v1, s[44:47], s55 offen offset:2048 sc1
 buffer_load_dwordx4 v[108:111], v1, s[44:47], s55 offen offset:3072 sc1
 s_branch L_att_end2
L_att_end:
 s_waitcnt vmcnt(0)
 v_readfirstlane_b32 s57, v10
 s_cmp_ge_u32 s57, 27
 s_cbranch_scc1 Lpok_74
 s_mov_b32 s66, 0x10000
Lpoll_75:
 buffer_load_dword v10, v4, s[44:47], s76 offen sc1
 s_waitcnt vmcnt(0)
 v_readfirstlane_b32 s57, v10
 s_cmp_ge_u32 s57, 27
 s_cbranch_scc1 Lpolld_76
 s_sleep 2
 s_sub_u32 s66, s66, 1
 s_cmp_lg_u32 s66, 0
 s_cbranch_scc1 Lpoll_75
Lpolld_76:
Lpok_74:
 s_add_u32 s55, s81, 0
 buffer_load_dwordx4 v[48:51], v1, s[44:47], s55 offen offset:0 sc1
 buffer_load_dwordx4 v[52:55], v1, s[44:47], s55 offen offset:1024 sc1
 buffer_load_dwordx4 v[56:59], v1, s[44:47], s55 offen offset:2048 sc1
 buffer_load_dwordx4 v[60:63], v1, s[44:47], s55 offen offset:3072 sc1
 v_rcp_f32 v156, v144
 v_rcp_f32 v158, v148
 s_add_u32 s62, s75, 4096
 v_pk_mul_f32 v[160:161], v[160:161], v[156:157] op_sel_hi:[1,0]
 v_pk_mul_f32 v[162:163], v[162:163], v[156:157] op_sel_hi:[1,0]
 v_pk_mul_f32 v[168:169], v[168:169], v[156:157] op_sel_hi:[1,0]
 v_pk_mul_f32 v[170:171], v[170:171], v[156:157] op_sel_hi:[1,0]
 v_cvt_pk_bf16_f32 v224, v160, v161
 v_cvt_pk_bf16_f32 v225, v162, v163
 v_cvt_pk_bf16_f32 v226, v168, v169
 v_cvt_pk_bf16_f32 v227, v170, v171
 v_pk_mul_f32 v[164:165], v[164:165], v[158:159] op_sel_hi:[1,0]
 v_pk_mul_f32 v[166:167], v[166:167], v[158:159] op_sel_hi:[1,0]
 v_pk_mul_f32 v[172:173], v[172:173], v[158:159] op_sel_hi:[1,0]
 v_pk_mul_f32 v[174:175], v[174:175], v[158:159] op_sel_hi:[1,0]
 v_cvt_pk_bf16_f32 v228, v164, v165
 v_cvt_pk_bf16_f32 v229, v166, v167
 v_cvt_pk_bf16_f32 v230, v172, v173
 v_cvt_pk_bf16_f32 v231, v174, v175
 v_pk_mul_f32 v[176:177], v[176:177], v[156:157] op_sel_hi:[1,0]
 v_pk_mul_f32 v[178:179], v[178:179], v[156:157] op_sel_hi:[1,0]
 v_pk_mul_f32 v[184:185], v[184:185], v[156:157] op_sel_hi:[1,0]
 v_pk_mul_f32 v[186:187], v[186:187], v[156:157] op_sel_hi:[1,0]
 v_cvt_pk_bf16_f32 v232, v176, v177
 v_cvt_pk_bf16_f32 v233, v178, v179
 v_cvt_pk_bf16_f32 v234, v184, v185
 v_cvt_pk_bf16_f32 v235, v186, v187
 v_pk_mul_f32 v[180:181], v[180:181], v[158:159] op_sel_hi:[1,0]
 v_pk_mul_f32 v[182:183], v[182:183], v[158:159] op_sel_hi:[1,0]
 v_pk_mul_f32 v[188:189], v[188:189], v[158:159] op_sel_hi:[1,0]
 v_pk_mul_f32 v[190:191], v[190:191], v[158:159] op_sel_hi:[1,0]
 v_cvt_pk_bf16_f32 v236, v180, v181
 v_cvt_pk_bf16_f32 v237, v182, v183
 v_cvt_pk_bf16_f32 v238, v188, v189
 v_cvt_pk_bf16_f32 v239, v190, v191
 v_pk_mul_f32 v[192:193], v[192:193], v[156:157] op_sel_hi:[1,0]
 v_pk_mul_f32 v[194:195], v[194:195], v[156:157] op_sel_hi:[1,0]
 v_pk_mul_f32 v[200:201], v[200:201], v[156:157] op_sel_hi:[1,0]
 v_pk_mul_f32 v[202:203], v[202:203], v[156:157] op_sel_hi:[1,0]
 v_cvt_pk_bf16_f32 v240, v192, v193
 v_cvt_pk_bf16_f32 v241, v194, v195
 v_cvt_pk_bf16_f32 v242, v200, v201
 v_cvt_pk_bf16_f32 v243, v202, v203
 v_pk_mul_f32 v[196:197], v[196:197], v[158:159] op_sel_hi:[1,0]
 v_pk_mul_f32 v[198:199], v[198:199], v[158:159] op_sel_hi:[1,0]
 v_pk_mul_f32 v[204:205], v[204:205], v[158:159] op_sel_hi:[1,0]
 v_pk_mul_f32 v[206:207], v[206:207], v[158:159] op_sel_hi:[1,0]
 v_cvt_pk_bf16_f32 v244, v196, v197
 v_cvt_pk_bf16_f32 v245, v198, v199
 v_cvt_pk_bf16_f32 v246, v204, v205
 v_cvt_pk_bf16_f32 v247, v206, v207
 v_pk_mul_f32 v[208:209], v[208:209], v[156:157] op_sel_hi:[1,0]
 v_pk_mul_f32 v[210:211], v[210:211], v[156:157] op_sel_hi:[1,0]
 v_pk_mul_f32 v[216:217], v[216:217], v[156:157] op_sel_hi:[1,0]
 v_pk_mul_f32 v[218:219], v[218:219], v[156:157] op_sel_hi:[1,0]
 v_cvt_pk_bf16_f32 v248, v208, v209
 v_cvt_pk_bf16_f32 v249, v210, v211
 v_cvt_pk_bf16_f32 v250, v216, v217
 v_cvt_pk_bf16_f32 v251, v218, v219
 v_pk_mul_f32 v[212:213], v[212:213], v[158:159] op_sel_hi:[1,0]
 v_pk_mul_f32 v[214:215], v[214:215], v[158:159] op_sel_hi:[1,0]
 v_pk_mul_f32 v[220:221], v[220:221], v[158:159] op_sel_hi:[1,0]
 v_pk_mul_f32 v[222:223], v[222:223], v[158:159] op_sel_hi:[1,0]
 v_cvt_pk_bf16_f32 v252, v212, v213
 v_cvt_pk_bf16_f32 v253, v214, v215
 v_cvt_pk_bf16_f32 v254, v220, v221
 v_cvt_pk_bf16_f32 v255, v222, v223
 buffer_store_dwordx4 v[224:227], v1, s[44:47], s75 offen offset:0 sc1
 buffer_store_dwordx4 v[228:231], v1, s[44:47], s75 offen offset:1024 sc1
 buffer_store_dwordx4 v[232:235], v1, s[44:47], s75 offen offset:2048 sc1
 buffer_store_dwordx4 v[236:239], v1, s[44:47], s75 offen offset:3072 sc1
 buffer_store_dwordx4 v[240:243], v1, s[44:47], s62 offen offset:0 sc1
 buffer_store_dwordx4 v[244:247], v1, s[44:47], s62 offen offset:1024 sc1
 buffer_store_dwordx4 v[248:251], v1, s[44:47], s62 offen offset:2048 sc1
 buffer_store_dwordx4 v[252:255], v1, s[44:47], s62 offen offset:3072 sc1
 v_mov_b64 v[160:161], 0
 v_mov_b64 v[162:163], 0
 v_mov_b64 v[164:165], 0
 v_mov_b64 v[166:167], 0
 v_mov_b64 v[168:169], 0
 v_mov_b64 v[170:171], 0
 v_mov_b64 v[172:173], 0
 v_mov_b64 v[174:175], 0
 v_mov_b64 v[176:177], 0
 v_mov_b64 v[178:179], 0
 v_mov_b64 v[180:181], 0
 v_mov_b64 v[182:183], 0
 v_mov_b64 v[184:185], 0
 v_mov_b64 v[186:187], 0
 v_mov_b64 v[188:189], 0
 v_mov_b64 v[190:191], 0
 v_mov_b64 v[192:193], 0
 v_mov_b64 v[194:195], 0
 v_mov_b64 v[196:197], 0
 v_mov_b64 v[198:199], 0
 s_cmp_eq_u32 s61, 0
 s_cbranch_scc1 L_att_end2
 s_barrier
L_att_end2:
 v_mov_b32 v5, 132128
 s_barrier
 ds_read_b32 v5, v5
 s_waitcnt lgkmcnt(0)
 v_readfirstlane_b32 s57, v5
 s_cmp_eq_u32 s57, 0
 s_cbranch_scc1 L_att_ok
 s_cmp_lg_u32 s73, 0
 s_cbranch_scc1 L_att_ok
 s_mov_b32 s73, 1
 s_waitcnt vmcnt(0)
 s_barrier
 v_mov_b32 v9, 0xff800000
 v_mov_b32 v13, v1
 v_and_b32 v11, 48, v0
 v_lshrrev_b32 v11, 2, v11
 v_and_b32 v156, 15, v0
 v_sub_u32 v11, v156, v11
 v_mov_b64 v[128:129], 0
 v_mov_b64 v[130:131], 0
 v_mov_b64 v[132:133], 0
 v_mov_b64 v[134:135], 0
 v_mov_b64 v[136:137], 0
 v_mov_b64 v[138:139], 0
 v_mov_b64 v[140:141], 0
 v_mov_b64 v[142:143], 0
 v_mov_b64 v[144:145], 0
 v_mov_b64 v[146:147], 0
 v_mov_b64 v[148:149], 0
 v_mov_b64 v[150:151], 0
 v_mov_b32 v152, 0x3f803f80
 v_mov_b32 v153, 0x3f803f80
 v_mov_b32 v154, 0x3f803f80
 v_mov_b32 v155, 0x3f803f80
 s_cmp_lt_u32 s48, 4
 s_cbranch_scc1 L_att_start
 s_mul_i32 s77, s49, 0x106000
 s_add_u32 s77, s77, 0x960000
 s_and_b32 s57, s48, 3
 s_lshl_b32 s57, s57, 12
 s_add_u32 s77, s77, s57
 s_add_u32 s71, s77, 0x81000
 s_add_u32 s70, s77, 8192
 s_mov_b32 s72, s57
 s_cmp_lt_u32 s57, 8192
 s_cselect_b32 s78, s77, s71
 s_sub_u32 s94, s77, s57
 s_lshl_b32 s57, s50, 15
 s_sub_u32 s94, s94, s57
 s_add_u32 s94, s94, 0x80000
 s_add_u32 s95, s94, 0x83000
 s_add_u32 m0, s72, 0
 s_cmp_lt_u32 s70, s94
 s_cselect_b32 s96, s70, 0x10000000
 buffer_load_dwordx4 v1, s[44:47], s96 offen offset:0 sc1 lds
 buffer_load_dwordx4 v1, s[44:47], s96 offen offset:1024 sc1 lds
 buffer_load_dwordx4 v1, s[44:47], s96 offen offset:2048 sc1 lds
 buffer_load_dwordx4 v1, s[44:47], s96 offen offset:3072 sc1 lds
 s_add_u32 m0, s72, 16384
 s_cmp_lt_u32 s78, s95
 s_cselect_b32 s96, s78, 0x10000000
 buffer_load_dwordx4 v1, s[44:47], s96 offen offset:0 sc1 lds
 buffer_load_dwordx4 v1, s[44:47], s96 offen offset:1024 sc1 lds
 buffer_load_dwordx4 v1, s[44:47], s96 offen offset:2048 sc1 lds
 buffer_load_dwordx4 v1, s[44:47], s96 offen offset:3072 sc1 lds
 s_add_u32 s70, s70, 16384
 s_add_u32 s71, s71, 16384
 s_add_u32 s72, s72, 32768
 s_and_b32 s72, s72, 0x1ffff
 s_add_u32 m0, s72, 0
 s_cmp_lt_u32 s70, s94
 s_cselect_b32 s96, s70, 0x10000000
 buffer_load_dwordx4 v1, s[44:47], s96 offen offset:0 sc1 lds
 buffer_load_dwordx4 v1, s[44:47], s96 offen offset:1024 sc1 lds
 buffer_load_dwordx4 v1, s[44:47], s96 offen offset:2048 sc1 lds
 buffer_load_dwordx4 v1, s[44:47], s96 offen offset:3072 sc1 lds
 s_add_u32 m0, s72, 16384
 s_cmp_lt_u32 s71, s95
 s_cselect_b32 s96, s71, 0x10000000
 buffer_load_dwordx4 v1, s[44:47], s96 offen offset:0 sc1 lds
 buffer_load_dwordx4 v1, s[44:47], s96 offen offset:1024 sc1 lds
 buffer_load_dwordx4 v1, s[44:47], s96 offen offset:2048 sc1 lds
 buffer_load_dwordx4 v1, s[44:47], s96 offen offset:3072 sc1 lds
 s_add_u32 s70, s70, 16384
 s_add_u32 s71, s71, 16384
 s_add_u32 s72, s72, 32768
 s_and_b32 s72, s72, 0x1ffff
 s_add_u32 m0, s72, 0
 s_cmp_lt_u32 s70, s94
 s_cselect_b32 s96, s70, 0x10000000
 buffer_load_dwordx4 v1, s[44:47], s96 offen offset:0 sc1 lds
 buffer_load_dwordx4 v1, s[44:47], s96 offen offset:1024 sc1 lds
 buffer_load_dwordx4 v1, s[44:47], s96 offen offset:2048 sc1 lds
 buffer_load_dwordx4 v1, s[44:47], s96 offen offset:3072 sc1 lds
 s_add_u32 m0, s72, 16384
 s_cmp_lt_u32 s71, s95
 s_cselect_b32 s96, s71, 0x10000000
 buffer_load_dwordx4 v1, s[44:47], s96 offen offset:0 sc1 lds
 buffer_load_dwordx4 v1, s[44:47], s96 offen offset:1024 sc1 lds
 buffer_load_dwordx4 v1, s[44:47], s96 offen offset:2048 sc1 lds
 buffer_load_dwordx4 v1, s[44:47], s96 offen offset:3072 sc1 lds
 s_add_u32 s70, s70, 16384
 s_add_u32 s71, s71, 16384
 s_add_u32 s72, s72, 32768
 s_and_b32 s72, s72, 0x1ffff
 s_branch L_att_start
L_att_ok:
 s_lshl_b32 s76, s51, 1
 s_lshr_b32 s57, s49, 4
 s_add_u32 s76, s76, s57
 s_lshl_b32 s76, s76, 1
 s_add_u32 s76, s76, s80
 s_lshl_b32 s76, s76, 7
 s_add_u32 s76, s76, 12288
L_pub2:
 s_cmp_ge_u32 s48, 4
 s_cbranch_scc1 L_p3_S
 s_lshl_b32 s57, s80, 4
 s_add_u32 s57, s57, s87
 s_cmp_eq_u32 s57, 24
 s_cbranch_scc1 L_p3_L1_8
L_p3_L0_8:
 s_add_u32 s54, s83, s85
 s_add_u32 s54, s54, 0x5000
 s_add_u32 m0, s85, 0
 s_nop 0
 buffer_load_dwordx4 v1, s[44:47], s54 offen offset:0 sc1 lds
 buffer_load_dwordx4 v1, s[44:47], s54 offen offset:1024 sc1 lds
 s_waitcnt vmcnt(2)
 v_mov_b32 v5, 1
 s_mov_b64 exec, 1
 buffer_atomic_add v5, v4, s[44:47], s76 offen
 s_mov_b64 exec, -1
 s_add_u32 s55, s81, 8192
 buffer_load_dwordx4 v[64:67], v1, s[44:47], s55 offen offset:0 sc1
 buffer_load_dwordx4 v[68:71], v1, s[44:47], s55 offen offset:1024 sc1
 buffer_load_dwordx4 v[72:75], v1, s[44:47], s55 offen offset:2048 sc1
 buffer_load_dwordx4 v[76:79], v1, s[44:47], s55 offen offset:3072 sc1
 s_barrier
 TR 16,7,0
 TR 18,7,2560
 TR 20,7,32
 TR 22,7,2592
 TR 24,7,64
 TR 26,7,2624
 TR 28,7,96
 TR 30,7,2656
 TR 32,7,128
 TR 34,7,2688
 s_waitcnt lgkmcnt(8)
 MF 160,16,48,160
 TR 36,7,5120
 MF 164,16,52,164
 TR 38,7,7680
 s_add_u32 s54, s83, s85
 s_add_u32 s54, s54, 0xa000
 s_add_u32 m0, s85, 20480
 s_nop 0
 buffer_load_dwordx4 v1, s[44:47], s54 offen offset:0 sc1 lds
 buffer_load_dwordx4 v1, s[44:47], s54 offen offset:1024 sc1 lds
 s_waitcnt lgkmcnt(8)
 MF 168,20,48,168
 TR 40,7,5152
 MF 172,20,52,172
 TR 42,7,7712
 s_add_u32 s55, s81, 16384
 buffer_load_dwordx4 v[80:83], v1, s[44:47], s55 offen offset:0 sc1
 buffer_load_dwordx4 v[84:87], v1, s[44:47], s55 offen offset:1024 sc1
 s_waitcnt lgkmcnt(8)
 MF 176,24,48,176
 TR 44,7,5184
 MF 180,24,52,180
 TR 46,7,7744
 buffer_load_dwordx4 v[88:91], v1, s[44:47], s55 offen offset:2048 sc1
 buffer_load_dwordx4 v[92:95], v1, s[44:47], s55 offen offset:3072 sc1
 s_waitcnt lgkmcnt(8)
 MF 184,28,48,184
 TR 16,7,5216
 MF 188,28,52,188
 TR 18,7,7776
 s_add_u32 s55, s81, 32768
 buffer_load_dwordx4 v[112:115], v1, s[44:47], s55 offen offset:0 sc1
 buffer_load_dwordx4 v[116:119], v1, s[44:47], s55 offen offset:1024 sc1
 s_waitcnt lgkmcnt(8)
 MF 192,32,48,192
 TR 20,7,5248
 MF 196,32,52,196
 TR 22,7,7808
 buffer_load_dwordx4 v[120:123], v1, s[44:47], s55 offen offset:2048 sc1
 buffer_load_dwordx4 v[124:127], v1, s[44:47], s55 offen offset:3072 sc1
 s_waitcnt lgkmcnt(8)
 MF 160,36,56,160
 s_waitcnt vmcnt(15)
 s_barrier
 v_add_u32 v7, 0xfffdd000, v7
 TR 24,7,0
 MF 164,36,60,164
 TR 26,7,2560
 s_add_u32 s54, s83, s85
 s_add_u32 s54, s54, 0x19000
 s_add_u32 m0, s85, 81920
 s_nop 0
 buffer_load_dwordx4 v1, s[44:47], s54 offen offset:0 sc1 lds
 s_waitcnt lgkmcnt(8)
 MF 168,40,56,168
 TR 28,7,32
 MF 172,40,60,172
 TR 30,7,2592
 buffer_load_dwordx4 v1, s[44:47], s54 offen offset:1024 sc1 lds
 s_waitcnt lgkmcnt(8)
 MF 176,44,56,176
 TR 32,7,64
 MF 180,44,60,180
 TR 34,7,2624
 s_waitcnt lgkmcnt(8)
 MF 184,16,56,184
 TR 36,7,96
 MF 188,16,60,188
 TR 38,7,2656
 s_waitcnt lgkmcnt(8)
 MF 192,20,56,192
 TR 40,7,128
 MF 196,20,60,196
 TR 42,7,2688
 s_waitcnt lgkmcnt(8)
 s_waitcnt vmcnt(14)
 MF 160,24,64,160
 TR 44,7,5120
 MF 164,24,68,164
 TR 46,7,7680
 s_add_u32 s54, s83, s85
 s_add_u32 s54, s54, 0xf000
 s_add_u32 m0, s85, 40960
 s_nop 0
 buffer_load_dwordx4 v1, s[44:47], s54 offen offset:0 sc1 lds
 buffer_load_dwordx4 v1, s[44:47], s54 offen offset:1024 sc1 lds
 s_waitcnt lgkmcnt(8)
 MF 168,28,64,168
 TR 16,7,5152
 MF 172,28,68,172
 TR 18,7,7712
 s_add_u32 s55, s81, 24576
 buffer_load_dwordx4 v[96:99], v1, s[44:47], s55 offen offset:0 sc1
 buffer_load_dwordx4 v[100:103], v1, s[44:47], s55 offen offset:1024 sc1
 s_waitcnt lgkmcnt(8)
 MF 176,32,64,176
 TR 20,7,5184
 MF 180,32,68,180
 TR 22,7,7744
 buffer_load_dwordx4 v[104:107], v1, s[44:47], s55 offen offset:2048 sc1
 buffer_load_dwordx4 v[108:111], v1, s[44:47], s55 offen offset:3072 sc1
 s_waitcnt lgkmcnt(8)
 MF 184,36,64,184
 TR 24,7,5216
 MF 188,36,68,188
 TR 26,7,7776
 s_add_u32 s55, s81, 40960
 buffer_load_dwordx4 v[48:51], v1, s[44:47], s55 offen offset:0 sc1
 buffer_load_dwordx4 v[52:55], v1, s[44:47], s55 offen offset:1024 sc1
 s_waitcnt lgkmcnt(8)
 MF 192,40,64,192
 TR 28,7,5248
 MF 196,40,68,196
 TR 30,7,7808
 buffer_load_dwordx4 v[56:59], v1, s[44:47], s55 offen offset:2048 sc1
 buffer_load_dwordx4 v[60:63], v1, s[44:47], s55 offen offset:3072 sc1
 s_waitcnt lgkmcnt(8)
 s_waitcnt vmcnt(22)
 MF 160,44,72,160
 s_waitcnt vmcnt(20)
 s_barrier
 v_add_u32 v7, 0x5000, v7
 TR 32,7,0
 MF 164,44,76,164
 TR 34,7,2560
 s_add_u32 s54, s83, s85
 s_add_u32 s54, s54, 0x1e000
 s_add_u32 m0, s85, 102400
 s_nop 0
 buffer_load_dwordx4 v1, s[44:47], s54 offen offset:0 sc1 lds
 s_waitcnt lgkmcnt(8)
 MF 168,16,72,168
 TR 36,7,32
 MF 172,16,76,172
 TR 38,7,2592
 buffer_load_dwordx4 v1, s[44:47], s54 offen offset:1024 sc1 lds
 s_waitcnt lgkmcnt(8)
 MF 176,20,72,176
 TR 40,7,64
 MF 180,20,76,180
 TR 42,7,2624
 s_waitcnt lgkmcnt(8)
 MF 184,24,72,184
 TR 44,7,96
 MF 188,24,76,188
 TR 46,7,2656
 s_waitcnt lgkmcnt(8)
 MF 192,28,72,192
 TR 16,7,128
 MF 196,28,76,196
 TR 18,7,2688
 s_waitcnt lgkmcnt(8)
 s_waitcnt vmcnt(20)
 MF 160,32,80,160
 TR 20,7,5120
 MF 164,32,84,164
 TR 22,7,7680
 s_add_u32 s54, s83, s85
 s_add_u32 s54, s54, 0x14000
 s_add_u32 m0, s85, 61440
 s_nop 0
 buffer_load_dwordx4 v1, s[44:47], s54 offen offset:0 sc1 lds
 buffer_load_dwordx4 v1, s[44:47], s54 offen offset:1024 sc1 lds
 s_waitcnt lgkmcnt(8)
 MF 168,36,80,168
 TR 24,7,5152
 MF 172,36,84,172
 TR 26,7,7712
 s_add_u32 s55, s81, 49152
 buffer_load_dwordx4 v[64:67], v1, s[44:47], s55 offen offset:0 sc1
 s_waitcnt lgkmcnt(8)
 MF 176,40,80,176
 TR 28,7,5184
 MF 180,40,84,180
 TR 30,7,7744
 buffer_load_dwordx4 v[68:71], v1, s[44:47], s55 offen offset:1024 sc1
 s_waitcnt lgkmcnt(8)
 MF 184,44,80,184
 TR 32,7,5216
 MF 188,44,84,188
 TR 34,7,7776
 buffer_load_dwordx4 v[72:75], v1, s[44:47], s55 offen offset:2048 sc1
 s_waitcnt lgkmcnt(8)
 MF 192,16,80,192
 TR 36,7,5248
 MF 196,16,84,196
 TR 38,7,7808
 buffer_load_dwordx4 v[76:79], v1, s[44:47], s55 offen offset:3072 sc1
 s_waitcnt lgkmcnt(8)
 s_waitcnt vmcnt(24)
 MF 160,20,88,160
 s_waitcnt vmcnt(16)
 s_barrier
 v_add_u32 v7, 0x5000, v7
 TR 40,7,0
 MF 164,20,92,164
 TR 42,7,2560
 s_add_u32 s54, s83, s85
 s_add_u32 s54, s54, 0x23000
 s_add_u32 m0, s85, 122880
 s_nop 0
 buffer_load_dwordx4 v1, s[44:47], s54 offen offset:0 sc1 lds
 s_waitcnt lgkmcnt(8)
 MF 168,24,88,168
 TR 44,7,32
 MF 172,24,92,172
 TR 46,7,2592
 buffer_load_dwordx4 v1, s[44:47], s54 offen offset:1024 sc1 lds
 s_waitcnt lgkmcnt(8)
 MF 176,28,88,176
 TR 16,7,64
 MF 180,28,92,180
 TR 18,7,2624
 s_waitcnt lgkmcnt(8)
 MF 184,32,88,184
 TR 20,7,96
 MF 188,32,92,188
 TR 22,7,2656
 s_waitcnt lgkmcnt(8)
 MF 192,36,88,192
 TR 24,7,128
 MF 196,36,92,196
 TR 26,7,2688
 s_waitcnt lgkmcnt(8)
 s_waitcnt vmcnt(16)
 MF 160,40,96,160
 TR 28,7,5120
 MF 164,40,100,164
 TR 30,7,7680
 s_add_u32 s55, s81, 57344
 buffer_load_dwordx4 v[80:83], v1, s[44:47], s55 offen offset:0 sc1
 s_waitcnt lgkmcnt(8)
 MF 168,44,96,168
 TR 32,7,5152
 MF 172,44,100,172
 TR 34,7,7712
 buffer_load_dwordx4 v[84:87], v1, s[44:47], s55 offen offset:1024 sc1
 s_waitcnt lgkmcnt(8)
 MF 176,16,96,176
 TR 36,7,5184
 MF 180,16,100,180
 TR 38,7,7744
 buffer_load_dwordx4 v[88:91], v1, s[44:47], s55 offen offset:2048 sc1
 s_waitcnt lgkmcnt(8)
 MF 184,20,96,184
 TR 40,7,5216
 MF 188,20,100,188
 TR 42,7,7776
 buffer_load_dwordx4 v[92:95], v1, s[44:47], s55 offen offset:3072 sc1
 s_waitcnt lgkmcnt(8)
 MF 192,24,96,192
 TR 44,7,5248
 MF 196,24,100,196
 TR 46,7,7808
 s_waitcnt lgkmcnt(8)
 s_waitcnt vmcnt(18)
 MF 160,28,104,160
 s_waitcnt vmcnt(10)
 s_barrier
 buffer_load_dword v10, v4, s[44:47], s86 offen sc1
 v_add_u32 v7, 0x5000, v7
 TR 16,7,0
 MF 164,28,108,164
 TR 18,7,2560
 s_add_u32 s54, s84, s85
 s_add_u32 m0, s85, 143360
 s_nop 0
 buffer_load_dwordx4 v1, s[44:47], s54 offen offset:0 sc1 lds
 s_waitcnt lgkmcnt(8)
 MF 168,32,104,168
 TR 20,7,32
 MF 172,32,108,172
 TR 22,7,2592
 buffer_load_dwordx4 v1, s[44:47], s54 offen offset:1024 sc1 lds
 s_waitcnt lgkmcnt(8)
 MF 176,36,104,176
 TR 24,7,64
 MF 180,36,108,180
 TR 26,7,2624
 s_waitcnt lgkmcnt(8)
 MF 184,40,104,184
 TR 28,7,96
 MF 188,40,108,188
 TR 30,7,2656
 s_waitcnt lgkmcnt(8)
 MF 192,44,104,192
 TR 32,7,128
 MF 196,44,108,196
 TR 34,7,2688
 s_waitcnt lgkmcnt(8)
 MF 160,16,112,160
 TR 36,7,5120
 MF 164,16,116,164
 TR 38,7,7680
 s_waitcnt lgkmcnt(8)
 MF 168,20,112,168
 TR 40,7,5152
 MF 172,20,116,172
 TR 42,7,7712
 s_waitcnt lgkmcnt(8)
 MF 176,24,112,176
 TR 44,7,5184
 MF 180,24,116,180
 TR 46,7,7744
 s_waitcnt lgkmcnt(8)
 MF 184,28,112,184
 TR 16,7,5216
 MF 188,28,116,188
 TR 18,7,7776
 s_waitcnt lgkmcnt(8)
 MF 192,32,112,192
 TR 20,7,5248
 MF 196,32,116,196
 TR 22,7,7808
 s_waitcnt lgkmcnt(8)
 MF 160,36,120,160
 s_waitcnt vmcnt(2)
 v_readfirstlane_b32 s57, v10
 s_cmp_ge_u32 s57, 8
 s_cbranch_scc1 Lpok_77
 s_mov_b32 s66, 0x10000
Lpoll_78:
 buffer_load_dword v10, v4, s[44:47], s86 offen sc1
 s_waitcnt vmcnt(0)
 v_readfirstlane_b32 s57, v10
 s_cmp_ge_u32 s57, 8
 s_cbranch_scc1 Lpolld_79
 s_sleep 2
 s_sub_u32 s66, s66, 1
 s_cmp_lg_u32 s66, 0
 s_cbranch_scc1 Lpoll_78
Lpolld_79:
Lpok_77:
 s_barrier
 v_add_u32 v7, 0x5000, v7
 TR 24,7,0
 MF 164,36,124,164
 TR 26,7,2560
 s_add_u32 s54, s84, s85
 s_add_u32 s54, s54, 0x5000
 s_add_u32 m0, s85, 0
 s_nop 0
 buffer_load_dwordx4 v1, s[44:47], s54 offen offset:0 sc1 lds
 s_waitcnt lgkmcnt(8)
 MF 168,40,120,168
 TR 28,7,32
 MF 172,40,124,172
 TR 30,7,2592
 buffer_load_dwordx4 v1, s[44:47], s54 offen offset:1024 sc1 lds
 s_waitcnt lgkmcnt(8)
 MF 176,44,120,176
 TR 32,7,64
 MF 180,44,124,180
 TR 34,7,2624
 s_waitcnt lgkmcnt(8)
 MF 184,16,120,184
 TR 36,7,96
 MF 188,16,124,188
 TR 38,7,2656
 s_waitcnt lgkmcnt(8)
 MF 192,20,120,192
 TR 40,7,128
 MF 196,20,124,196
 TR 42,7,2688
 s_waitcnt lgkmcnt(8)
 MF 160,24,48,160
 TR 44,7,5120
 MF 164,24,52,164
 TR 46,7,7680
 s_add_u32 s55, s82, 0
 buffer_load_dwordx4 v[96:99], v1, s[44:47], s55 offen offset:0 sc1
 buffer_load_dwordx4 v[100:103], v1, s[44:47], s55 offen offset:1024 sc1
 s_waitcnt lgkmcnt(8)
 MF 168,28,48,168
 TR 16,7,5152
 MF 172,28,52,172
 TR 18,7,7712
 buffer_load_dwordx4 v[104:107], v1, s[44:47], s55 offen offset:2048 sc1
 buffer_load_dwordx4 v[108:111], v1, s[44:47], s55 offen offset:3072 sc1
 s_waitcnt lgkmcnt(8)
 MF 176,32,48,176
 TR 20,7,5184
 MF 180,32,52,180
 TR 22,7,7744
 s_add_u32 s55, s82, 8192
 buffer_load_dwordx4 v[112:115], v1, s[44:47], s55 offen offset:0 sc1
 s_waitcnt lgkmcnt(8)
 MF 184,36,48,184
 TR 24,7,5216
 MF 188,36,52,188
 TR 26,7,7776
 buffer_load_dwordx4 v[116:119], v1, s[44:47], s55 offen offset:1024 sc1
 buffer_load_dwordx4 v[120:123], v1, s[44:47], s55 offen offset:2048 sc1
 s_waitcnt lgkmcnt(8)
 MF 192,40,48,192
 TR 28,7,5248
 MF 196,40,52,196
 TR 30,7,7808
 buffer_load_dwordx4 v[124:127], v1, s[44:47], s55 offen offset:3072 sc1
 s_waitcnt lgkmcnt(8)
 MF 160,44,56,160
 s_barrier
 v_add_u32 v7, 0x5000, v7
 TR 32,7,0
 MF 164,44,60,164
 TR 34,7,2560
 s_add_u32 s54, s84, s85
 s_add_u32 s54, s54, 0xa000
 s_add_u32 m0, s85, 20480
 s_nop 0
 buffer_load_dwordx4 v1, s[44:47], s54 offen offset:0 sc1 lds
 s_waitcnt lgkmcnt(8)
 MF 168,16,56,168
 TR 36,7,32
 MF 172,16,60,172
 TR 38,7,2592
 buffer_load_dwordx4 v1, s[44:47], s54 offen offset:1024 sc1 lds
 s_waitcnt lgkmcnt(8)
 MF 176,20,56,176
 TR 40,7,64
 MF 180,20,60,180
 TR 42,7,2624
 s_waitcnt lgkmcnt(8)
 MF 184,24,56,184
 TR 44,7,96
 MF 188,24,60,188
 TR 46,7,2656
 s_waitcnt lgkmcnt(8)
 MF 192,28,56,192
 TR 16,7,128
 MF 196,28,60,196
 TR 18,7,2688
 s_waitcnt lgkmcnt(8)
 MF 160,32,64,160
 TR 20,7,5120
 MF 164,32,68,164
 TR 22,7,7680
 s_add_u32 s55, s82, 16384
 buffer_load_dwordx4 v[48:51], v1, s[44:47], s55 offen offset:0 sc1
 s_waitcnt lgkmcnt(8)
 MF 168,36,64,168
 TR 24,7,5152
 MF 172,36,68,172
 TR 26,7,7712
 buffer_load_dwordx4 v[52:55], v1, s[44:47], s55 offen offset:1024 sc1
 s_waitcnt lgkmcnt(8)
 MF 176,40,64,176
 TR 28,7,5184
 MF 180,40,68,180
 TR 30,7,7744
 buffer_load_dwordx4 v[56:59], v1, s[44:47], s55 offen offset:2048 sc1
 s_waitcnt lgkmcnt(8)
 MF 184,44,64,184
 TR 32,7,5216
 MF 188,44,68,188
 TR 34,7,7776
 buffer_load_dwordx4 v[60:63], v1, s[44:47], s55 offen offset:3072 sc1
 s_waitcnt lgkmcnt(8)
 MF 192,16,64,192
 TR 36,7,5248
 MF 196,16,68,196
 TR 38,7,7808
 s_waitcnt lgkmcnt(8)
 MF 160,20,72,160
 s_barrier
 v_add_u32 v7, 0x5000, v7
 TR 40,7,0
 MF 164,20,76,164
 TR 42,7,2560
 s_add_u32 s54, s84, s85
 s_add_u32 s54, s54, 0xf000
 s_add_u32 m0, s85, 40960
 s_nop 0
 buffer_load_dwordx4 v1, s[44:47], s54 offen offset:0 sc1 lds
 s_waitcnt lgkmcnt(8)
 MF 168,24,72,168
 TR 44,7,32
 MF 172,24,76,172
 TR 46,7,2592
 buffer_load_dwordx4 v1, s[44:47], s54 offen offset:1024 sc1 lds
 s_waitcnt lgkmcnt(8)
 MF 176,28,72,176
 TR 16,7,64
 MF 180,28,76,180
 TR 18,7,2624
 s_waitcnt lgkmcnt(8)
 MF 184,32,72,184
 TR 20,7,96
 MF 188,32,76,188
 TR 22,7,2656
 s_waitcnt lgkmcnt(8)
 MF 192,36,72,192
 TR 24,7,128
 MF 196,36,76,196
 TR 26,7,2688
 s_waitcnt lgkmcnt(8)
 MF 160,40,80,160
 TR 28,7,5120
 MF 164,40,84,164
 TR 30,7,7680
 s_add_u32 s55, s82, 24576
 buffer_load_dwordx4 v[64:67], v1, s[44:47], s55 offen offset:0 sc1
 s_waitcnt lgkmcnt(8)
 MF 168,44,80,168
 TR 32,7,5152
 MF 172,44,84,172
 TR 34,7,7712
 buffer_load_dwordx4 v[68:71], v1, s[44:47], s55 offen offset:1024 sc1
 s_waitcnt lgkmcnt(8)
 MF 176,16,80,176
 TR 36,7,5184
 MF 180,16,84,180
 TR 38,7,7744
 buffer_load_dwordx4 v[72:75], v1, s[44:47], s55 offen offset:2048 sc1
 s_waitcnt lgkmcnt(8)
 MF 184,20,80,184
 TR 40,7,5216
 MF 188,20,84,188
 TR 42,7,7776
 buffer_load_dwordx4 v[76:79], v1, s[44:47], s55 offen offset:3072 sc1
 s_waitcnt lgkmcnt(8)
 MF 192,24,80,192
 TR 44,7,5248
 MF 196,24,84,196
 TR 46,7,7808
 s_waitcnt lgkmcnt(8)
 MF 160,28,88,160
 s_waitcnt vmcnt(22)
 s_barrier
 v_add_u32 v7, 0x5000, v7
 TR 16,7,0
 MF 164,28,92,164
 TR 18,7,2560
 s_add_u32 s54, s84, s85
 s_add_u32 s54, s54, 0x28000
 s_add_u32 m0, s85, 61440
 s_nop 0
 buffer_load_dwordx4 v1, s[44:47], s54 offen offset:0 sc1 lds
 s_waitcnt lgkmcnt(8)
 MF 168,32,88,168
 TR 20,7,32
 MF 172,32,92,172
 TR 22,7,2592
 buffer_load_dwordx4 v1, s[44:47], s54 offen offset:1024 sc1 lds
 s_waitcnt lgkmcnt(8)
 MF 176,36,88,176
 TR 24,7,64
 MF 180,36,92,180
 TR 26,7,2624
 s_waitcnt lgkmcnt(8)
 MF 184,40,88,184
 TR 28,7,96
 MF 188,40,92,188
 TR 30,7,2656
 s_waitcnt lgkmcnt(8)
 MF 192,44,88,192
 TR 32,7,128
 MF 196,44,92,196
 TR 34,7,2688
 s_waitcnt lgkmcnt(8)
 s_waitcnt vmcnt(20)
 MF 160,16,96,160
 TR 36,7,5120
 MF 164,16,100,164
 TR 38,7,7680
 s_add_u32 s55, s82, 65536
 buffer_load_dwordx4 v[80:83], v1, s[44:47], s55 offen offset:0 sc1
 s_waitcnt lgkmcnt(8)
 MF 168,20,96,168
 TR 40,7,5152
 MF 172,20,100,172
 TR 42,7,7712
 buffer_load_dwordx4 v[84:87], v1, s[44:47], s55 offen offset:1024 sc1
 s_waitcnt lgkmcnt(8)
 MF 176,24,96,176
 TR 44,7,5184
 MF 180,24,100,180
 TR 46,7,7744
 buffer_load_dwordx4 v[88:91], v1, s[44:47], s55 offen offset:2048 sc1
 s_waitcnt lgkmcnt(8)
 MF 184,28,96,184
 TR 16,7,5216
 MF 188,28,100,188
 TR 18,7,7776
 buffer_load_dwordx4 v[92:95], v1, s[44:47], s55 offen offset:3072 sc1
 s_waitcnt lgkmcnt(8)
 MF 192,32,96,192
 TR 20,7,5248
 MF 196,32,100,196
 TR 22,7,7808
 s_waitcnt lgkmcnt(8)
 s_waitcnt vmcnt(22)
 MF 160,36,104,160
 s_barrier
 v_add_u32 v7, 0xfffdd000, v7
 TR 24,7,0
 MF 164,36,108,164
 TR 26,7,2560
 s_add_u32 s54, s84, s85
 s_add_u32 s54, s54, 0x2d000
 s_add_u32 m0, s85, 81920
 s_nop 0
 buffer_load_dwordx4 v1, s[44:47], s54 offen offset:0 sc1 lds
 s_waitcnt lgkmcnt(8)
 MF 168,40,104,168
 TR 28,7,32
 MF 172,40,108,172
 TR 30,7,2592
 buffer_load_dwordx4 v1, s[44:47], s54 offen offset:1024 sc1 lds
 s_waitcnt lgkmcnt(8)
 MF 176,44,104,176
 TR 32,7,64
 MF 180,44,108,180
 TR 34,7,2624
 s_waitcnt lgkmcnt(8)
 MF 184,16,104,184
 TR 36,7,96
 MF 188,16,108,188
 TR 38,7,2656
 s_waitcnt lgkmcnt(8)
 MF 192,20,104,192
 TR 40,7,128
 MF 196,20,108,196
 TR 42,7,2688
 s_waitcnt lgkmcnt(8)
 s_waitcnt vmcnt(22)
 MF 160,24,112,160
 TR 44,7,5120
 MF 164,24,116,164
 TR 46,7,7680
 s_add_u32 s55, s82, 73728
 buffer_load_dwordx4 v[96:99], v1, s[44:47], s55 offen offset:0 sc1
 s_waitcnt lgkmcnt(8)
 MF 168,28,112,168
 TR 16,7,5152
 MF 172,28,116,172
 TR 18,7,7712
 buffer_load_dwordx4 v[100:103], v1, s[44:47], s55 offen offset:1024 sc1
 s_waitcnt lgkmcnt(8)
 MF 176,32,112,176
 TR 20,7,5184
 MF 180,32,116,180
 TR 22,7,7744
 buffer_load_dwordx4 v[104:107], v1, s[44:47], s55 offen offset:2048 sc1
 s_waitcnt lgkmcnt(8)
 MF 184,36,112,184
 TR 24,7,5216
 MF 188,36,116,188
 TR 26,7,7776
 buffer_load_dwordx4 v[108:111], v1, s[44:47], s55 offen offset:3072 sc1
 s_waitcnt lgkmcnt(8)
 MF 192,40,112,192
 TR 28,7,5248
 MF 196,40,116,196
 TR 30,7,7808
 s_waitcnt lgkmcnt(8)
 s_waitcnt vmcnt(24)
 MF 160,44,120,160
 s_waitcnt vmcnt(22)
 s_barrier
 v_add_u32 v7, 0x5000, v7
 TR 32,7,0
 MF 164,44,124,164
 TR 34,7,2560
 s_add_u32 s54, s84, s85
 s_add_u32 s54, s54, 0x32000
 s_add_u32 m0, s85, 102400
 s_nop 0
 buffer_load_dwordx4 v1, s[44:47], s54 offen offset:0 sc1 lds
 s_waitcnt lgkmcnt(8)
 MF 168,16,120,168
 TR 36,7,32
 MF 172,16,124,172
 TR 38,7,2592
 buffer_load_dwordx4 v1, s[44:47], s54 offen offset:1024 sc1 lds
 s_waitcnt lgkmcnt(8)
 MF 176,20,120,176
 TR 40,7,64
 MF 180,20,124,180
 TR 42,7,2624
 s_waitcnt lgkmcnt(8)
 MF 184,24,120,184
 TR 44,7,96
 MF 188,24,124,188
 TR 46,7,2656
 s_waitcnt lgkmcnt(8)
 MF 192,28,120,192
 TR 16,7,128
 MF 196,28,124,196
 TR 18,7,2688
 s_waitcnt lgkmcnt(8)
 s_waitcnt vmcnt(22)
 MF 160,32,48,160
 TR 20,7,5120
 MF 164,32,52,164
 TR 22,7,7680
 s_add_u32 s55, s82, 81920
 buffer_load_dwordx4 v[112:115], v1, s[44:47], s55 offen offset:0 sc1
 s_waitcnt lgkmcnt(8)
 MF 168,36,48,168
 TR 24,7,5152
 MF 172,36,52,172
 TR 26,7,7712
 buffer_load_dwordx4 v[116:119], v1, s[44:47], s55 offen offset:1024 sc1
 s_waitcnt lgkmcnt(8)
 MF 176,40,48,176
 TR 28,7,5184
 MF 180,40,52,180
 TR 30,7,7744
 buffer_load_dwordx4 v[120:123], v1, s[44:47], s55 offen offset:2048 sc1
 s_waitcnt lgkmcnt(8)
 MF 184,44,48,184
 TR 32,7,5216
 MF 188,44,52,188
 TR 34,7,7776
 buffer_load_dwordx4 v[124:127], v1, s[44:47], s55 offen offset:3072 sc1
 s_waitcnt lgkmcnt(8)
 MF 192,16,48,192
 TR 36,7,5248
 MF 196,16,52,196
 TR 38,7,7808
 s_waitcnt lgkmcnt(8)
 s_waitcnt vmcnt(24)
 MF 160,20,56,160
 s_waitcnt vmcnt(22)
 s_barrier
 v_add_u32 v7, 0x5000, v7
 TR 40,7,0
 MF 164,20,60,164
 TR 42,7,2560
 s_add_u32 s54, s84, s85
 s_add_u32 s54, s54, 0x37000
 s_add_u32 m0, s85, 122880
 s_nop 0
 buffer_load_dwordx4 v1, s[44:47], s54 offen offset:0 sc1 lds
 s_waitcnt lgkmcnt(8)
 MF 168,24,56,168
 TR 44,7,32
 MF 172,24,60,172
 TR 46,7,2592
 buffer_load_dwordx4 v1, s[44:47], s54 offen offset:1024 sc1 lds
 s_waitcnt lgkmcnt(8)
 MF 176,28,56,176
 TR 16,7,64
 MF 180,28,60,180
 TR 18,7,2624
 s_waitcnt lgkmcnt(8)
 MF 184,32,56,184
 TR 20,7,96
 MF 188,32,60,188
 TR 22,7,2656
 s_waitcnt lgkmcnt(8)
 MF 192,36,56,192
 TR 24,7,128
 MF 196,36,60,196
 TR 26,7,2688
 s_waitcnt lgkmcnt(8)
 s_waitcnt vmcnt(22)
 MF 160,40,64,160
 TR 28,7,5120
 MF 164,40,68,164
 TR 30,7,7680
 s_add_u32 s55, s82, 90112
 buffer_load_dwordx4 v[48:51], v1, s[44:47], s55 offen offset:0 sc1
 s_waitcnt lgkmcnt(8)
 MF 168,44,64,168
 TR 32,7,5152
 MF 172,44,68,172
 TR 34,7,7712
 buffer_load_dwordx4 v[52:55], v1, s[44:47], s55 offen offset:1024 sc1
 s_waitcnt lgkmcnt(8)
 MF 176,16,64,176
 TR 36,7,5184
 MF 180,16,68,180
 TR 38,7,7744
 buffer_load_dwordx4 v[56:59], v1, s[44:47], s55 offen offset:2048 sc1
 s_waitcnt lgkmcnt(8)
 MF 184,20,64,184
 TR 40,7,5216
 MF 188,20,68,188
 TR 42,7,7776
 buffer_load_dwordx4 v[60:63], v1, s[44:47], s55 offen offset:3072 sc1
 s_waitcnt lgkmcnt(8)
 MF 192,24,64,192
 TR 44,7,5248
 MF 196,24,68,196
 TR 46,7,7808
 s_waitcnt lgkmcnt(8)
 s_waitcnt vmcnt(24)
 MF 160,28,72,160
 s_waitcnt vmcnt(22)
 s_barrier
 s_add_u32 s86, s86, 128
 buffer_load_dword v10, v4, s[44:47], s86 offen sc1
 v_add_u32 v7, 0x5000, v7
 TR 16,7,0
 MF 164,28,76,164
 TR 18,7,2560
 s_add_u32 s54, s84, s85
 s_add_u32 s54, s54, 0x14000
 s_add_u32 m0, s85, 143360
 s_nop 0
 buffer_load_dwordx4 v1, s[44:47], s54 offen offset:0 sc1 lds
 s_waitcnt lgkmcnt(8)
 MF 168,32,72,168
 TR 20,7,32
 MF 172,32,76,172
 TR 22,7,2592
 buffer_load_dwordx4 v1, s[44:47], s54 offen offset:1024 sc1 lds
 s_waitcnt lgkmcnt(8)
 MF 176,36,72,176
 TR 24,7,64
 MF 180,36,76,180
 TR 26,7,2624
 s_waitcnt lgkmcnt(8)
 MF 184,40,72,184
 TR 28,7,96
 MF 188,40,76,188
 TR 30,7,2656
 s_waitcnt lgkmcnt(8)
 MF 192,44,72,192
 TR 32,7,128
 MF 196,44,76,196
 TR 34,7,2688
 s_waitcnt lgkmcnt(8)
 s_waitcnt vmcnt(23)
 MF 160,16,80,160
 TR 36,7,5120
 MF 164,16,84,164
 TR 38,7,7680
 s_waitcnt lgkmcnt(8)
 MF 168,20,80,168
 TR 40,7,5152
 MF 172,20,84,172
 TR 42,7,7712
 s_waitcnt lgkmcnt(8)
 MF 176,24,80,176
 TR 44,7,5184
 MF 180,24,84,180
 TR 46,7,7744
 s_waitcnt lgkmcnt(8)
 MF 184,28,80,184
 TR 16,7,5216
 MF 188,28,84,188
 TR 18,7,7776
 s_waitcnt lgkmcnt(8)
 MF 192,32,80,192
 TR 20,7,5248
 MF 196,32,84,196
 TR 22,7,7808
 s_waitcnt lgkmcnt(8)
 s_waitcnt vmcnt(21)
 MF 160,36,88,160
 s_waitcnt vmcnt(2)
 v_readfirstlane_b32 s57, v10
 s_cmp_ge_u32 s57, 8
 s_cbranch_scc1 Lpok_80
 s_mov_b32 s66, 0x10000
Lpoll_81:
 buffer_load_dword v10, v4, s[44:47], s86 offen sc1
 s_waitcnt vmcnt(0)
 v_readfirstlane_b32 s57, v10
 s_cmp_ge_u32 s57, 8
 s_cbranch_scc1 Lpolld_82
 s_sleep 2
 s_sub_u32 s66, s66, 1
 s_cmp_lg_u32 s66, 0
 s_cbranch_scc1 Lpoll_81
Lpolld_82:
Lpok_80:
 s_barrier
 v_add_u32 v7, 0x5000, v7
 TR 24,7,0
 MF 164,36,92,164
 TR 26,7,2560
 s_add_u32 s54, s84, s85
 s_add_u32 s54, s54, 0x19000
 s_add_u32 m0, s85, 0
 s_nop 0
 buffer_load_dwordx4 v1, s[44:47], s54 offen offset:0 sc1 lds
 s_waitcnt lgkmcnt(8)
 MF 168,40,88,168
 TR 28,7,32
 MF 172,40,92,172
 TR 30,7,2592
 buffer_load_dwordx4 v1, s[44:47], s54 offen offset:1024 sc1 lds
 s_waitcnt lgkmcnt(8)
 MF 176,44,88,176
 TR 32,7,64
 MF 180,44,92,180
 TR 34,7,2624
 s_waitcnt lgkmcnt(8)
 MF 184,16,88,184
 TR 36,7,96
 MF 188,16,92,188
 TR 38,7,2656
 s_waitcnt lgkmcnt(8)
 MF 192,20,88,192
 TR 40,7,128
 MF 196,20,92,196
 TR 42,7,2688
 s_waitcnt lgkmcnt(8)
 MF 160,24,96,160
 TR 44,7,5120
 MF 164,24,100,164
 TR 46,7,7680
 s_add_u32 s55, s82, 32768
 buffer_load_dwordx4 v[64:67], v1, s[44:47], s55 offen offset:0 sc1
 buffer_load_dwordx4 v[68:71], v1, s[44:47], s55 offen offset:1024 sc1
 s_waitcnt lgkmcnt(8)
 MF 168,28,96,168
 TR 16,7,5152
 MF 172,28,100,172
 TR 18,7,7712
 buffer_load_dwordx4 v[72:75], v1, s[44:47], s55 offen offset:2048 sc1
 buffer_load_dwordx4 v[76:79], v1, s[44:47], s55 offen offset:3072 sc1
 s_waitcnt lgkmcnt(8)
 MF 176,32,96,176
 TR 20,7,5184
 MF 180,32,100,180
 TR 22,7,7744
 s_add_u32 s55, s82, 40960
 buffer_load_dwordx4 v[80:83], v1, s[44:47], s55 offen offset:0 sc1
 s_waitcnt lgkmcnt(8)
 MF 184,36,96,184
 TR 24,7,5216
 MF 188,36,100,188
 TR 26,7,7776
 buffer_load_dwordx4 v[84:87], v1, s[44:47], s55 offen offset:1024 sc1
 buffer_load_dwordx4 v[88:91], v1, s[44:47], s55 offen offset:2048 sc1
 s_waitcnt lgkmcnt(8)
 MF 192,40,96,192
 TR 28,7,5248
 MF 196,40,100,196
 TR 30,7,7808
 buffer_load_dwordx4 v[92:95], v1, s[44:47], s55 offen offset:3072 sc1
 s_waitcnt lgkmcnt(8)
 MF 160,44,104,160
 s_barrier
 v_add_u32 v7, 0x5000, v7
 TR 32,7,0
 MF 164,44,108,164
 TR 34,7,2560
 s_add_u32 s54, s84, s85
 s_add_u32 s54, s54, 0x1e000
 s_add_u32 m0, s85, 20480
 s_nop 0
 buffer_load_dwordx4 v1, s[44:47], s54 offen offset:0 sc1 lds
 s_waitcnt lgkmcnt(8)
 MF 168,16,104,168
 TR 36,7,32
 MF 172,16,108,172
 TR 38,7,2592
 buffer_load_dwordx4 v1, s[44:47], s54 offen offset:1024 sc1 lds
 s_waitcnt lgkmcnt(8)
 MF 176,20,104,176
 TR 40,7,64
 MF 180,20,108,180
 TR 42,7,2624
 s_waitcnt lgkmcnt(8)
 MF 184,24,104,184
 TR 44,7,96
 MF 188,24,108,188
 TR 46,7,2656
 s_waitcnt lgkmcnt(8)
 MF 192,28,104,192
 TR 16,7,128
 MF 196,28,108,196
 TR 18,7,2688
 s_waitcnt lgkmcnt(8)
 MF 160,32,112,160
 TR 20,7,5120
 MF 164,32,116,164
 TR 22,7,7680
 s_add_u32 s55, s82, 49152
 buffer_load_dwordx4 v[96:99], v1, s[44:47], s55 offen offset:0 sc1
 s_waitcnt lgkmcnt(8)
 MF 168,36,112,168
 TR 24,7,5152
 MF 172,36,116,172
 TR 26,7,7712
 buffer_load_dwordx4 v[100:103], v1, s[44:47], s55 offen offset:1024 sc1
 s_waitcnt lgkmcnt(8)
 MF 176,40,112,176
 TR 28,7,5184
 MF 180,40,116,180
 TR 30,7,7744
 buffer_load_dwordx4 v[104:107], v1, s[44:47], s55 offen offset:2048 sc1
 s_waitcnt lgkmcnt(8)
 MF 184,44,112,184
 TR 32,7,5216
 MF 188,44,116,188
 TR 34,7,7776
 buffer_load_dwordx4 v[108:111], v1, s[44:47], s55 offen offset:3072 sc1
 s_waitcnt lgkmcnt(8)
 MF 192,16,112,192
 TR 36,7,5248
 MF 196,16,116,196
 TR 38,7,7808
 s_waitcnt lgkmcnt(8)
 MF 160,20,120,160
 s_barrier
 v_add_u32 v7, 0x5000, v7
 TR 40,7,0
 MF 164,20,124,164
 TR 42,7,2560
 s_add_u32 s54, s84, s85
 s_add_u32 s54, s54, 0x23000
 s_add_u32 m0, s85, 40960
 s_nop 0
 buffer_load_dwordx4 v1, s[44:47], s54 offen offset:0 sc1 lds
 s_waitcnt lgkmcnt(8)
 MF 168,24,120,168
 TR 44,7,32
 MF 172,24,124,172
 TR 46,7,2592
 buffer_load_dwordx4 v1, s[44:47], s54 offen offset:1024 sc1 lds
 s_waitcnt lgkmcnt(8)
 MF 176,28,120,176
 TR 16,7,64
 MF 180,28,124,180
 TR 18,7,2624
 s_waitcnt lgkmcnt(8)
 MF 184,32,120,184
 TR 20,7,96
 MF 188,32,124,188
 TR 22,7,2656
 s_waitcnt lgkmcnt(8)
 MF 192,36,120,192
 TR 24,7,128
 MF 196,36,124,196
 TR 26,7,2688
 s_waitcnt lgkmcnt(8)
 MF 160,40,48,160
 TR 28,7,5120
 MF 164,40,52,164
 TR 30,7,7680
 s_add_u32 s55, s82, 57344
 buffer_load_dwordx4 v[112:115], v1, s[44:47], s55 offen offset:0 sc1
 s_waitcnt lgkmcnt(8)
 MF 168,44,48,168
 TR 32,7,5152
 MF 172,44,52,172
 TR 34,7,7712
 buffer_load_dwordx4 v[116:119], v1, s[44:47], s55 offen offset:1024 sc1
 s_waitcnt lgkmcnt(8)
 MF 176,16,48,176
 TR 36,7,5184
 MF 180,16,52,180
 TR 38,7,7744
 buffer_load_dwordx4 v[120:123], v1, s[44:47], s55 offen offset:2048 sc1
 s_waitcnt lgkmcnt(8)
 MF 184,20,48,184
 TR 40,7,5216
 MF 188,20,52,188
 TR 42,7,7776
 buffer_load_dwordx4 v[124:127], v1, s[44:47], s55 offen offset:3072 sc1
 s_waitcnt lgkmcnt(8)
 MF 192,24,48,192
 TR 44,7,5248
 MF 196,24,52,196
 TR 46,7,7808
 s_waitcnt lgkmcnt(8)
 MF 160,28,56,160
 s_waitcnt vmcnt(22)
 s_barrier
 v_add_u32 v7, 0x5000, v7
 TR 16,7,0
 MF 164,28,60,164
 TR 18,7,2560
 s_add_u32 s54, s84, s85
 s_add_u32 s54, s54, 0x3c000
 s_add_u32 m0, s85, 61440
 s_nop 0
 buffer_load_dwordx4 v1, s[44:47], s54 offen offset:0 sc1 lds
 s_waitcnt lgkmcnt(8)
 MF 168,32,56,168
 TR 20,7,32
 MF 172,32,60,172
 TR 22,7,2592
 buffer_load_dwordx4 v1, s[44:47], s54 offen offset:1024 sc1 lds
 s_waitcnt lgkmcnt(8)
 MF 176,36,56,176
 TR 24,7,64
 MF 180,36,60,180
 TR 26,7,2624
 s_waitcnt lgkmcnt(8)
 MF 184,40,56,184
 TR 28,7,96
 MF 188,40,60,188
 TR 30,7,2656
 s_waitcnt lgkmcnt(8)
 MF 192,44,56,192
 TR 32,7,128
 MF 196,44,60,196
 TR 34,7,2688
 s_waitcnt lgkmcnt(8)
 s_waitcnt vmcnt(20)
 MF 160,16,64,160
 TR 36,7,5120
 MF 164,16,68,164
 TR 38,7,7680
 s_add_u32 s55, s82, 98304
 buffer_load_dwordx4 v[48:51], v1, s[44:47], s55 offen offset:0 sc1
 s_waitcnt lgkmcnt(8)
 MF 168,20,64,168
 TR 40,7,5152
 MF 172,20,68,172
 TR 42,7,7712
 buffer_load_dwordx4 v[52:55], v1, s[44:47], s55 offen offset:1024 sc1
 s_waitcnt lgkmcnt(8)
 MF 176,24,64,176
 TR 44,7,5184
 MF 180,24,68,180
 TR 46,7,7744
 buffer_load_dwordx4 v[56:59], v1, s[44:47], s55 offen offset:2048 sc1
 s_waitcnt lgkmcnt(8)
 MF 184,28,64,184
 TR 16,7,5216
 MF 188,28,68,188
 TR 18,7,7776
 buffer_load_dwordx4 v[60:63], v1, s[44:47], s55 offen offset:3072 sc1
 s_waitcnt lgkmcnt(8)
 MF 192,32,64,192
 TR 20,7,5248
 MF 196,32,68,196
 TR 22,7,7808
 s_waitcnt lgkmcnt(8)
 s_waitcnt vmcnt(22)
 MF 160,36,72,160
 s_barrier
 v_add_u32 v7, 0xfffdd000, v7
 TR 24,7,0
 MF 164,36,76,164
 TR 26,7,2560
 s_add_u32 s54, s84, s85
 s_add_u32 s54, s54, 0x41000
 s_add_u32 m0, s85, 81920
 s_nop 0
 buffer_load_dwordx4 v1, s[44:47], s54 offen offset:0 sc1 lds
 s_waitcnt lgkmcnt(8)
 MF 168,40,72,168
 TR 28,7,32
 MF 172,40,76,172
 TR 30,7,2592
 buffer_load_dwordx4 v1, s[44:47], s54 offen offset:1024 sc1 lds
 s_waitcnt lgkmcnt(8)
 MF 176,44,72,176
 TR 32,7,64
 MF 180,44,76,180
 TR 34,7,2624
 s_waitcnt lgkmcnt(8)
 MF 184,16,72,184
 TR 36,7,96
 MF 188,16,76,188
 TR 38,7,2656
 s_waitcnt lgkmcnt(8)
 MF 192,20,72,192
 TR 40,7,128
 MF 196,20,76,196
 TR 42,7,2688
 s_waitcnt lgkmcnt(8)
 s_waitcnt vmcnt(22)
 MF 160,24,80,160
 TR 44,7,5120
 MF 164,24,84,164
 TR 46,7,7680
 s_add_u32 s55, s82, 106496
 buffer_load_dwordx4 v[64:67], v1, s[44:47], s55 offen offset:0 sc1
 s_waitcnt lgkmcnt(8)
 MF 168,28,80,168
 TR 16,7,5152
 MF 172,28,84,172
 TR 18,7,7712
 buffer_load_dwordx4 v[68:71], v1, s[44:47], s55 offen offset:1024 sc1
 s_waitcnt lgkmcnt(8)
 MF 176,32,80,176
 TR 20,7,5184
 MF 180,32,84,180
 TR 22,7,7744
 buffer_load_dwordx4 v[72:75], v1, s[44:47], s55 offen offset:2048 sc1
 s_waitcnt lgkmcnt(8)
 MF 184,36,80,184
 TR 24,7,5216
 MF 188,36,84,188
 TR 26,7,7776
 buffer_load_dwordx4 v[76:79], v1, s[44:47], s55 offen offset:3072 sc1
 s_waitcnt lgkmcnt(8)
 MF 192,40,80,192
 TR 28,7,5248
 MF 196,40,84,196
 TR 30,7,7808
 s_waitcnt lgkmcnt(8)
 s_waitcnt vmcnt(24)
 MF 160,44,88,160
 s_waitcnt vmcnt(22)
 s_barrier
 v_add_u32 v7, 0x5000, v7
 TR 32,7,0
 MF 164,44,92,164
 TR 34,7,2560
 s_add_u32 s54, s84, s85
 s_add_u32 s54, s54, 0x46000
 s_add_u32 m0, s85, 102400
 s_nop 0
 buffer_load_dwordx4 v1, s[44:47], s54 offen offset:0 sc1 lds
 s_waitcnt lgkmcnt(8)
 MF 168,16,88,168
 TR 36,7,32
 MF 172,16,92,172
 TR 38,7,2592
 buffer_load_dwordx4 v1, s[44:47], s54 offen offset:1024 sc1 lds
 s_waitcnt lgkmcnt(8)
 MF 176,20,88,176
 TR 40,7,64
 MF 180,20,92,180
 TR 42,7,2624
 s_waitcnt lgkmcnt(8)
 MF 184,24,88,184
 TR 44,7,96
 MF 188,24,92,188
 TR 46,7,2656
 s_waitcnt lgkmcnt(8)
 MF 192,28,88,192
 TR 16,7,128
 MF 196,28,92,196
 TR 18,7,2688
 s_waitcnt lgkmcnt(8)
 s_waitcnt vmcnt(22)
 MF 160,32,96,160
 TR 20,7,5120
 MF 164,32,100,164
 TR 22,7,7680
 s_add_u32 s55, s82, 114688
 buffer_load_dwordx4 v[80:83], v1, s[44:47], s55 offen offset:0 sc1
 s_waitcnt lgkmcnt(8)
 MF 168,36,96,168
 TR 24,7,5152
 MF 172,36,100,172
 TR 26,7,7712
 buffer_load_dwordx4 v[84:87], v1, s[44:47], s55 offen offset:1024 sc1
 s_waitcnt lgkmcnt(8)
 MF 176,40,96,176
 TR 28,7,5184
 MF 180,40,100,180
 TR 30,7,7744
 buffer_load_dwordx4 v[88:91], v1, s[44:47], s55 offen offset:2048 sc1
 s_waitcnt lgkmcnt(8)
 MF 184,44,96,184
 TR 32,7,5216
 MF 188,44,100,188
 TR 34,7,7776
 buffer_load_dwordx4 v[92:95], v1, s[44:47], s55 offen offset:3072 sc1
 s_waitcnt lgkmcnt(8)
 MF 192,16,96,192
 TR 36,7,5248
 MF 196,16,100,196
 TR 38,7,7808
 s_waitcnt lgkmcnt(8)
 s_waitcnt vmcnt(24)
 MF 160,20,104,160
 s_waitcnt vmcnt(22)
 s_barrier
 v_add_u32 v7, 0x5000, v7
 TR 40,7,0
 MF 164,20,108,164
 TR 42,7,2560
 s_add_u32 s54, s84, s85
 s_add_u32 s54, s54, 0x4b000
 s_add_u32 m0, s85, 122880
 s_nop 0
 buffer_load_dwordx4 v1, s[44:47], s54 offen offset:0 sc1 lds
 s_waitcnt lgkmcnt(8)
 MF 168,24,104,168
 TR 44,7,32
 MF 172,24,108,172
 TR 46,7,2592
 buffer_load_dwordx4 v1, s[44:47], s54 offen offset:1024 sc1 lds
 s_waitcnt lgkmcnt(8)
 MF 176,28,104,176
 TR 16,7,64
 MF 180,28,108,180
 TR 18,7,2624
 s_waitcnt lgkmcnt(8)
 MF 184,32,104,184
 TR 20,7,96
 MF 188,32,108,188
 TR 22,7,2656
 s_waitcnt lgkmcnt(8)
 MF 192,36,104,192
 TR 24,7,128
 MF 196,36,108,196
 TR 26,7,2688
 s_waitcnt lgkmcnt(8)
 s_waitcnt vmcnt(22)
 MF 160,40,112,160
 TR 28,7,5120
 MF 164,40,116,164
 TR 30,7,7680
 s_add_u32 s55, s82, 122880
 buffer_load_dwordx4 v[96:99], v1, s[44:47], s55 offen offset:0 sc1
 s_waitcnt lgkmcnt(8)
 MF 168,44,112,168
 TR 32,7,5152
 MF 172,44,116,172
 TR 34,7,7712
 buffer_load_dwordx4 v[100:103], v1, s[44:47], s55 offen offset:1024 sc1
 s_waitcnt lgkmcnt(8)
 MF 176,16,112,176
 TR 36,7,5184
 MF 180,16,116,180
 TR 38,7,7744
 buffer_load_dwordx4 v[104:107], v1, s[44:47], s55 offen offset:2048 sc1
 s_waitcnt lgkmcnt(8)
 MF 184,20,112,184
 TR 40,7,5216
 MF 188,20,116,188
 TR 42,7,7776
 buffer_load_dwordx4 v[108:111], v1, s[44:47], s55 offen offset:3072 sc1
 s_waitcnt lgkmcnt(8)
 MF 192,24,112,192
 TR 44,7,5248
 MF 196,24,116,196
 TR 46,7,7808
 s_waitcnt lgkmcnt(8)
 s_waitcnt vmcnt(24)
 MF 160,28,120,160
 s_waitcnt vmcnt(22)
 s_barrier
 v_add_u32 v7, 0x5000, v7
 TR 16,7,0
 MF 164,28,124,164
 TR 18,7,2560
 s_waitcnt lgkmcnt(8)
 MF 168,32,120,168
 TR 20,7,32
 MF 172,32,124,172
 TR 22,7,2592
 s_waitcnt lgkmcnt(8)
 MF 176,36,120,176
 TR 24,7,64
 MF 180,36,124,180
 TR 26,7,2624
 s_waitcnt lgkmcnt(8)
 MF 184,40,120,184
 TR 28,7,96
 MF 188,40,124,188
 TR 30,7,2656
 s_waitcnt lgkmcnt(8)
 MF 192,44,120,192
 TR 32,7,128
 MF 196,44,124,196
 TR 34,7,2688
 s_waitcnt lgkmcnt(8)
 s_waitcnt vmcnt(20)
 MF 160,16,48,160
 TR 36,7,5120
 MF 164,16,52,164
 TR 38,7,7680
 s_waitcnt lgkmcnt(8)
 MF 168,20,48,168
 TR 40,7,5152
 MF 172,20,52,172
 TR 42,7,7712
 s_waitcnt lgkmcnt(8)
 MF 176,24,48,176
 TR 44,7,5184
 MF 180,24,52,180
 TR 46,7,7744
 s_waitcnt lgkmcnt(8)
 MF 184,28,48,184
 TR 16,7,5216
 MF 188,28,52,188
 TR 18,7,7776
 s_waitcnt lgkmcnt(8)
 MF 192,32,48,192
 TR 20,7,5248
 MF 196,32,52,196
 TR 22,7,7808
 s_waitcnt lgkmcnt(8)
 s_waitcnt vmcnt(18)
 MF 160,36,56,160
 s_waitcnt vmcnt(16)
 s_barrier
 v_add_u32 v7, 0x5000, v7
 TR 24,7,0
 MF 164,36,60,164
 TR 26,7,2560
 s_waitcnt lgkmcnt(8)
 MF 168,40,56,168
 TR 28,7,32
 MF 172,40,60,172
 TR 30,7,2592
 s_waitcnt lgkmcnt(8)
 MF 176,44,56,176
 TR 32,7,64
 MF 180,44,60,180
 TR 34,7,2624
 s_waitcnt lgkmcnt(8)
 MF 184,16,56,184
 TR 36,7,96
 MF 188,16,60,188
 TR 38,7,2656
 s_waitcnt lgkmcnt(8)
 MF 192,20,56,192
 TR 40,7,128
 MF 196,20,60,196
 TR 42,7,2688
 s_waitcnt lgkmcnt(8)
 s_waitcnt vmcnt(14)
 MF 160,24,64,160
 TR 44,7,5120
 MF 164,24,68,164
 TR 46,7,7680
 s_waitcnt lgkmcnt(8)
 MF 168,28,64,168
 TR 16,7,5152
 MF 172,28,68,172
 TR 18,7,7712
 s_waitcnt lgkmcnt(8)
 MF 176,32,64,176
 TR 20,7,5184
 MF 180,32,68,180
 TR 22,7,7744
 s_waitcnt lgkmcnt(8)
 MF 184,36,64,184
 TR 24,7,5216
 MF 188,36,68,188
 TR 26,7,7776
 s_waitcnt lgkmcnt(8)
 MF 192,40,64,192
 TR 28,7,5248
 MF 196,40,68,196
 TR 30,7,7808
 s_waitcnt lgkmcnt(8)
 s_waitcnt vmcnt(12)
 MF 160,44,72,160
 s_waitcnt vmcnt(10)
 s_barrier
 v_add_u32 v7, 0x5000, v7
 TR 32,7,0
 MF 164,44,76,164
 TR 34,7,2560
 s_waitcnt lgkmcnt(8)
 MF 168,16,72,168
 TR 36,7,32
 MF 172,16,76,172
 TR 38,7,2592
 s_waitcnt lgkmcnt(8)
 MF 176,20,72,176
 TR 40,7,64
 MF 180,20,76,180
 TR 42,7,2624
 s_waitcnt lgkmcnt(8)
 MF 184,24,72,184
 TR 44,7,96
 MF 188,24,76,188
 TR 46,7,2656
 s_waitcnt lgkmcnt(8)
 MF 192,28,72,192
 TR 16,7,128
 MF 196,28,76,196
 TR 18,7,2688
 s_waitcnt lgkmcnt(8)
 s_waitcnt vmcnt(8)
 MF 160,32,80,160
 TR 20,7,5120
 MF 164,32,84,164
 TR 22,7,7680
 s_waitcnt lgkmcnt(8)
 MF 168,36,80,168
 TR 24,7,5152
 MF 172,36,84,172
 TR 26,7,7712
 s_waitcnt lgkmcnt(8)
 MF 176,40,80,176
 TR 28,7,5184
 MF 180,40,84,180
 TR 30,7,7744
 s_waitcnt lgkmcnt(8)
 MF 184,44,80,184
 TR 32,7,5216
 MF 188,44,84,188
 TR 34,7,7776
 s_waitcnt lgkmcnt(8)
 MF 192,16,80,192
 TR 36,7,5248
 MF 196,16,84,196
 TR 38,7,7808
 s_waitcnt lgkmcnt(8)
 s_waitcnt vmcnt(6)
 MF 160,20,88,160
 s_waitcnt vmcnt(4)
 s_barrier
 v_add_u32 v7, 0x5000, v7
 TR 40,7,0
 MF 164,20,92,164
 TR 42,7,2560
 s_waitcnt lgkmcnt(8)
 MF 168,24,88,168
 TR 44,7,32
 MF 172,24,92,172
 TR 46,7,2592
 s_waitcnt lgkmcnt(8)
 MF 176,28,88,176
 TR 16,7,64
 MF 180,28,92,180
 TR 18,7,2624
 s_waitcnt lgkmcnt(8)
 MF 184,32,88,184
 TR 20,7,96
 MF 188,32,92,188
 TR 22,7,2656
 s_waitcnt lgkmcnt(8)
 MF 192,36,88,192
 TR 24,7,128
 MF 196,36,92,196
 TR 26,7,2688
 s_waitcnt lgkmcnt(8)
 s_waitcnt vmcnt(2)
 MF 160,40,96,160
 TR 28,7,5120
 MF 164,40,100,164
 TR 30,7,7680
 s_waitcnt lgkmcnt(8)
 MF 168,44,96,168
 TR 32,7,5152
 MF 172,44,100,172
 TR 34,7,7712
 s_waitcnt lgkmcnt(8)
 MF 176,16,96,176
 TR 36,7,5184
 MF 180,16,100,180
 TR 38,7,7744
 s_waitcnt lgkmcnt(8)
 MF 184,20,96,184
 TR 40,7,5216
 MF 188,20,100,188
 TR 42,7,7776
 s_waitcnt lgkmcnt(8)
 MF 192,24,96,192
 TR 44,7,5248
 MF 196,24,100,196
 TR 46,7,7808
 s_waitcnt lgkmcnt(8)
 s_waitcnt vmcnt(0)
 MF 160,28,104,160
 MF 164,28,108,164
 s_waitcnt lgkmcnt(6)
 MF 168,32,104,168
 MF 172,32,108,172
 s_waitcnt lgkmcnt(4)
 MF 176,36,104,176
 MF 180,36,108,180
 s_waitcnt lgkmcnt(2)
 MF 184,40,104,184
 MF 188,40,108,188
 s_waitcnt lgkmcnt(0)
 MF 192,44,104,192
 MF 196,44,108,196
 s_mul_i32 s57, s48, 5120
 v_add_u32 v5, s57, v1
 s_xor_b32 s58, s48, 4
 s_mul_i32 s58, s58, 5120
 v_add_u32 v10, s58, v1
 v_add_u32 v5, 0, v5
 v_add_u32 v10, 0, v10
 s_nop 2
 ds_write_b128 v5, v[164:167] offset:0
 ds_write_b128 v5, v[172:175] offset:1024
 ds_write_b128 v5, v[180:183] offset:2048
 ds_write_b128 v5, v[188:191] offset:3072
 ds_write_b128 v5, v[196:199] offset:4096
 s_bfe_u32 s56, s48, 0x10001
 s_cmp_eq_u32 s56, s80
 s_cselect_b32 s56, 0xc1, 0
 s_xor_b32 s58, s2, s56
 s_mul_i32 s54, s58, 0xac00
 s_add_u32 s54, s54, s57
 s_add_u32 s54, s54, 0x3ae0000
 s_lshl_b32 s76, s58, 7
 s_lshl_b32 s58, s48, 2
 s_add_u32 s76, s76, s58
 s_add_u32 s76, s76, 45056
 s_waitcnt lgkmcnt(0)
 s_barrier
 RD 16,10,0
 RD 20,10,1024
 RD 24,10,2048
 RD 28,10,3072
 RD 32,10,4096
 s_cmp_lg_u32 s56, 0
 s_cbranch_scc1 Lkeep_83
 s_waitcnt lgkmcnt(4)
 v_pk_add_f32 v[160:161], v[160:161], v[16:17]
 v_pk_add_f32 v[162:163], v[162:163], v[18:19]
 buffer_store_dwordx4 v[160:163], v1, s[44:47], s54 offen offset:0 sc1
 s_waitcnt lgkmcnt(3)
 v_pk_add_f32 v[168:169], v[168:169], v[20:21]
 v_pk_add_f32 v[170:171], v[170:171], v[22:23]
 buffer_store_dwordx4 v[168:171], v1, s[44:47], s54 offen offset:1024 sc1
 s_waitcnt lgkmcnt(2)
 v_pk_add_f32 v[176:177], v[176:177], v[24:25]
 v_pk_add_f32 v[178:179], v[178:179], v[26:27]
 buffer_store_dwordx4 v[176:179], v1, s[44:47], s54 offen offset:2048 sc1
 s_waitcnt lgkmcnt(1)
 v_pk_add_f32 v[184:185], v[184:185], v[28:29]
 v_pk_add_f32 v[186:187], v[186:187], v[30:31]
 buffer_store_dwordx4 v[184:187], v1, s[44:47], s54 offen offset:3072 sc1
 s_waitcnt lgkmcnt(0)
 v_pk_add_f32 v[192:193], v[192:193], v[32:33]
 v_pk_add_f32 v[194:195], v[194:195], v[34:35]
 buffer_store_dwordx4 v[192:195], v15, s[44:47], s54 offen offset:0 sc1
 v_mov_b32 v5, 1
 s_waitcnt vmcnt(0)
 s_mov_b64 exec, 1
 buffer_store_dword v5, v4, s[44:47], s76 offen sc1
 s_endpgm
Lkeep_83:
 s_waitcnt lgkmcnt(4)
 v_pk_add_f32 v[160:161], v[160:161], v[16:17]
 v_pk_add_f32 v[162:163], v[162:163], v[18:19]
 s_waitcnt lgkmcnt(3)
 v_pk_add_f32 v[168:169], v[168:169], v[20:21]
 v_pk_add_f32 v[170:171], v[170:171], v[22:23]
 s_waitcnt lgkmcnt(2)
 v_pk_add_f32 v[176:177], v[176:177], v[24:25]
 v_pk_add_f32 v[178:179], v[178:179], v[26:27]
 s_waitcnt lgkmcnt(1)
 v_pk_add_f32 v[184:185], v[184:185], v[28:29]
 v_pk_add_f32 v[186:187], v[186:187], v[30:31]
 s_waitcnt lgkmcnt(0)
 v_pk_add_f32 v[192:193], v[192:193], v[32:33]
 v_pk_add_f32 v[194:195], v[194:195], v[34:35]
 s_mov_b32 s66, 0x10000
Lpoll_84:
 buffer_load_dword v10, v4, s[44:47], s76 offen sc1
 s_waitcnt vmcnt(0)
 v_readfirstlane_b32 s57, v10
 s_cmp_ge_u32 s57, 1
 s_cbranch_scc1 Lpolld_85
 s_sleep 2
 s_sub_u32 s66, s66, 1
 s_cmp_lg_u32 s66, 0
 s_cbranch_scc1 Lpoll_84
Lpolld_85:
 buffer_load_dwordx4 v[16:19], v1, s[44:47], s54 offen offset:0 sc1
 buffer_load_dwordx4 v[20:23], v1, s[44:47], s54 offen offset:1024 sc1
 buffer_load_dwordx4 v[24:27], v1, s[44:47], s54 offen offset:2048 sc1
 buffer_load_dwordx4 v[28:31], v1, s[44:47], s54 offen offset:3072 sc1
 buffer_load_dwordx4 v[32:35], v15, s[44:47], s54 offen offset:0 sc1
 s_waitcnt vmcnt(4)
 v_pk_add_f32 v[160:161], v[160:161], v[16:17]
 v_pk_add_f32 v[162:163], v[162:163], v[18:19]
 v_cvt_pk_bf16_f32 v160, v160, v161
 v_cvt_pk_bf16_f32 v161, v162, v163
 buffer_store_dwordx2 v[160:161], v6, s[36:39], 0 offen offset:0
 s_waitcnt vmcnt(4)
 v_pk_add_f32 v[168:169], v[168:169], v[20:21]
 v_pk_add_f32 v[170:171], v[170:171], v[22:23]
 v_cvt_pk_bf16_f32 v168, v168, v169
 v_cvt_pk_bf16_f32 v169, v170, v171
 buffer_store_dwordx2 v[168:169], v6, s[36:39], 0 offen offset:32
 s_waitcnt vmcnt(4)
 v_pk_add_f32 v[176:177], v[176:177], v[24:25]
 v_pk_add_f32 v[178:179], v[178:179], v[26:27]
 v_cvt_pk_bf16_f32 v176, v176, v177
 v_cvt_pk_bf16_f32 v177, v178, v179
 buffer_store_dwordx2 v[176:177], v6, s[36:39], 0 offen offset:64
 s_waitcnt vmcnt(4)
 v_pk_add_f32 v[184:185], v[184:185], v[28:29]
 v_pk_add_f32 v[186:187], v[186:187], v[30:31]
 v_cvt_pk_bf16_f32 v184, v184, v185
 v_cvt_pk_bf16_f32 v185, v186, v187
 buffer_store_dwordx2 v[184:185], v6, s[36:39], 0 offen offset:96
 s_waitcnt vmcnt(4)
 v_pk_add_f32 v[192:193], v[192:193], v[32:33]
 v_pk_add_f32 v[194:195], v[194:195], v[34:35]
 v_cvt_pk_bf16_f32 v192, v192, v193
 v_cvt_pk_bf16_f32 v193, v194, v195
 buffer_store_dwordx2 v[192:193], v6, s[36:39], 0 offen offset:128
 s_endpgm
L_p3_L1_8:
 s_add_u32 s54, s83, s85
 s_add_u32 s54, s54, 0x5000
 s_add_u32 m0, s85, 0
 s_nop 0
 buffer_load_dwordx4 v1, s[44:47], s54 offen offset:0 sc1 lds
 buffer_load_dwordx4 v1, s[44:47], s54 offen offset:1024 sc1 lds
 s_waitcnt vmcnt(2)
 v_mov_b32 v5, 1
 s_mov_b64 exec, 1
 buffer_atomic_add v5, v4, s[44:47], s76 offen
 s_mov_b64 exec, -1
 s_add_u32 s55, s81, 8192
 buffer_load_dwordx4 v[64:67], v1, s[44:47], s55 offen offset:0 sc1
 buffer_load_dwordx4 v[68:71], v1, s[44:47], s55 offen offset:1024 sc1
 buffer_load_dwordx4 v[72:75], v1, s[44:47], s55 offen offset:2048 sc1
 buffer_load_dwordx4 v[76:79], v1, s[44:47], s55 offen offset:3072 sc1
 s_barrier
 TR 16,7,0
 TR 18,7,2560
 TR 20,7,32
 TR 22,7,2592
 TR 24,7,64
 TR 26,7,2624
 TR 28,7,96
 TR 30,7,2656
 TR 32,7,128
 TR 34,7,2688
 s_waitcnt lgkmcnt(8)
 TR 36,7,5120
 TR 38,7,7680
 s_add_u32 s54, s83, s85
 s_add_u32 s54, s54, 0xa000
 s_add_u32 m0, s85, 20480
 s_nop 0
 buffer_load_dwordx4 v1, s[44:47], s54 offen offset:0 sc1 lds
 buffer_load_dwordx4 v1, s[44:47], s54 offen offset:1024 sc1 lds
 s_waitcnt lgkmcnt(8)
 TR 40,7,5152
 TR 42,7,7712
 s_add_u32 s55, s81, 16384
 buffer_load_dwordx4 v[80:83], v1, s[44:47], s55 offen offset:0 sc1
 buffer_load_dwordx4 v[84:87], v1, s[44:47], s55 offen offset:1024 sc1
 s_waitcnt lgkmcnt(8)
 TR 44,7,5184
 TR 46,7,7744
 buffer_load_dwordx4 v[88:91], v1, s[44:47], s55 offen offset:2048 sc1
 buffer_load_dwordx4 v[92:95], v1, s[44:47], s55 offen offset:3072 sc1
 s_waitcnt lgkmcnt(8)
 TR 16,7,5216
 TR 18,7,7776
 s_add_u32 s55, s81, 32768
 buffer_load_dwordx4 v[112:115], v1, s[44:47], s55 offen offset:0 sc1
 buffer_load_dwordx4 v[116:119], v1, s[44:47], s55 offen offset:1024 sc1
 s_waitcnt lgkmcnt(8)
 TR 20,7,5248
 TR 22,7,7808
 buffer_load_dwordx4 v[120:123], v1, s[44:47], s55 offen offset:2048 sc1
 buffer_load_dwordx4 v[124:127], v1, s[44:47], s55 offen offset:3072 sc1
 s_waitcnt lgkmcnt(8)
 s_waitcnt vmcnt(15)
 s_barrier
 v_add_u32 v7, 0xfffdd000, v7
 TR 24,7,0
 TR 26,7,2560
 s_add_u32 s54, s83, s85
 s_add_u32 s54, s54, 0x19000
 s_add_u32 m0, s85, 81920
 s_nop 0
 buffer_load_dwordx4 v1, s[44:47], s54 offen offset:0 sc1 lds
 s_waitcnt lgkmcnt(8)
 TR 28,7,32
 TR 30,7,2592
 buffer_load_dwordx4 v1, s[44:47], s54 offen offset:1024 sc1 lds
 s_waitcnt lgkmcnt(8)
 TR 32,7,64
 TR 34,7,2624
 s_waitcnt lgkmcnt(8)
 TR 36,7,96
 TR 38,7,2656
 s_waitcnt lgkmcnt(8)
 TR 40,7,128
 TR 42,7,2688
 s_waitcnt lgkmcnt(8)
 s_waitcnt vmcnt(14)
 MF 160,24,64,160
 TR 44,7,5120
 MF 164,24,68,164
 TR 46,7,7680
 s_add_u32 s54, s83, s85
 s_add_u32 s54, s54, 0xf000
 s_add_u32 m0, s85, 40960
 s_nop 0
 buffer_load_dwordx4 v1, s[44:47], s54 offen offset:0 sc1 lds
 buffer_load_dwordx4 v1, s[44:47], s54 offen offset:1024 sc1 lds
 s_waitcnt lgkmcnt(8)
 MF 168,28,64,168
 TR 16,7,5152
 MF 172,28,68,172
 TR 18,7,7712
 s_add_u32 s55, s81, 24576
 buffer_load_dwordx4 v[96:99], v1, s[44:47], s55 offen offset:0 sc1
 buffer_load_dwordx4 v[100:103], v1, s[44:47], s55 offen offset:1024 sc1
 s_waitcnt lgkmcnt(8)
 MF 176,32,64,176
 TR 20,7,5184
 MF 180,32,68,180
 TR 22,7,7744
 buffer_load_dwordx4 v[104:107], v1, s[44:47], s55 offen offset:2048 sc1
 buffer_load_dwordx4 v[108:111], v1, s[44:47], s55 offen offset:3072 sc1
 s_waitcnt lgkmcnt(8)
 MF 184,36,64,184
 TR 24,7,5216
 MF 188,36,68,188
 TR 26,7,7776
 s_add_u32 s55, s81, 40960
 buffer_load_dwordx4 v[48:51], v1, s[44:47], s55 offen offset:0 sc1
 buffer_load_dwordx4 v[52:55], v1, s[44:47], s55 offen offset:1024 sc1
 s_waitcnt lgkmcnt(8)
 MF 192,40,64,192
 TR 28,7,5248
 MF 196,40,68,196
 TR 30,7,7808
 buffer_load_dwordx4 v[56:59], v1, s[44:47], s55 offen offset:2048 sc1
 buffer_load_dwordx4 v[60:63], v1, s[44:47], s55 offen offset:3072 sc1
 s_waitcnt lgkmcnt(8)
 s_waitcnt vmcnt(22)
 MF 160,44,72,160
 s_waitcnt vmcnt(20)
 s_barrier
 buffer_load_dword v10, v4, s[44:47], s86 offen sc1
 v_add_u32 v7, 0x5000, v7
 TR 32,7,0
 MF 164,44,76,164
 TR 34,7,2560
 s_add_u32 s54, s84, s85
 s_add_u32 m0, s85, 102400
 s_nop 0
 buffer_load_dwordx4 v1, s[44:47], s54 offen offset:0 sc1 lds
 s_waitcnt lgkmcnt(8)
 MF 168,16,72,168
 TR 36,7,32
 MF 172,16,76,172
 TR 38,7,2592
 buffer_load_dwordx4 v1, s[44:47], s54 offen offset:1024 sc1 lds
 s_waitcnt lgkmcnt(8)
 MF 176,20,72,176
 TR 40,7,64
 MF 180,20,76,180
 TR 42,7,2624
 s_waitcnt lgkmcnt(8)
 MF 184,24,72,184
 TR 44,7,96
 MF 188,24,76,188
 TR 46,7,2656
 s_waitcnt lgkmcnt(8)
 MF 192,28,72,192
 TR 16,7,128
 MF 196,28,76,196
 TR 18,7,2688
 s_waitcnt lgkmcnt(8)
 s_waitcnt vmcnt(21)
 MF 160,32,80,160
 TR 20,7,5120
 MF 164,32,84,164
 TR 22,7,7680
 s_add_u32 s54, s83, s85
 s_add_u32 s54, s54, 0x14000
 s_add_u32 m0, s85, 61440
 s_nop 0
 buffer_load_dwordx4 v1, s[44:47], s54 offen offset:0 sc1 lds
 s_waitcnt lgkmcnt(8)
 MF 168,36,80,168
 TR 24,7,5152
 MF 172,36,84,172
 TR 26,7,7712
 s_waitcnt lgkmcnt(8)
 MF 176,40,80,176
 TR 28,7,5184
 MF 180,40,84,180
 TR 30,7,7744
 buffer_load_dwordx4 v1, s[44:47], s54 offen offset:1024 sc1 lds
 s_waitcnt lgkmcnt(8)
 MF 184,44,80,184
 TR 32,7,5216
 MF 188,44,84,188
 TR 34,7,7776
 s_waitcnt lgkmcnt(8)
 MF 192,16,80,192
 TR 36,7,5248
 MF 196,16,84,196
 TR 38,7,7808
 s_waitcnt lgkmcnt(8)
 s_waitcnt vmcnt(21)
 MF 160,20,88,160
 s_waitcnt vmcnt(4)
 v_readfirstlane_b32 s57, v10
 s_cmp_ge_u32 s57, 8
 s_cbranch_scc1 Lpok_86
 s_mov_b32 s66, 0x10000
Lpoll_87:
 buffer_load_dword v10, v4, s[44:47], s86 offen sc1
 s_waitcnt vmcnt(0)
 v_readfirstlane_b32 s57, v10
 s_cmp_ge_u32 s57, 8
 s_cbranch_scc1 Lpolld_88
 s_sleep 2
 s_sub_u32 s66, s66, 1
 s_cmp_lg_u32 s66, 0
 s_cbranch_scc1 Lpoll_87
Lpolld_88:
Lpok_86:
 s_barrier
 v_add_u32 v7, 0x5000, v7
 TR 40,7,0
 MF 164,20,92,164
 TR 42,7,2560
 s_add_u32 s54, s84, s85
 s_add_u32 s54, s54, 0x5000
 s_add_u32 m0, s85, 122880
 s_nop 0
 buffer_load_dwordx4 v1, s[44:47], s54 offen offset:0 sc1 lds
 s_waitcnt lgkmcnt(8)
 MF 168,24,88,168
 TR 44,7,32
 MF 172,24,92,172
 TR 46,7,2592
 buffer_load_dwordx4 v1, s[44:47], s54 offen offset:1024 sc1 lds
 s_waitcnt lgkmcnt(8)
 MF 176,28,88,176
 TR 16,7,64
 MF 180,28,92,180
 TR 18,7,2624
 s_waitcnt lgkmcnt(8)
 MF 184,32,88,184
 TR 20,7,96
 MF 188,32,92,188
 TR 22,7,2656
 s_waitcnt lgkmcnt(8)
 MF 192,36,88,192
 TR 24,7,128
 MF 196,36,92,196
 TR 26,7,2688
 s_waitcnt lgkmcnt(8)
 MF 160,40,96,160
 TR 28,7,5120
 MF 164,40,100,164
 TR 30,7,7680
 s_add_u32 s55, s82, 0
 buffer_load_dwordx4 v[64:67], v1, s[44:47], s55 offen offset:0 sc1
 buffer_load_dwordx4 v[68:71], v1, s[44:47], s55 offen offset:1024 sc1
 s_waitcnt lgkmcnt(8)
 MF 168,44,96,168
 TR 32,7,5152
 MF 172,44,100,172
 TR 34,7,7712
 buffer_load_dwordx4 v[72:75], v1, s[44:47], s55 offen offset:2048 sc1
 buffer_load_dwordx4 v[76:79], v1, s[44:47], s55 offen offset:3072 sc1
 s_waitcnt lgkmcnt(8)
 MF 176,16,96,176
 TR 36,7,5184
 MF 180,16,100,180
 TR 38,7,7744
 s_add_u32 s55, s82, 8192
 buffer_load_dwordx4 v[80:83], v1, s[44:47], s55 offen offset:0 sc1
 s_waitcnt lgkmcnt(8)
 MF 184,20,96,184
 TR 40,7,5216
 MF 188,20,100,188
 TR 42,7,7776
 buffer_load_dwordx4 v[84:87], v1, s[44:47], s55 offen offset:1024 sc1
 buffer_load_dwordx4 v[88:91], v1, s[44:47], s55 offen offset:2048 sc1
 s_waitcnt lgkmcnt(8)
 MF 192,24,96,192
 TR 44,7,5248
 MF 196,24,100,196
 TR 46,7,7808
 buffer_load_dwordx4 v[92:95], v1, s[44:47], s55 offen offset:3072 sc1
 s_waitcnt lgkmcnt(8)
 MF 160,28,104,160
 s_waitcnt vmcnt(10)
 s_barrier
 v_add_u32 v7, 0x5000, v7
 TR 16,7,0
 MF 164,28,108,164
 TR 18,7,2560
 s_add_u32 s54, s84, s85
 s_add_u32 s54, s54, 0xa000
 s_add_u32 m0, s85, 143360
 s_nop 0
 buffer_load_dwordx4 v1, s[44:47], s54 offen offset:0 sc1 lds
 s_waitcnt lgkmcnt(8)
 MF 168,32,104,168
 TR 20,7,32
 MF 172,32,108,172
 TR 22,7,2592
 buffer_load_dwordx4 v1, s[44:47], s54 offen offset:1024 sc1 lds
 s_waitcnt lgkmcnt(8)
 MF 176,36,104,176
 TR 24,7,64
 MF 180,36,108,180
 TR 26,7,2624
 s_waitcnt lgkmcnt(8)
 MF 184,40,104,184
 TR 28,7,96
 MF 188,40,108,188
 TR 30,7,2656
 s_waitcnt lgkmcnt(8)
 MF 192,44,104,192
 TR 32,7,128
 MF 196,44,108,196
 TR 34,7,2688
 s_waitcnt lgkmcnt(8)
 MF 160,16,112,160
 TR 36,7,5120
 MF 164,16,116,164
 TR 38,7,7680
 s_add_u32 s55, s82, 16384
 buffer_load_dwordx4 v[96:99], v1, s[44:47], s55 offen offset:0 sc1
 s_waitcnt lgkmcnt(8)
 MF 168,20,112,168
 TR 40,7,5152
 MF 172,20,116,172
 TR 42,7,7712
 buffer_load_dwordx4 v[100:103], v1, s[44:47], s55 offen offset:1024 sc1
 s_waitcnt lgkmcnt(8)
 MF 176,24,112,176
 TR 44,7,5184
 MF 180,24,116,180
 TR 46,7,7744
 buffer_load_dwordx4 v[104:107], v1, s[44:47], s55 offen offset:2048 sc1
 s_waitcnt lgkmcnt(8)
 MF 184,28,112,184
 TR 16,7,5216
 MF 188,28,116,188
 TR 18,7,7776
 buffer_load_dwordx4 v[108:111], v1, s[44:47], s55 offen offset:3072 sc1
 s_waitcnt lgkmcnt(8)
 MF 192,32,112,192
 TR 20,7,5248
 MF 196,32,116,196
 TR 22,7,7808
 s_waitcnt lgkmcnt(8)
 MF 160,36,120,160
 s_barrier
 v_add_u32 v7, 0x5000, v7
 TR 24,7,0
 MF 164,36,124,164
 TR 26,7,2560
 s_add_u32 s54, s84, s85
 s_add_u32 s54, s54, 0xf000
 s_add_u32 m0, s85, 0
 s_nop 0
 buffer_load_dwordx4 v1, s[44:47], s54 offen offset:0 sc1 lds
 s_waitcnt lgkmcnt(8)
 MF 168,40,120,168
 TR 28,7,32
 MF 172,40,124,172
 TR 30,7,2592
 buffer_load_dwordx4 v1, s[44:47], s54 offen offset:1024 sc1 lds
 s_waitcnt lgkmcnt(8)
 MF 176,44,120,176
 TR 32,7,64
 MF 180,44,124,180
 TR 34,7,2624
 s_waitcnt lgkmcnt(8)
 MF 184,16,120,184
 TR 36,7,96
 MF 188,16,124,188
 TR 38,7,2656
 s_waitcnt lgkmcnt(8)
 MF 192,20,120,192
 TR 40,7,128
 MF 196,20,124,196
 TR 42,7,2688
 s_waitcnt lgkmcnt(8)
 MF 160,24,48,160
 TR 44,7,5120
 MF 164,24,52,164
 TR 46,7,7680
 s_add_u32 s55, s82, 24576
 buffer_load_dwordx4 v[112:115], v1, s[44:47], s55 offen offset:0 sc1
 s_waitcnt lgkmcnt(8)
 MF 168,28,48,168
 TR 16,7,5152
 MF 172,28,52,172
 TR 18,7,7712
 buffer_load_dwordx4 v[116:119], v1, s[44:47], s55 offen offset:1024 sc1
 s_waitcnt lgkmcnt(8)
 MF 176,32,48,176
 TR 20,7,5184
 MF 180,32,52,180
 TR 22,7,7744
 buffer_load_dwordx4 v[120:123], v1, s[44:47], s55 offen offset:2048 sc1
 s_waitcnt lgkmcnt(8)
 MF 184,36,48,184
 TR 24,7,5216
 MF 188,36,52,188
 TR 26,7,7776
 buffer_load_dwordx4 v[124:127], v1, s[44:47], s55 offen offset:3072 sc1
 s_waitcnt lgkmcnt(8)
 MF 192,40,48,192
 TR 28,7,5248
 MF 196,40,52,196
 TR 30,7,7808
 s_waitcnt lgkmcnt(8)
 MF 160,44,56,160
 s_barrier
 v_add_u32 v7, 0x5000, v7
 TR 32,7,0
 MF 164,44,60,164
 TR 34,7,2560
 s_add_u32 s54, s84, s85
 s_add_u32 s54, s54, 0x28000
 s_add_u32 m0, s85, 20480
 s_nop 0
 buffer_load_dwordx4 v1, s[44:47], s54 offen offset:0 sc1 lds
 s_waitcnt lgkmcnt(8)
 MF 168,16,56,168
 TR 36,7,32
 MF 172,16,60,172
 TR 38,7,2592
 buffer_load_dwordx4 v1, s[44:47], s54 offen offset:1024 sc1 lds
 s_waitcnt lgkmcnt(8)
 MF 176,20,56,176
 TR 40,7,64
 MF 180,20,60,180
 TR 42,7,2624
 s_waitcnt lgkmcnt(8)
 MF 184,24,56,184
 TR 44,7,96
 MF 188,24,60,188
 TR 46,7,2656
 s_waitcnt lgkmcnt(8)
 MF 192,28,56,192
 TR 16,7,128
 MF 196,28,60,196
 TR 18,7,2688
 s_waitcnt lgkmcnt(8)
 s_waitcnt vmcnt(20)
 MF 160,32,64,160
 TR 20,7,5120
 MF 164,32,68,164
 TR 22,7,7680
 s_add_u32 s55, s82, 65536
 buffer_load_dwordx4 v[48:51], v1, s[44:47], s55 offen offset:0 sc1
 s_waitcnt lgkmcnt(8)
 MF 168,36,64,168
 TR 24,7,5152
 MF 172,36,68,172
 TR 26,7,7712
 buffer_load_dwordx4 v[52:55], v1, s[44:47], s55 offen offset:1024 sc1
 s_waitcnt lgkmcnt(8)
 MF 176,40,64,176
 TR 28,7,5184
 MF 180,40,68,180
 TR 30,7,7744
 buffer_load_dwordx4 v[56:59], v1, s[44:47], s55 offen offset:2048 sc1
 s_waitcnt lgkmcnt(8)
 MF 184,44,64,184
 TR 32,7,5216
 MF 188,44,68,188
 TR 34,7,7776
 buffer_load_dwordx4 v[60:63], v1, s[44:47], s55 offen offset:3072 sc1
 s_waitcnt lgkmcnt(8)
 MF 192,16,64,192
 TR 36,7,5248
 MF 196,16,68,196
 TR 38,7,7808
 s_waitcnt lgkmcnt(8)
 s_waitcnt vmcnt(22)
 MF 160,20,72,160
 s_barrier
 v_add_u32 v7, 0x5000, v7
 TR 40,7,0
 MF 164,20,76,164
 TR 42,7,2560
 s_add_u32 s54, s84, s85
 s_add_u32 s54, s54, 0x2d000
 s_add_u32 m0, s85, 40960
 s_nop 0
 buffer_load_dwordx4 v1, s[44:47], s54 offen offset:0 sc1 lds
 s_waitcnt lgkmcnt(8)
 MF 168,24,72,168
 TR 44,7,32
 MF 172,24,76,172
 TR 46,7,2592
 buffer_load_dwordx4 v1, s[44:47], s54 offen offset:1024 sc1 lds
 s_waitcnt lgkmcnt(8)
 MF 176,28,72,176
 TR 16,7,64
 MF 180,28,76,180
 TR 18,7,2624
 s_waitcnt lgkmcnt(8)
 MF 184,32,72,184
 TR 20,7,96
 MF 188,32,76,188
 TR 22,7,2656
 s_waitcnt lgkmcnt(8)
 MF 192,36,72,192
 TR 24,7,128
 MF 196,36,76,196
 TR 26,7,2688
 s_waitcnt lgkmcnt(8)
 s_waitcnt vmcnt(22)
 MF 160,40,80,160
 TR 28,7,5120
 MF 164,40,84,164
 TR 30,7,7680
 s_add_u32 s55, s82, 73728
 buffer_load_dwordx4 v[64:67], v1, s[44:47], s55 offen offset:0 sc1
 s_waitcnt lgkmcnt(8)
 MF 168,44,80,168
 TR 32,7,5152
 MF 172,44,84,172
 TR 34,7,7712
 buffer_load_dwordx4 v[68:71], v1, s[44:47], s55 offen offset:1024 sc1
 s_waitcnt lgkmcnt(8)
 MF 176,16,80,176
 TR 36,7,5184
 MF 180,16,84,180
 TR 38,7,7744
 buffer_load_dwordx4 v[72:75], v1, s[44:47], s55 offen offset:2048 sc1
 s_waitcnt lgkmcnt(8)
 MF 184,20,80,184
 TR 40,7,5216
 MF 188,20,84,188
 TR 42,7,7776
 buffer_load_dwordx4 v[76:79], v1, s[44:47], s55 offen offset:3072 sc1
 s_waitcnt lgkmcnt(8)
 MF 192,24,80,192
 TR 44,7,5248
 MF 196,24,84,196
 TR 46,7,7808
 s_waitcnt lgkmcnt(8)
 s_waitcnt vmcnt(24)
 MF 160,28,88,160
 s_waitcnt vmcnt(22)
 s_barrier
 v_add_u32 v7, 0x5000, v7
 TR 16,7,0
 MF 164,28,92,164
 TR 18,7,2560
 s_add_u32 s54, s84, s85
 s_add_u32 s54, s54, 0x32000
 s_add_u32 m0, s85, 61440
 s_nop 0
 buffer_load_dwordx4 v1, s[44:47], s54 offen offset:0 sc1 lds
 s_waitcnt lgkmcnt(8)
 MF 168,32,88,168
 TR 20,7,32
 MF 172,32,92,172
 TR 22,7,2592
 buffer_load_dwordx4 v1, s[44:47], s54 offen offset:1024 sc1 lds
 s_waitcnt lgkmcnt(8)
 MF 176,36,88,176
 TR 24,7,64
 MF 180,36,92,180
 TR 26,7,2624
 s_waitcnt lgkmcnt(8)
 MF 184,40,88,184
 TR 28,7,96
 MF 188,40,92,188
 TR 30,7,2656
 s_waitcnt lgkmcnt(8)
 MF 192,44,88,192
 TR 32,7,128
 MF 196,44,92,196
 TR 34,7,2688
 s_waitcnt lgkmcnt(8)
 s_waitcnt vmcnt(22)
 MF 160,16,96,160
 TR 36,7,5120
 MF 164,16,100,164
 TR 38,7,7680
 s_add_u32 s55, s82, 81920
 buffer_load_dwordx4 v[80:83], v1, s[44:47], s55 offen offset:0 sc1
 s_waitcnt lgkmcnt(8)
 MF 168,20,96,168
 TR 40,7,5152
 MF 172,20,100,172
 TR 42,7,7712
 buffer_load_dwordx4 v[84:87], v1, s[44:47], s55 offen offset:1024 sc1
 s_waitcnt lgkmcnt(8)
 MF 176,24,96,176
 TR 44,7,5184
 MF 180,24,100,180
 TR 46,7,7744
 buffer_load_dwordx4 v[88:91], v1, s[44:47], s55 offen offset:2048 sc1
 s_waitcnt lgkmcnt(8)
 MF 184,28,96,184
 TR 16,7,5216
 MF 188,28,100,188
 TR 18,7,7776
 buffer_load_dwordx4 v[92:95], v1, s[44:47], s55 offen offset:3072 sc1
 s_waitcnt lgkmcnt(8)
 MF 192,32,96,192
 TR 20,7,5248
 MF 196,32,100,196
 TR 22,7,7808
 s_waitcnt lgkmcnt(8)
 s_waitcnt vmcnt(24)
 MF 160,36,104,160
 s_waitcnt vmcnt(22)
 s_barrier
 v_add_u32 v7, 0xfffdd000, v7
 TR 24,7,0
 MF 164,36,108,164
 TR 26,7,2560
 s_add_u32 s54, s84, s85
 s_add_u32 s54, s54, 0x37000
 s_add_u32 m0, s85, 81920
 s_nop 0
 buffer_load_dwordx4 v1, s[44:47], s54 offen offset:0 sc1 lds
 s_waitcnt lgkmcnt(8)
 MF 168,40,104,168
 TR 28,7,32
 MF 172,40,108,172
 TR 30,7,2592
 buffer_load_dwordx4 v1, s[44:47], s54 offen offset:1024 sc1 lds
 s_waitcnt lgkmcnt(8)
 MF 176,44,104,176
 TR 32,7,64
 MF 180,44,108,180
 TR 34,7,2624
 s_waitcnt lgkmcnt(8)
 MF 184,16,104,184
 TR 36,7,96
 MF 188,16,108,188
 TR 38,7,2656
 s_waitcnt lgkmcnt(8)
 MF 192,20,104,192
 TR 40,7,128
 MF 196,20,108,196
 TR 42,7,2688
 s_waitcnt lgkmcnt(8)
 s_waitcnt vmcnt(22)
 MF 160,24,112,160
 TR 44,7,5120
 MF 164,24,116,164
 TR 46,7,7680
 s_add_u32 s55, s82, 90112
 buffer_load_dwordx4 v[96:99], v1, s[44:47], s55 offen offset:0 sc1
 s_waitcnt lgkmcnt(8)
 MF 168,28,112,168
 TR 16,7,5152
 MF 172,28,116,172
 TR 18,7,7712
 buffer_load_dwordx4 v[100:103], v1, s[44:47], s55 offen offset:1024 sc1
 s_waitcnt lgkmcnt(8)
 MF 176,32,112,176
 TR 20,7,5184
 MF 180,32,116,180
 TR 22,7,7744
 buffer_load_dwordx4 v[104:107], v1, s[44:47], s55 offen offset:2048 sc1
 s_waitcnt lgkmcnt(8)
 MF 184,36,112,184
 TR 24,7,5216
 MF 188,36,116,188
 TR 26,7,7776
 buffer_load_dwordx4 v[108:111], v1, s[44:47], s55 offen offset:3072 sc1
 s_waitcnt lgkmcnt(8)
 MF 192,40,112,192
 TR 28,7,5248
 MF 196,40,116,196
 TR 30,7,7808
 s_waitcnt lgkmcnt(8)
 s_waitcnt vmcnt(24)
 MF 160,44,120,160
 s_waitcnt vmcnt(22)
 s_barrier
 s_add_u32 s86, s86, 128
 buffer_load_dword v10, v4, s[44:47], s86 offen sc1
 v_add_u32 v7, 0x5000, v7
 TR 32,7,0
 MF 164,44,124,164
 TR 34,7,2560
 s_add_u32 s54, s84, s85
 s_add_u32 s54, s54, 0x14000
 s_add_u32 m0, s85, 102400
 s_nop 0
 buffer_load_dwordx4 v1, s[44:47], s54 offen offset:0 sc1 lds
 s_waitcnt lgkmcnt(8)
 MF 168,16,120,168
 TR 36,7,32
 MF 172,16,124,172
 TR 38,7,2592
 buffer_load_dwordx4 v1, s[44:47], s54 offen offset:1024 sc1 lds
 s_waitcnt lgkmcnt(8)
 MF 176,20,120,176
 TR 40,7,64
 MF 180,20,124,180
 TR 42,7,2624
 s_waitcnt lgkmcnt(8)
 MF 184,24,120,184
 TR 44,7,96
 MF 188,24,124,188
 TR 46,7,2656
 s_waitcnt lgkmcnt(8)
 MF 192,28,120,192
 TR 16,7,128
 MF 196,28,124,196
 TR 18,7,2688
 s_waitcnt lgkmcnt(8)
 s_waitcnt vmcnt(23)
 MF 160,32,48,160
 TR 20,7,5120
 MF 164,32,52,164
 TR 22,7,7680
 s_waitcnt lgkmcnt(8)
 MF 168,36,48,168
 TR 24,7,5152
 MF 172,36,52,172
 TR 26,7,7712
 s_waitcnt lgkmcnt(8)
 MF 176,40,48,176
 TR 28,7,5184
 MF 180,40,52,180
 TR 30,7,7744
 s_waitcnt lgkmcnt(8)
 MF 184,44,48,184
 TR 32,7,5216
 MF 188,44,52,188
 TR 34,7,7776
 s_waitcnt lgkmcnt(8)
 MF 192,16,48,192
 TR 36,7,5248
 MF 196,16,52,196
 TR 38,7,7808
 s_waitcnt lgkmcnt(8)
 s_waitcnt vmcnt(21)
 MF 160,20,56,160
 s_waitcnt vmcnt(2)
 v_readfirstlane_b32 s57, v10
 s_cmp_ge_u32 s57, 8
 s_cbranch_scc1 Lpok_89
 s_mov_b32 s66, 0x10000
Lpoll_90:
 buffer_load_dword v10, v4, s[44:47], s86 offen sc1
 s_waitcnt vmcnt(0)
 v_readfirstlane_b32 s57, v10
 s_cmp_ge_u32 s57, 8
 s_cbranch_scc1 Lpolld_91
 s_sleep 2
 s_sub_u32 s66, s66, 1
 s_cmp_lg_u32 s66, 0
 s_cbranch_scc1 Lpoll_90
Lpolld_91:
Lpok_89:
 s_barrier
 v_add_u32 v7, 0x5000, v7
 TR 40,7,0
 MF 164,20,60,164
 TR 42,7,2560
 s_add_u32 s54, s84, s85
 s_add_u32 s54, s54, 0x19000
 s_add_u32 m0, s85, 122880
 s_nop 0
 buffer_load_dwordx4 v1, s[44:47], s54 offen offset:0 sc1 lds
 s_waitcnt lgkmcnt(8)
 MF 168,24,56,168
 TR 44,7,32
 MF 172,24,60,172
 TR 46,7,2592
 buffer_load_dwordx4 v1, s[44:47], s54 offen offset:1024 sc1 lds
 s_waitcnt lgkmcnt(8)
 MF 176,28,56,176
 TR 16,7,64
 MF 180,28,60,180
 TR 18,7,2624
 s_waitcnt lgkmcnt(8)
 MF 184,32,56,184
 TR 20,7,96
 MF 188,32,60,188
 TR 22,7,2656
 s_waitcnt lgkmcnt(8)
 MF 192,36,56,192
 TR 24,7,128
 MF 196,36,60,196
 TR 26,7,2688
 s_waitcnt lgkmcnt(8)
 MF 160,40,64,160
 TR 28,7,5120
 MF 164,40,68,164
 TR 30,7,7680
 s_add_u32 s55, s82, 32768
 buffer_load_dwordx4 v[112:115], v1, s[44:47], s55 offen offset:0 sc1
 buffer_load_dwordx4 v[116:119], v1, s[44:47], s55 offen offset:1024 sc1
 s_waitcnt lgkmcnt(8)
 MF 168,44,64,168
 TR 32,7,5152
 MF 172,44,68,172
 TR 34,7,7712
 buffer_load_dwordx4 v[120:123], v1, s[44:47], s55 offen offset:2048 sc1
 buffer_load_dwordx4 v[124:127], v1, s[44:47], s55 offen offset:3072 sc1
 s_waitcnt lgkmcnt(8)
 MF 176,16,64,176
 TR 36,7,5184
 MF 180,16,68,180
 TR 38,7,7744
 s_add_u32 s55, s82, 40960
 buffer_load_dwordx4 v[48:51], v1, s[44:47], s55 offen offset:0 sc1
 s_waitcnt lgkmcnt(8)
 MF 184,20,64,184
 TR 40,7,5216
 MF 188,20,68,188
 TR 42,7,7776
 buffer_load_dwordx4 v[52:55], v1, s[44:47], s55 offen offset:1024 sc1
 buffer_load_dwordx4 v[56:59], v1, s[44:47], s55 offen offset:2048 sc1
 s_waitcnt lgkmcnt(8)
 MF 192,24,64,192
 TR 44,7,5248
 MF 196,24,68,196
 TR 46,7,7808
 buffer_load_dwordx4 v[60:63], v1, s[44:47], s55 offen offset:3072 sc1
 s_waitcnt lgkmcnt(8)
 MF 160,28,72,160
 s_barrier
 v_add_u32 v7, 0x5000, v7
 TR 16,7,0
 MF 164,28,76,164
 TR 18,7,2560
 s_add_u32 s54, s84, s85
 s_add_u32 s54, s54, 0x1e000
 s_add_u32 m0, s85, 143360
 s_nop 0
 buffer_load_dwordx4 v1, s[44:47], s54 offen offset:0 sc1 lds
 s_waitcnt lgkmcnt(8)
 MF 168,32,72,168
 TR 20,7,32
 MF 172,32,76,172
 TR 22,7,2592
 buffer_load_dwordx4 v1, s[44:47], s54 offen offset:1024 sc1 lds
 s_waitcnt lgkmcnt(8)
 MF 176,36,72,176
 TR 24,7,64
 MF 180,36,76,180
 TR 26,7,2624
 s_waitcnt lgkmcnt(8)
 MF 184,40,72,184
 TR 28,7,96
 MF 188,40,76,188
 TR 30,7,2656
 s_waitcnt lgkmcnt(8)
 MF 192,44,72,192
 TR 32,7,128
 MF 196,44,76,196
 TR 34,7,2688
 s_waitcnt lgkmcnt(8)
 MF 160,16,80,160
 TR 36,7,5120
 MF 164,16,84,164
 TR 38,7,7680
 s_add_u32 s55, s82, 49152
 buffer_load_dwordx4 v[64:67], v1, s[44:47], s55 offen offset:0 sc1
 s_waitcnt lgkmcnt(8)
 MF 168,20,80,168
 TR 40,7,5152
 MF 172,20,84,172
 TR 42,7,7712
 buffer_load_dwordx4 v[68:71], v1, s[44:47], s55 offen offset:1024 sc1
 s_waitcnt lgkmcnt(8)
 MF 176,24,80,176
 TR 44,7,5184
 MF 180,24,84,180
 TR 46,7,7744
 buffer_load_dwordx4 v[72:75], v1, s[44:47], s55 offen offset:2048 sc1
 s_waitcnt lgkmcnt(8)
 MF 184,28,80,184
 TR 16,7,5216
 MF 188,28,84,188
 TR 18,7,7776
 buffer_load_dwordx4 v[76:79], v1, s[44:47], s55 offen offset:3072 sc1
 s_waitcnt lgkmcnt(8)
 MF 192,32,80,192
 TR 20,7,5248
 MF 196,32,84,196
 TR 22,7,7808
 s_waitcnt lgkmcnt(8)
 MF 160,36,88,160
 s_barrier
 v_add_u32 v7, 0x5000, v7
 TR 24,7,0
 MF 164,36,92,164
 TR 26,7,2560
 s_add_u32 s54, s84, s85
 s_add_u32 s54, s54, 0x23000
 s_add_u32 m0, s85, 0
 s_nop 0
 buffer_load_dwordx4 v1, s[44:47], s54 offen offset:0 sc1 lds
 s_waitcnt lgkmcnt(8)
 MF 168,40,88,168
 TR 28,7,32
 MF 172,40,92,172
 TR 30,7,2592
 buffer_load_dwordx4 v1, s[44:47], s54 offen offset:1024 sc1 lds
 s_waitcnt lgkmcnt(8)
 MF 176,44,88,176
 TR 32,7,64
 MF 180,44,92,180
 TR 34,7,2624
 s_waitcnt lgkmcnt(8)
 MF 184,16,88,184
 TR 36,7,96
 MF 188,16,92,188
 TR 38,7,2656
 s_waitcnt lgkmcnt(8)
 MF 192,20,88,192
 TR 40,7,128
 MF 196,20,92,196
 TR 42,7,2688
 s_waitcnt lgkmcnt(8)
 MF 160,24,96,160
 TR 44,7,5120
 MF 164,24,100,164
 TR 46,7,7680
 s_add_u32 s55, s82, 57344
 buffer_load_dwordx4 v[80:83], v1, s[44:47], s55 offen offset:0 sc1
 s_waitcnt lgkmcnt(8)
 MF 168,28,96,168
 TR 16,7,5152
 MF 172,28,100,172
 TR 18,7,7712
 buffer_load_dwordx4 v[84:87], v1, s[44:47], s55 offen offset:1024 sc1
 s_waitcnt lgkmcnt(8)
 MF 176,32,96,176
 TR 20,7,5184
 MF 180,32,100,180
 TR 22,7,7744
 buffer_load_dwordx4 v[88:91], v1, s[44:47], s55 offen offset:2048 sc1
 s_waitcnt lgkmcnt(8)
 MF 184,36,96,184
 TR 24,7,5216
 MF 188,36,100,188
 TR 26,7,7776
 buffer_load_dwordx4 v[92:95], v1, s[44:47], s55 offen offset:3072 sc1
 s_waitcnt lgkmcnt(8)
 MF 192,40,96,192
 TR 28,7,5248
 MF 196,40,100,196
 TR 30,7,7808
 s_waitcnt lgkmcnt(8)
 MF 160,44,104,160
 s_waitcnt vmcnt(22)
 s_barrier
 v_add_u32 v7, 0x5000, v7
 TR 32,7,0
 MF 164,44,108,164
 TR 34,7,2560
 s_add_u32 s54, s84, s85
 s_add_u32 s54, s54, 0x3c000
 s_add_u32 m0, s85, 20480
 s_nop 0
 buffer_load_dwordx4 v1, s[44:47], s54 offen offset:0 sc1 lds
 s_waitcnt lgkmcnt(8)
 MF 168,16,104,168
 TR 36,7,32
 MF 172,16,108,172
 TR 38,7,2592
 buffer_load_dwordx4 v1, s[44:47], s54 offen offset:1024 sc1 lds
 s_waitcnt lgkmcnt(8)
 MF 176,20,104,176
 TR 40,7,64
 MF 180,20,108,180
 TR 42,7,2624
 s_waitcnt lgkmcnt(8)
 MF 184,24,104,184
 TR 44,7,96
 MF 188,24,108,188
 TR 46,7,2656
 s_waitcnt lgkmcnt(8)
 MF 192,28,104,192
 TR 16,7,128
 MF 196,28,108,196
 TR 18,7,2688
 s_waitcnt lgkmcnt(8)
 s_waitcnt vmcnt(20)
 MF 160,32,112,160
 TR 20,7,5120
 MF 164,32,116,164
 TR 22,7,7680
 s_add_u32 s55, s82, 98304
 buffer_load_dwordx4 v[96:99], v1, s[44:47], s55 offen offset:0 sc1
 s_waitcnt lgkmcnt(8)
 MF 168,36,112,168
 TR 24,7,5152
 MF 172,36,116,172
 TR 26,7,7712
 buffer_load_dwordx4 v[100:103], v1, s[44:47], s55 offen offset:1024 sc1
 s_waitcnt lgkmcnt(8)
 MF 176,40,112,176
 TR 28,7,5184
 MF 180,40,116,180
 TR 30,7,7744
 buffer_load_dwordx4 v[104:107], v1, s[44:47], s55 offen offset:2048 sc1
 s_waitcnt lgkmcnt(8)
 MF 184,44,112,184
 TR 32,7,5216
 MF 188,44,116,188
 TR 34,7,7776
 buffer_load_dwordx4 v[108:111], v1, s[44:47], s55 offen offset:3072 sc1
 s_waitcnt lgkmcnt(8)
 MF 192,16,112,192
 TR 36,7,5248
 MF 196,16,116,196
 TR 38,7,7808
 s_waitcnt lgkmcnt(8)
 s_waitcnt vmcnt(22)
 MF 160,20,120,160
 s_barrier
 v_add_u32 v7, 0x5000, v7
 TR 40,7,0
 MF 164,20,124,164
 TR 42,7,2560
 s_add_u32 s54, s84, s85
 s_add_u32 s54, s54, 0x41000
 s_add_u32 m0, s85, 40960
 s_nop 0
 buffer_load_dwordx4 v1, s[44:47], s54 offen offset:0 sc1 lds
 s_waitcnt lgkmcnt(8)
 MF 168,24,120,168
 TR 44,7,32
 MF 172,24,124,172
 TR 46,7,2592
 buffer_load_dwordx4 v1, s[44:47], s54 offen offset:1024 sc1 lds
 s_waitcnt lgkmcnt(8)
 MF 176,28,120,176
 TR 16,7,64
 MF 180,28,124,180
 TR 18,7,2624
 s_waitcnt lgkmcnt(8)
 MF 184,32,120,184
 TR 20,7,96
 MF 188,32,124,188
 TR 22,7,2656
 s_waitcnt lgkmcnt(8)
 MF 192,36,120,192
 TR 24,7,128
 MF 196,36,124,196
 TR 26,7,2688
 s_waitcnt lgkmcnt(8)
 s_waitcnt vmcnt(22)
 MF 160,40,48,160
 TR 28,7,5120
 MF 164,40,52,164
 TR 30,7,7680
 s_add_u32 s55, s82, 106496
 buffer_load_dwordx4 v[112:115], v1, s[44:47], s55 offen offset:0 sc1
 s_waitcnt lgkmcnt(8)
 MF 168,44,48,168
 TR 32,7,5152
 MF 172,44,52,172
 TR 34,7,7712
 buffer_load_dwordx4 v[116:119], v1, s[44:47], s55 offen offset:1024 sc1
 s_waitcnt lgkmcnt(8)
 MF 176,16,48,176
 TR 36,7,5184
 MF 180,16,52,180
 TR 38,7,7744
 buffer_load_dwordx4 v[120:123], v1, s[44:47], s55 offen offset:2048 sc1
 s_waitcnt lgkmcnt(8)
 MF 184,20,48,184
 TR 40,7,5216
 MF 188,20,52,188
 TR 42,7,7776
 buffer_load_dwordx4 v[124:127], v1, s[44:47], s55 offen offset:3072 sc1
 s_waitcnt lgkmcnt(8)
 MF 192,24,48,192
 TR 44,7,5248
 MF 196,24,52,196
 TR 46,7,7808
 s_waitcnt lgkmcnt(8)
 s_waitcnt vmcnt(24)
 MF 160,28,56,160
 s_waitcnt vmcnt(22)
 s_barrier
 v_add_u32 v7, 0x5000, v7
 TR 16,7,0
 MF 164,28,60,164
 TR 18,7,2560
 s_add_u32 s54, s84, s85
 s_add_u32 s54, s54, 0x46000
 s_add_u32 m0, s85, 61440
 s_nop 0
 buffer_load_dwordx4 v1, s[44:47], s54 offen offset:0 sc1 lds
 s_waitcnt lgkmcnt(8)
 MF 168,32,56,168
 TR 20,7,32
 MF 172,32,60,172
 TR 22,7,2592
 buffer_load_dwordx4 v1, s[44:47], s54 offen offset:1024 sc1 lds
 s_waitcnt lgkmcnt(8)
 MF 176,36,56,176
 TR 24,7,64
 MF 180,36,60,180
 TR 26,7,2624
 s_waitcnt lgkmcnt(8)
 MF 184,40,56,184
 TR 28,7,96
 MF 188,40,60,188
 TR 30,7,2656
 s_waitcnt lgkmcnt(8)
 MF 192,44,56,192
 TR 32,7,128
 MF 196,44,60,196
 TR 34,7,2688
 s_waitcnt lgkmcnt(8)
 s_waitcnt vmcnt(22)
 MF 160,16,64,160
 TR 36,7,5120
 MF 164,16,68,164
 TR 38,7,7680
 s_add_u32 s55, s82, 114688
 buffer_load_dwordx4 v[48:51], v1, s[44:47], s55 offen offset:0 sc1
 s_waitcnt lgkmcnt(8)
 MF 168,20,64,168
 TR 40,7,5152
 MF 172,20,68,172
 TR 42,7,7712
 buffer_load_dwordx4 v[52:55], v1, s[44:47], s55 offen offset:1024 sc1
 s_waitcnt lgkmcnt(8)
 MF 176,24,64,176
 TR 44,7,5184
 MF 180,24,68,180
 TR 46,7,7744
 buffer_load_dwordx4 v[56:59], v1, s[44:47], s55 offen offset:2048 sc1
 s_waitcnt lgkmcnt(8)
 MF 184,28,64,184
 TR 16,7,5216
 MF 188,28,68,188
 TR 18,7,7776
 buffer_load_dwordx4 v[60:63], v1, s[44:47], s55 offen offset:3072 sc1
 s_waitcnt lgkmcnt(8)
 MF 192,32,64,192
 TR 20,7,5248
 MF 196,32,68,196
 TR 22,7,7808
 s_waitcnt lgkmcnt(8)
 s_waitcnt vmcnt(24)
 MF 160,36,72,160
 s_waitcnt vmcnt(22)
 s_barrier
 v_add_u32 v7, 0xfffdd000, v7
 TR 24,7,0
 MF 164,36,76,164
 TR 26,7,2560
 s_add_u32 s54, s84, s85
 s_add_u32 s54, s54, 0x4b000
 s_add_u32 m0, s85, 81920
 s_nop 0
 buffer_load_dwordx4 v1, s[44:47], s54 offen offset:0 sc1 lds
 s_waitcnt lgkmcnt(8)
 MF 168,40,72,168
 TR 28,7,32
 MF 172,40,76,172
 TR 30,7,2592
 buffer_load_dwordx4 v1, s[44:47], s54 offen offset:1024 sc1 lds
 s_waitcnt lgkmcnt(8)
 MF 176,44,72,176
 TR 32,7,64
 MF 180,44,76,180
 TR 34,7,2624
 s_waitcnt lgkmcnt(8)
 MF 184,16,72,184
 TR 36,7,96
 MF 188,16,76,188
 TR 38,7,2656
 s_waitcnt lgkmcnt(8)
 MF 192,20,72,192
 TR 40,7,128
 MF 196,20,76,196
 TR 42,7,2688
 s_waitcnt lgkmcnt(8)
 s_waitcnt vmcnt(22)
 MF 160,24,80,160
 TR 44,7,5120
 MF 164,24,84,164
 TR 46,7,7680
 s_add_u32 s55, s82, 122880
 buffer_load_dwordx4 v[64:67], v1, s[44:47], s55 offen offset:0 sc1
 s_waitcnt lgkmcnt(8)
 MF 168,28,80,168
 TR 16,7,5152
 MF 172,28,84,172
 TR 18,7,7712
 buffer_load_dwordx4 v[68:71], v1, s[44:47], s55 offen offset:1024 sc1
 s_waitcnt lgkmcnt(8)
 MF 176,32,80,176
 TR 20,7,5184
 MF 180,32,84,180
 TR 22,7,7744
 buffer_load_dwordx4 v[72:75], v1, s[44:47], s55 offen offset:2048 sc1
 s_waitcnt lgkmcnt(8)
 MF 184,36,80,184
 TR 24,7,5216
 MF 188,36,84,188
 TR 26,7,7776
 buffer_load_dwordx4 v[76:79], v1, s[44:47], s55 offen offset:3072 sc1
 s_waitcnt lgkmcnt(8)
 MF 192,40,80,192
 TR 28,7,5248
 MF 196,40,84,196
 TR 30,7,7808
 s_waitcnt lgkmcnt(8)
 s_waitcnt vmcnt(24)
 MF 160,44,88,160
 s_waitcnt vmcnt(22)
 s_barrier
 v_add_u32 v7, 0x5000, v7
 TR 32,7,0
 MF 164,44,92,164
 TR 34,7,2560
 s_waitcnt lgkmcnt(8)
 MF 168,16,88,168
 TR 36,7,32
 MF 172,16,92,172
 TR 38,7,2592
 s_waitcnt lgkmcnt(8)
 MF 176,20,88,176
 TR 40,7,64
 MF 180,20,92,180
 TR 42,7,2624
 s_waitcnt lgkmcnt(8)
 MF 184,24,88,184
 TR 44,7,96
 MF 188,24,92,188
 TR 46,7,2656
 s_waitcnt lgkmcnt(8)
 MF 192,28,88,192
 TR 16,7,128
 MF 196,28,92,196
 TR 18,7,2688
 s_waitcnt lgkmcnt(8)
 s_waitcnt vmcnt(20)
 MF 160,32,96,160
 TR 20,7,5120
 MF 164,32,100,164
 TR 22,7,7680
 s_waitcnt lgkmcnt(8)
 MF 168,36,96,168
 TR 24,7,5152
 MF 172,36,100,172
 TR 26,7,7712
 s_waitcnt lgkmcnt(8)
 MF 176,40,96,176
 TR 28,7,5184
 MF 180,40,100,180
 TR 30,7,7744
 s_waitcnt lgkmcnt(8)
 MF 184,44,96,184
 TR 32,7,5216
 MF 188,44,100,188
 TR 34,7,7776
 s_waitcnt lgkmcnt(8)
 MF 192,16,96,192
 TR 36,7,5248
 MF 196,16,100,196
 TR 38,7,7808
 s_waitcnt lgkmcnt(8)
 s_waitcnt vmcnt(18)
 MF 160,20,104,160
 s_waitcnt vmcnt(16)
 s_barrier
 v_add_u32 v7, 0x5000, v7
 TR 40,7,0
 MF 164,20,108,164
 TR 42,7,2560
 s_waitcnt lgkmcnt(8)
 MF 168,24,104,168
 TR 44,7,32
 MF 172,24,108,172
 TR 46,7,2592
 s_waitcnt lgkmcnt(8)
 MF 176,28,104,176
 TR 16,7,64
 MF 180,28,108,180
 TR 18,7,2624
 s_waitcnt lgkmcnt(8)
 MF 184,32,104,184
 TR 20,7,96
 MF 188,32,108,188
 TR 22,7,2656
 s_waitcnt lgkmcnt(8)
 MF 192,36,104,192
 TR 24,7,128
 MF 196,36,108,196
 TR 26,7,2688
 s_waitcnt lgkmcnt(8)
 s_waitcnt vmcnt(14)
 MF 160,40,112,160
 TR 28,7,5120
 MF 164,40,116,164
 TR 30,7,7680
 s_waitcnt lgkmcnt(8)
 MF 168,44,112,168
 TR 32,7,5152
 MF 172,44,116,172
 TR 34,7,7712
 s_waitcnt lgkmcnt(8)
 MF 176,16,112,176
 TR 36,7,5184
 MF 180,16,116,180
 TR 38,7,7744
 s_waitcnt lgkmcnt(8)
 MF 184,20,112,184
 TR 40,7,5216
 MF 188,20,116,188
 TR 42,7,7776
 s_waitcnt lgkmcnt(8)
 MF 192,24,112,192
 TR 44,7,5248
 MF 196,24,116,196
 TR 46,7,7808
 s_waitcnt lgkmcnt(8)
 s_waitcnt vmcnt(12)
 MF 160,28,120,160
 s_waitcnt vmcnt(10)
 s_barrier
 v_add_u32 v7, 0x5000, v7
 TR 16,7,0
 MF 164,28,124,164
 TR 18,7,2560
 s_waitcnt lgkmcnt(8)
 MF 168,32,120,168
 TR 20,7,32
 MF 172,32,124,172
 TR 22,7,2592
 s_waitcnt lgkmcnt(8)
 MF 176,36,120,176
 TR 24,7,64
 MF 180,36,124,180
 TR 26,7,2624
 s_waitcnt lgkmcnt(8)
 MF 184,40,120,184
 TR 28,7,96
 MF 188,40,124,188
 TR 30,7,2656
 s_waitcnt lgkmcnt(8)
 MF 192,44,120,192
 TR 32,7,128
 MF 196,44,124,196
 TR 34,7,2688
 s_waitcnt lgkmcnt(8)
 s_waitcnt vmcnt(8)
 MF 160,16,48,160
 TR 36,7,5120
 MF 164,16,52,164
 TR 38,7,7680
 s_waitcnt lgkmcnt(8)
 MF 168,20,48,168
 TR 40,7,5152
 MF 172,20,52,172
 TR 42,7,7712
 s_waitcnt lgkmcnt(8)
 MF 176,24,48,176
 TR 44,7,5184
 MF 180,24,52,180
 TR 46,7,7744
 s_waitcnt lgkmcnt(8)
 MF 184,28,48,184
 TR 16,7,5216
 MF 188,28,52,188
 TR 18,7,7776
 s_waitcnt lgkmcnt(8)
 MF 192,32,48,192
 TR 20,7,5248
 MF 196,32,52,196
 TR 22,7,7808
 s_waitcnt lgkmcnt(8)
 s_waitcnt vmcnt(6)
 MF 160,36,56,160
 s_waitcnt vmcnt(4)
 s_barrier
 v_add_u32 v7, 0x5000, v7
 TR 24,7,0
 MF 164,36,60,164
 TR 26,7,2560
 s_waitcnt lgkmcnt(8)
 MF 168,40,56,168
 TR 28,7,32
 MF 172,40,60,172
 TR 30,7,2592
 s_waitcnt lgkmcnt(8)
 MF 176,44,56,176
 TR 32,7,64
 MF 180,44,60,180
 TR 34,7,2624
 s_waitcnt lgkmcnt(8)
 MF 184,16,56,184
 TR 36,7,96
 MF 188,16,60,188
 TR 38,7,2656
 s_waitcnt lgkmcnt(8)
 MF 192,20,56,192
 TR 40,7,128
 MF 196,20,60,196
 TR 42,7,2688
 s_waitcnt lgkmcnt(8)
 s_waitcnt vmcnt(2)
 MF 160,24,64,160
 TR 44,7,5120
 MF 164,24,68,164
 TR 46,7,7680
 s_waitcnt lgkmcnt(8)
 MF 168,28,64,168
 TR 16,7,5152
 MF 172,28,68,172
 TR 18,7,7712
 s_waitcnt lgkmcnt(8)
 MF 176,32,64,176
 TR 20,7,5184
 MF 180,32,68,180
 TR 22,7,7744
 s_waitcnt lgkmcnt(8)
 MF 184,36,64,184
 TR 24,7,5216
 MF 188,36,68,188
 TR 26,7,7776
 s_waitcnt lgkmcnt(8)
 MF 192,40,64,192
 TR 28,7,5248
 MF 196,40,68,196
 TR 30,7,7808
 s_waitcnt lgkmcnt(8)
 s_waitcnt vmcnt(0)
 MF 160,44,72,160
 MF 164,44,76,164
 s_waitcnt lgkmcnt(6)
 MF 168,16,72,168
 MF 172,16,76,172
 s_waitcnt lgkmcnt(4)
 MF 176,20,72,176
 MF 180,20,76,180
 s_waitcnt lgkmcnt(2)
 MF 184,24,72,184
 MF 188,24,76,188
 s_waitcnt lgkmcnt(0)
 MF 192,28,72,192
 MF 196,28,76,196
 s_mul_i32 s57, s48, 5120
 v_add_u32 v5, s57, v1
 s_xor_b32 s58, s48, 4
 s_mul_i32 s58, s58, 5120
 v_add_u32 v10, s58, v1
 v_add_u32 v5, 0, v5
 v_add_u32 v10, 0, v10
 s_nop 2
 ds_write_b128 v5, v[164:167] offset:0
 ds_write_b128 v5, v[172:175] offset:1024
 ds_write_b128 v5, v[180:183] offset:2048
 ds_write_b128 v5, v[188:191] offset:3072
 ds_write_b128 v5, v[196:199] offset:4096
 s_bfe_u32 s56, s48, 0x10001
 s_cmp_eq_u32 s56, s80
 s_cselect_b32 s56, 0xc1, 0
 s_xor_b32 s58, s2, s56
 s_mul_i32 s54, s58, 0xac00
 s_add_u32 s54, s54, s57
 s_add_u32 s54, s54, 0x3ae0000
 s_lshl_b32 s76, s58, 7
 s_lshl_b32 s58, s48, 2
 s_add_u32 s76, s76, s58
 s_add_u32 s76, s76, 45056
 s_waitcnt lgkmcnt(0)
 s_barrier
 RD 16,10,0
 RD 20,10,1024
 RD 24,10,2048
 RD 28,10,3072
 RD 32,10,4096
 s_cmp_lg_u32 s56, 0
 s_cbranch_scc1 Lkeep_92
 s_waitcnt lgkmcnt(4)
 v_pk_add_f32 v[160:161], v[160:161], v[16:17]
 v_pk_add_f32 v[162:163], v[162:163], v[18:19]
 buffer_store_dwordx4 v[160:163], v1, s[44:47], s54 offen offset:0 sc1
 s_waitcnt lgkmcnt(3)
 v_pk_add_f32 v[168:169], v[168:169], v[20:21]
 v_pk_add_f32 v[170:171], v[170:171], v[22:23]
 buffer_store_dwordx4 v[168:171], v1, s[44:47], s54 offen offset:1024 sc1
 s_waitcnt lgkmcnt(2)
 v_pk_add_f32 v[176:177], v[176:177], v[24:25]
 v_pk_add_f32 v[178:179], v[178:179], v[26:27]
 buffer_store_dwordx4 v[176:179], v1, s[44:47], s54 offen offset:2048 sc1
 s_waitcnt lgkmcnt(1)
 v_pk_add_f32 v[184:185], v[184:185], v[28:29]
 v_pk_add_f32 v[186:187], v[186:187], v[30:31]
 buffer_store_dwordx4 v[184:187], v1, s[44:47], s54 offen offset:3072 sc1
 s_waitcnt lgkmcnt(0)
 v_pk_add_f32 v[192:193], v[192:193], v[32:33]
 v_pk_add_f32 v[194:195], v[194:195], v[34:35]
 buffer_store_dwordx4 v[192:195], v15, s[44:47], s54 offen offset:0 sc1
 v_mov_b32 v5, 1
 s_waitcnt vmcnt(0)
 s_mov_b64 exec, 1
 buffer_store_dword v5, v4, s[44:47], s76 offen sc1
 s_endpgm
Lkeep_92:
 s_waitcnt lgkmcnt(4)
 v_pk_add_f32 v[160:161], v[160:161], v[16:17]
 v_pk_add_f32 v[162:163], v[162:163], v[18:19]
 s_waitcnt lgkmcnt(3)
 v_pk_add_f32 v[168:169], v[168:169], v[20:21]
 v_pk_add_f32 v[170:171], v[170:171], v[22:23]
 s_waitcnt lgkmcnt(2)
 v_pk_add_f32 v[176:177], v[176:177], v[24:25]
 v_pk_add_f32 v[178:179], v[178:179], v[26:27]
 s_waitcnt lgkmcnt(1)
 v_pk_add_f32 v[184:185], v[184:185], v[28:29]
 v_pk_add_f32 v[186:187], v[186:187], v[30:31]
 s_waitcnt lgkmcnt(0)
 v_pk_add_f32 v[192:193], v[192:193], v[32:33]
 v_pk_add_f32 v[194:195], v[194:195], v[34:35]
 s_mov_b32 s66, 0x10000
Lpoll_93:
 buffer_load_dword v10, v4, s[44:47], s76 offen sc1
 s_waitcnt vmcnt(0)
 v_readfirstlane_b32 s57, v10
 s_cmp_ge_u32 s57, 1
 s_cbranch_scc1 Lpolld_94
 s_sleep 2
 s_sub_u32 s66, s66, 1
 s_cmp_lg_u32 s66, 0
 s_cbranch_scc1 Lpoll_93
Lpolld_94:
 buffer_load_dwordx4 v[16:19], v1, s[44:47], s54 offen offset:0 sc1
 buffer_load_dwordx4 v[20:23], v1, s[44:47], s54 offen offset:1024 sc1
 buffer_load_dwordx4 v[24:27], v1, s[44:47], s54 offen offset:2048 sc1
 buffer_load_dwordx4 v[28:31], v1, s[44:47], s54 offen offset:3072 sc1
 buffer_load_dwordx4 v[32:35], v15, s[44:47], s54 offen offset:0 sc1
 s_waitcnt vmcnt(4)
 v_pk_add_f32 v[160:161], v[160:161], v[16:17]
 v_pk_add_f32 v[162:163], v[162:163], v[18:19]
 v_cvt_pk_bf16_f32 v160, v160, v161
 v_cvt_pk_bf16_f32 v161, v162, v163
 buffer_store_dwordx2 v[160:161], v6, s[36:39], 0 offen offset:0
 s_waitcnt vmcnt(4)
 v_pk_add_f32 v[168:169], v[168:169], v[20:21]
 v_pk_add_f32 v[170:171], v[170:171], v[22:23]
 v_cvt_pk_bf16_f32 v168, v168, v169
 v_cvt_pk_bf16_f32 v169, v170, v171
 buffer_store_dwordx2 v[168:169], v6, s[36:39], 0 offen offset:32
 s_waitcnt vmcnt(4)
 v_pk_add_f32 v[176:177], v[176:177], v[24:25]
 v_pk_add_f32 v[178:179], v[178:179], v[26:27]
 v_cvt_pk_bf16_f32 v176, v176, v177
 v_cvt_pk_bf16_f32 v177, v178, v179
 buffer_store_dwordx2 v[176:177], v6, s[36:39], 0 offen offset:64
 s_waitcnt vmcnt(4)
 v_pk_add_f32 v[184:185], v[184:185], v[28:29]
 v_pk_add_f32 v[186:187], v[186:187], v[30:31]
 v_cvt_pk_bf16_f32 v184, v184, v185
 v_cvt_pk_bf16_f32 v185, v186, v187
 buffer_store_dwordx2 v[184:185], v6, s[36:39], 0 offen offset:96
 s_waitcnt vmcnt(4)
 v_pk_add_f32 v[192:193], v[192:193], v[32:33]
 v_pk_add_f32 v[194:195], v[194:195], v[34:35]
 v_cvt_pk_bf16_f32 v192, v192, v193
 v_cvt_pk_bf16_f32 v193, v194, v195
 buffer_store_dwordx2 v[192:193], v6, s[36:39], 0 offen offset:128
 s_endpgm
L_p3_S:
 s_cmp_lg_u32 s98, 0
 s_cbranch_scc1 LpreB_95
 s_add_u32 s55, s81, 32768
 buffer_load_dwordx4 v[112:115], v1, s[44:47], s55 offen offset:0 sc1
 buffer_load_dwordx4 v[116:119], v1, s[44:47], s55 offen offset:1024 sc1
 buffer_load_dwordx4 v[120:123], v1, s[44:47], s55 offen offset:2048 sc1
 buffer_load_dwordx4 v[124:127], v1, s[44:47], s55 offen offset:3072 sc1
 s_add_u32 s55, s81, 40960
 buffer_load_dwordx4 v[128:131], v1, s[44:47], s55 offen offset:0 sc1
 buffer_load_dwordx4 v[132:135], v1, s[44:47], s55 offen offset:1024 sc1
 buffer_load_dwordx4 v[136:139], v1, s[44:47], s55 offen offset:2048 sc1
 buffer_load_dwordx4 v[140:143], v1, s[44:47], s55 offen offset:3072 sc1
LpreB_95:
 s_lshl_b32 s57, s80, 4
 s_add_u32 s57, s57, s87
 s_cmp_eq_u32 s57, 24
 s_cbranch_scc1 L_p3_S1_8
L_p3_S0_8:
 v_mov_b32 v5, 1
 s_mov_b64 exec, 1
 buffer_atomic_add v5, v4, s[44:47], s76 offen
 s_mov_b64 exec, -1
 s_add_u32 s54, s83, s85
 s_add_u32 s54, s54, 0x5000
 s_add_u32 m0, s85, 0
 s_nop 0
 buffer_load_dwordx4 v1, s[44:47], s54 offen offset:0 sc1 lds
 buffer_load_dwordx4 v1, s[44:47], s54 offen offset:1024 sc1 lds
 buffer_load_dwordx4 v1, s[44:47], s54 offen offset:2048 sc1 lds
 s_add_u32 s54, s83, s85
 s_add_u32 s54, s54, 0xa000
 s_add_u32 m0, s85, 20480
 s_nop 0
 buffer_load_dwordx4 v1, s[44:47], s54 offen offset:0 sc1 lds
 buffer_load_dwordx4 v1, s[44:47], s54 offen offset:1024 sc1 lds
 buffer_load_dwordx4 v1, s[44:47], s54 offen offset:2048 sc1 lds
 s_add_u32 s54, s83, s85
 s_add_u32 s54, s54, 0xf000
 s_add_u32 m0, s85, 40960
 s_nop 0
 buffer_load_dwordx4 v1, s[44:47], s54 offen offset:0 sc1 lds
 buffer_load_dwordx4 v1, s[44:47], s54 offen offset:1024 sc1 lds
 buffer_load_dwordx4 v1, s[44:47], s54 offen offset:2048 sc1 lds
 s_add_u32 s54, s83, s85
 s_add_u32 s54, s54, 0x14000
 s_add_u32 m0, s85, 61440
 s_nop 0
 buffer_load_dwordx4 v1, s[44:47], s54 offen offset:0 sc1 lds
 buffer_load_dwordx4 v1, s[44:47], s54 offen offset:1024 sc1 lds
 buffer_load_dwordx4 v1, s[44:47], s54 offen offset:2048 sc1 lds
 s_waitcnt vmcnt(33)
 v_lshlrev_b32 v160, 16, v200
 v_and_b32 v161, 0xffff0000, v200
 v_lshlrev_b32 v162, 16, v201
 v_and_b32 v163, 0xffff0000, v201
 v_lshlrev_b32 v164, 16, v202
 v_and_b32 v165, 0xffff0000, v202
 v_lshlrev_b32 v166, 16, v203
 v_and_b32 v167, 0xffff0000, v203
 v_lshlrev_b32 v168, 16, v204
 v_and_b32 v169, 0xffff0000, v204
 v_lshlrev_b32 v170, 16, v205
 v_and_b32 v171, 0xffff0000, v205
 v_lshlrev_b32 v172, 16, v206
 v_and_b32 v173, 0xffff0000, v206
 v_lshlrev_b32 v174, 16, v207
 v_and_b32 v175, 0xffff0000, v207
 v_lshlrev_b32 v176, 16, v208
 v_and_b32 v177, 0xffff0000, v208
 v_lshlrev_b32 v178, 16, v209
 v_and_b32 v179, 0xffff0000, v209
 v_lshlrev_b32 v180, 16, v210
 v_and_b32 v181, 0xffff0000, v210
 v_lshlrev_b32 v182, 16, v211
 v_and_b32 v183, 0xffff0000, v211
 v_lshlrev_b32 v184, 16, v212
 v_and_b32 v185, 0xffff0000, v212
 v_lshlrev_b32 v186, 16, v213
 v_and_b32 v187, 0xffff0000, v213
 v_lshlrev_b32 v188, 16, v214
 v_and_b32 v189, 0xffff0000, v214
 v_lshlrev_b32 v190, 16, v215
 v_and_b32 v191, 0xffff0000, v215
 v_lshlrev_b32 v192, 16, v216
 v_and_b32 v193, 0xffff0000, v216
 v_lshlrev_b32 v194, 16, v217
 v_and_b32 v195, 0xffff0000, v217
 v_lshlrev_b32 v196, 16, v218
 v_and_b32 v197, 0xffff0000, v218
 v_lshlrev_b32 v198, 16, v219
 v_and_b32 v199, 0xffff0000, v219
 s_barrier
 TR 16,7,0
 TR 18,7,2560
 TR 20,7,32
 TR 22,7,2592
 TR 24,7,64
 TR 26,7,2624
 TR 28,7,96
 TR 30,7,2656
 TR 32,7,128
 TR 34,7,2688
 s_waitcnt lgkmcnt(8)
 MF 160,16,48,160
 TR 36,7,5120
 MF 164,16,52,164
 TR 38,7,7680
 s_waitcnt lgkmcnt(8)
 MF 168,20,48,168
 TR 40,7,5152
 MF 172,20,52,172
 TR 42,7,7712
 s_waitcnt lgkmcnt(8)
 MF 176,24,48,176
 TR 44,7,5184
 MF 180,24,52,180
 TR 46,7,7744
 s_waitcnt lgkmcnt(8)
 MF 184,28,48,184
 TR 16,7,5216
 MF 188,28,52,188
 TR 18,7,7776
 s_waitcnt lgkmcnt(8)
 MF 192,32,48,192
 TR 20,7,5248
 MF 196,32,52,196
 TR 22,7,7808
 s_waitcnt lgkmcnt(8)
 MF 160,36,56,160
 s_waitcnt vmcnt(9)
 s_barrier
 v_add_u32 v7, 0xfffdd000, v7
 TR 24,7,0
 MF 164,36,60,164
 TR 26,7,2560
 s_add_u32 s54, s83, s85
 s_add_u32 s54, s54, 0x19000
 s_add_u32 m0, s85, 81920
 s_nop 0
 buffer_load_dwordx4 v1, s[44:47], s54 offen offset:0 sc1 lds
 s_waitcnt lgkmcnt(8)
 MF 168,40,56,168
 TR 28,7,32
 MF 172,40,60,172
 TR 30,7,2592
 buffer_load_dwordx4 v1, s[44:47], s54 offen offset:1024 sc1 lds
 s_waitcnt lgkmcnt(8)
 MF 176,44,56,176
 TR 32,7,64
 MF 180,44,60,180
 TR 34,7,2624
 buffer_load_dwordx4 v1, s[44:47], s54 offen offset:2048 sc1 lds
 s_waitcnt lgkmcnt(8)
 MF 184,16,56,184
 TR 36,7,96
 MF 188,16,60,188
 TR 38,7,2656
 s_waitcnt lgkmcnt(8)
 MF 192,20,56,192
 TR 40,7,128
 MF 196,20,60,196
 TR 42,7,2688
 s_waitcnt lgkmcnt(8)
 MF 160,24,64,160
 TR 44,7,5120
 MF 164,24,68,164
 TR 46,7,7680
 s_waitcnt lgkmcnt(8)
 MF 168,28,64,168
 TR 16,7,5152
 MF 172,28,68,172
 TR 18,7,7712
 s_waitcnt lgkmcnt(8)
 MF 176,32,64,176
 TR 20,7,5184
 MF 180,32,68,180
 TR 22,7,7744
 s_waitcnt lgkmcnt(8)
 MF 184,36,64,184
 TR 24,7,5216
 MF 188,36,68,188
 TR 26,7,7776
 s_waitcnt lgkmcnt(8)
 MF 192,40,64,192
 TR 28,7,5248
 MF 196,40,68,196
 TR 30,7,7808
 s_waitcnt lgkmcnt(8)
 MF 160,44,72,160
 s_waitcnt vmcnt(9)
 s_barrier
 v_add_u32 v7, 0x5000, v7
 TR 32,7,0
 MF 164,44,76,164
 TR 34,7,2560
 s_add_u32 s54, s83, s85
 s_add_u32 s54, s54, 0x1e000
 s_add_u32 m0, s85, 102400
 s_nop 0
 buffer_load_dwordx4 v1, s[44:47], s54 offen offset:0 sc1 lds
 s_waitcnt lgkmcnt(8)
 MF 168,16,72,168
 TR 36,7,32
 MF 172,16,76,172
 TR 38,7,2592
 buffer_load_dwordx4 v1, s[44:47], s54 offen offset:1024 sc1 lds
 s_waitcnt lgkmcnt(8)
 MF 176,20,72,176
 TR 40,7,64
 MF 180,20,76,180
 TR 42,7,2624
 buffer_load_dwordx4 v1, s[44:47], s54 offen offset:2048 sc1 lds
 s_waitcnt lgkmcnt(8)
 MF 184,24,72,184
 TR 44,7,96
 MF 188,24,76,188
 TR 46,7,2656
 s_waitcnt lgkmcnt(8)
 MF 192,28,72,192
 TR 16,7,128
 MF 196,28,76,196
 TR 18,7,2688
 s_waitcnt lgkmcnt(8)
 MF 160,32,80,160
 TR 20,7,5120
 MF 164,32,84,164
 TR 22,7,7680
 s_add_u32 s55, s81, 49152
 buffer_load_dwordx4 v[144:147], v1, s[44:47], s55 offen offset:0 sc1
 s_waitcnt lgkmcnt(8)
 MF 168,36,80,168
 TR 24,7,5152
 MF 172,36,84,172
 TR 26,7,7712
 buffer_load_dwordx4 v[148:151], v1, s[44:47], s55 offen offset:1024 sc1
 s_waitcnt lgkmcnt(8)
 MF 176,40,80,176
 TR 28,7,5184
 MF 180,40,84,180
 TR 30,7,7744
 buffer_load_dwordx4 v[152:155], v1, s[44:47], s55 offen offset:2048 sc1
 s_waitcnt lgkmcnt(8)
 MF 184,44,80,184
 TR 32,7,5216
 MF 188,44,84,188
 TR 34,7,7776
 buffer_load_dwordx4 v[156:159], v1, s[44:47], s55 offen offset:3072 sc1
 s_waitcnt lgkmcnt(8)
 MF 192,16,80,192
 TR 36,7,5248
 MF 196,16,84,196
 TR 38,7,7808
 s_waitcnt lgkmcnt(8)
 MF 160,20,88,160
 s_waitcnt vmcnt(13)
 s_barrier
 v_add_u32 v7, 0x5000, v7
 TR 40,7,0
 MF 164,20,92,164
 TR 42,7,2560
 s_add_u32 s54, s83, s85
 s_add_u32 s54, s54, 0x23000
 s_add_u32 m0, s85, 122880
 s_nop 0
 buffer_load_dwordx4 v1, s[44:47], s54 offen offset:0 sc1 lds
 s_waitcnt lgkmcnt(8)
 MF 168,24,88,168
 TR 44,7,32
 MF 172,24,92,172
 TR 46,7,2592
 buffer_load_dwordx4 v1, s[44:47], s54 offen offset:1024 sc1 lds
 s_waitcnt lgkmcnt(8)
 MF 176,28,88,176
 TR 16,7,64
 MF 180,28,92,180
 TR 18,7,2624
 buffer_load_dwordx4 v1, s[44:47], s54 offen offset:2048 sc1 lds
 s_waitcnt lgkmcnt(8)
 MF 184,32,88,184
 TR 20,7,96
 MF 188,32,92,188
 TR 22,7,2656
 s_waitcnt lgkmcnt(8)
 MF 192,36,88,192
 TR 24,7,128
 MF 196,36,92,196
 TR 26,7,2688
 s_waitcnt lgkmcnt(8)
 MF 160,40,96,160
 TR 28,7,5120
 MF 164,40,100,164
 TR 30,7,7680
 s_add_u32 s55, s81, 57344
 buffer_load_dwordx4 v[48:51], v1, s[44:47], s55 offen offset:0 sc1
 s_waitcnt lgkmcnt(8)
 MF 168,44,96,168
 TR 32,7,5152
 MF 172,44,100,172
 TR 34,7,7712
 buffer_load_dwordx4 v[52:55], v1, s[44:47], s55 offen offset:1024 sc1
 s_waitcnt lgkmcnt(8)
 MF 176,16,96,176
 TR 36,7,5184
 MF 180,16,100,180
 TR 38,7,7744
 buffer_load_dwordx4 v[56:59], v1, s[44:47], s55 offen offset:2048 sc1
 s_waitcnt lgkmcnt(8)
 MF 184,20,96,184
 TR 40,7,5216
 MF 188,20,100,188
 TR 42,7,7776
 buffer_load_dwordx4 v[60:63], v1, s[44:47], s55 offen offset:3072 sc1
 s_waitcnt lgkmcnt(8)
 MF 192,24,96,192
 TR 44,7,5248
 MF 196,24,100,196
 TR 46,7,7808
 s_waitcnt lgkmcnt(8)
 MF 160,28,104,160
 s_waitcnt vmcnt(17)
 s_barrier
 buffer_load_dword v10, v4, s[44:47], s86 offen sc1
 v_add_u32 v7, 0x5000, v7
 TR 16,7,0
 MF 164,28,108,164
 TR 18,7,2560
 s_add_u32 s54, s84, s85
 s_add_u32 m0, s85, 143360
 s_nop 0
 buffer_load_dwordx4 v1, s[44:47], s54 offen offset:0 sc1 lds
 s_waitcnt lgkmcnt(8)
 MF 168,32,104,168
 TR 20,7,32
 MF 172,32,108,172
 TR 22,7,2592
 buffer_load_dwordx4 v1, s[44:47], s54 offen offset:1024 sc1 lds
 s_waitcnt lgkmcnt(8)
 MF 176,36,104,176
 TR 24,7,64
 MF 180,36,108,180
 TR 26,7,2624
 buffer_load_dwordx4 v1, s[44:47], s54 offen offset:2048 sc1 lds
 s_waitcnt lgkmcnt(8)
 MF 184,40,104,184
 TR 28,7,96
 MF 188,40,108,188
 TR 30,7,2656
 s_waitcnt lgkmcnt(8)
 MF 192,44,104,192
 TR 32,7,128
 MF 196,44,108,196
 TR 34,7,2688
 s_waitcnt lgkmcnt(8)
 MF 160,16,112,160
 TR 36,7,5120
 MF 164,16,116,164
 TR 38,7,7680
 s_waitcnt lgkmcnt(8)
 MF 168,20,112,168
 TR 40,7,5152
 MF 172,20,116,172
 TR 42,7,7712
 s_waitcnt lgkmcnt(8)
 MF 176,24,112,176
 TR 44,7,5184
 MF 180,24,116,180
 TR 46,7,7744
 s_waitcnt lgkmcnt(8)
 MF 184,28,112,184
 TR 16,7,5216
 MF 188,28,116,188
 TR 18,7,7776
 s_waitcnt lgkmcnt(8)
 MF 192,32,112,192
 TR 20,7,5248
 MF 196,32,116,196
 TR 22,7,7808
 s_waitcnt lgkmcnt(8)
 MF 160,36,120,160
 s_waitcnt vmcnt(3)
 v_readfirstlane_b32 s57, v10
 s_cmp_ge_u32 s57, 8
 s_cbranch_scc1 Lpok_96
 s_mov_b32 s66, 0x10000
Lpoll_97:
 buffer_load_dword v10, v4, s[44:47], s86 offen sc1
 s_waitcnt vmcnt(0)
 v_readfirstlane_b32 s57, v10
 s_cmp_ge_u32 s57, 8
 s_cbranch_scc1 Lpolld_98
 s_sleep 2
 s_sub_u32 s66, s66, 1
 s_cmp_lg_u32 s66, 0
 s_cbranch_scc1 Lpoll_97
Lpolld_98:
Lpok_96:
 s_barrier
 v_add_u32 v7, 0x5000, v7
 TR 24,7,0
 MF 164,36,124,164
 TR 26,7,2560
 s_add_u32 s54, s84, s85
 s_add_u32 s54, s54, 0x5000
 s_add_u32 m0, s85, 0
 s_nop 0
 buffer_load_dwordx4 v1, s[44:47], s54 offen offset:0 sc1 lds
 s_waitcnt lgkmcnt(8)
 MF 168,40,120,168
 TR 28,7,32
 MF 172,40,124,172
 TR 30,7,2592
 buffer_load_dwordx4 v1, s[44:47], s54 offen offset:1024 sc1 lds
 s_waitcnt lgkmcnt(8)
 MF 176,44,120,176
 TR 32,7,64
 MF 180,44,124,180
 TR 34,7,2624
 buffer_load_dwordx4 v1, s[44:47], s54 offen offset:2048 sc1 lds
 s_waitcnt lgkmcnt(8)
 MF 184,16,120,184
 TR 36,7,96
 MF 188,16,124,188
 TR 38,7,2656
 s_waitcnt lgkmcnt(8)
 MF 192,20,120,192
 TR 40,7,128
 MF 196,20,124,196
 TR 42,7,2688
 s_waitcnt lgkmcnt(8)
 MF 160,24,128,160
 TR 44,7,5120
 MF 164,24,132,164
 TR 46,7,7680
 s_add_u32 s55, s82, 0
 buffer_load_dwordx4 v[64:67], v1, s[44:47], s55 offen offset:0 sc1
 buffer_load_dwordx4 v[68:71], v1, s[44:47], s55 offen offset:1024 sc1
 s_waitcnt lgkmcnt(8)
 MF 168,28,128,168
 TR 16,7,5152
 MF 172,28,132,172
 TR 18,7,7712
 buffer_load_dwordx4 v[72:75], v1, s[44:47], s55 offen offset:2048 sc1
 buffer_load_dwordx4 v[76:79], v1, s[44:47], s55 offen offset:3072 sc1
 s_waitcnt lgkmcnt(8)
 MF 176,32,128,176
 TR 20,7,5184
 MF 180,32,132,180
 TR 22,7,7744
 s_add_u32 s55, s82, 8192
 buffer_load_dwordx4 v[80:83], v1, s[44:47], s55 offen offset:0 sc1
 s_waitcnt lgkmcnt(8)
 MF 184,36,128,184
 TR 24,7,5216
 MF 188,36,132,188
 TR 26,7,7776
 buffer_load_dwordx4 v[84:87], v1, s[44:47], s55 offen offset:1024 sc1
 buffer_load_dwordx4 v[88:91], v1, s[44:47], s55 offen offset:2048 sc1
 s_waitcnt lgkmcnt(8)
 MF 192,40,128,192
 TR 28,7,5248
 MF 196,40,132,196
 TR 30,7,7808
 buffer_load_dwordx4 v[92:95], v1, s[44:47], s55 offen offset:3072 sc1
 s_waitcnt lgkmcnt(8)
 MF 160,44,136,160
 s_barrier
 v_add_u32 v7, 0x5000, v7
 TR 32,7,0
 MF 164,44,140,164
 TR 34,7,2560
 s_add_u32 s54, s84, s85
 s_add_u32 s54, s54, 0xa000
 s_add_u32 m0, s85, 20480
 s_nop 0
 buffer_load_dwordx4 v1, s[44:47], s54 offen offset:0 sc1 lds
 s_waitcnt lgkmcnt(8)
 MF 168,16,136,168
 TR 36,7,32
 MF 172,16,140,172
 TR 38,7,2592
 buffer_load_dwordx4 v1, s[44:47], s54 offen offset:1024 sc1 lds
 s_waitcnt lgkmcnt(8)
 MF 176,20,136,176
 TR 40,7,64
 MF 180,20,140,180
 TR 42,7,2624
 buffer_load_dwordx4 v1, s[44:47], s54 offen offset:2048 sc1 lds
 s_waitcnt lgkmcnt(8)
 MF 184,24,136,184
 TR 44,7,96
 MF 188,24,140,188
 TR 46,7,2656
 s_waitcnt lgkmcnt(8)
 MF 192,28,136,192
 TR 16,7,128
 MF 196,28,140,196
 TR 18,7,2688
 s_waitcnt lgkmcnt(8)
 MF 160,32,144,160
 TR 20,7,5120
 MF 164,32,148,164
 TR 22,7,7680
 s_add_u32 s55, s82, 16384
 buffer_load_dwordx4 v[96:99], v1, s[44:47], s55 offen offset:0 sc1
 s_waitcnt lgkmcnt(8)
 MF 168,36,144,168
 TR 24,7,5152
 MF 172,36,148,172
 TR 26,7,7712
 buffer_load_dwordx4 v[100:103], v1, s[44:47], s55 offen offset:1024 sc1
 s_waitcnt lgkmcnt(8)
 MF 176,40,144,176
 TR 28,7,5184
 MF 180,40,148,180
 TR 30,7,7744
 buffer_load_dwordx4 v[104:107], v1, s[44:47], s55 offen offset:2048 sc1
 s_waitcnt lgkmcnt(8)
 MF 184,44,144,184
 TR 32,7,5216
 MF 188,44,148,188
 TR 34,7,7776
 buffer_load_dwordx4 v[108:111], v1, s[44:47], s55 offen offset:3072 sc1
 s_waitcnt lgkmcnt(8)
 MF 192,16,144,192
 TR 36,7,5248
 MF 196,16,148,196
 TR 38,7,7808
 s_waitcnt lgkmcnt(8)
 MF 160,20,152,160
 s_barrier
 v_add_u32 v7, 0x5000, v7
 TR 40,7,0
 MF 164,20,156,164
 TR 42,7,2560
 s_add_u32 s54, s84, s85
 s_add_u32 s54, s54, 0xf000
 s_add_u32 m0, s85, 40960
 s_nop 0
 buffer_load_dwordx4 v1, s[44:47], s54 offen offset:0 sc1 lds
 s_waitcnt lgkmcnt(8)
 MF 168,24,152,168
 TR 44,7,32
 MF 172,24,156,172
 TR 46,7,2592
 buffer_load_dwordx4 v1, s[44:47], s54 offen offset:1024 sc1 lds
 s_waitcnt lgkmcnt(8)
 MF 176,28,152,176
 TR 16,7,64
 MF 180,28,156,180
 TR 18,7,2624
 buffer_load_dwordx4 v1, s[44:47], s54 offen offset:2048 sc1 lds
 s_waitcnt lgkmcnt(8)
 MF 184,32,152,184
 TR 20,7,96
 MF 188,32,156,188
 TR 22,7,2656
 s_waitcnt lgkmcnt(8)
 MF 192,36,152,192
 TR 24,7,128
 MF 196,36,156,196
 TR 26,7,2688
 s_waitcnt lgkmcnt(8)
 MF 160,40,48,160
 TR 28,7,5120
 MF 164,40,52,164
 TR 30,7,7680
 s_add_u32 s55, s82, 24576
 buffer_load_dwordx4 v[112:115], v1, s[44:47], s55 offen offset:0 sc1
 s_waitcnt lgkmcnt(8)
 MF 168,44,48,168
 TR 32,7,5152
 MF 172,44,52,172
 TR 34,7,7712
 buffer_load_dwordx4 v[116:119], v1, s[44:47], s55 offen offset:1024 sc1
 s_waitcnt lgkmcnt(8)
 MF 176,16,48,176
 TR 36,7,5184
 MF 180,16,52,180
 TR 38,7,7744
 buffer_load_dwordx4 v[120:123], v1, s[44:47], s55 offen offset:2048 sc1
 s_waitcnt lgkmcnt(8)
 MF 184,20,48,184
 TR 40,7,5216
 MF 188,20,52,188
 TR 42,7,7776
 buffer_load_dwordx4 v[124:127], v1, s[44:47], s55 offen offset:3072 sc1
 s_waitcnt lgkmcnt(8)
 MF 192,24,48,192
 TR 44,7,5248
 MF 196,24,52,196
 TR 46,7,7808
 s_waitcnt lgkmcnt(8)
 MF 160,28,56,160
 s_waitcnt vmcnt(25)
 s_barrier
 v_add_u32 v7, 0x5000, v7
 TR 16,7,0
 MF 164,28,60,164
 TR 18,7,2560
 s_add_u32 s54, s84, s85
 s_add_u32 s54, s54, 0x28000
 s_add_u32 m0, s85, 61440
 s_nop 0
 buffer_load_dwordx4 v1, s[44:47], s54 offen offset:0 sc1 lds
 s_waitcnt lgkmcnt(8)
 MF 168,32,56,168
 TR 20,7,32
 MF 172,32,60,172
 TR 22,7,2592
 buffer_load_dwordx4 v1, s[44:47], s54 offen offset:1024 sc1 lds
 s_waitcnt lgkmcnt(8)
 MF 176,36,56,176
 TR 24,7,64
 MF 180,36,60,180
 TR 26,7,2624
 buffer_load_dwordx4 v1, s[44:47], s54 offen offset:2048 sc1 lds
 s_waitcnt lgkmcnt(8)
 MF 184,40,56,184
 TR 28,7,96
 MF 188,40,60,188
 TR 30,7,2656
 s_waitcnt lgkmcnt(8)
 MF 192,44,56,192
 TR 32,7,128
 MF 196,44,60,196
 TR 34,7,2688
 s_waitcnt lgkmcnt(8)
 s_waitcnt vmcnt(23)
 MF 160,16,64,160
 TR 36,7,5120
 MF 164,16,68,164
 TR 38,7,7680
 s_add_u32 s55, s82, 65536
 buffer_load_dwordx4 v[128:131], v1, s[44:47], s55 offen offset:0 sc1
 s_waitcnt lgkmcnt(8)
 MF 168,20,64,168
 TR 40,7,5152
 MF 172,20,68,172
 TR 42,7,7712
 buffer_load_dwordx4 v[132:135], v1, s[44:47], s55 offen offset:1024 sc1
 s_waitcnt lgkmcnt(8)
 MF 176,24,64,176
 TR 44,7,5184
 MF 180,24,68,180
 TR 46,7,7744
 buffer_load_dwordx4 v[136:139], v1, s[44:47], s55 offen offset:2048 sc1
 s_waitcnt lgkmcnt(8)
 MF 184,28,64,184
 TR 16,7,5216
 MF 188,28,68,188
 TR 18,7,7776
 buffer_load_dwordx4 v[140:143], v1, s[44:47], s55 offen offset:3072 sc1
 s_waitcnt lgkmcnt(8)
 MF 192,32,64,192
 TR 20,7,5248
 MF 196,32,68,196
 TR 22,7,7808
 s_waitcnt lgkmcnt(8)
 s_waitcnt vmcnt(25)
 MF 160,36,72,160
 s_barrier
 v_add_u32 v7, 0xfffdd000, v7
 TR 24,7,0
 MF 164,36,76,164
 TR 26,7,2560
 s_add_u32 s54, s84, s85
 s_add_u32 s54, s54, 0x2d000
 s_add_u32 m0, s85, 81920
 s_nop 0
 buffer_load_dwordx4 v1, s[44:47], s54 offen offset:0 sc1 lds
 s_waitcnt lgkmcnt(8)
 MF 168,40,72,168
 TR 28,7,32
 MF 172,40,76,172
 TR 30,7,2592
 buffer_load_dwordx4 v1, s[44:47], s54 offen offset:1024 sc1 lds
 s_waitcnt lgkmcnt(8)
 MF 176,44,72,176
 TR 32,7,64
 MF 180,44,76,180
 TR 34,7,2624
 buffer_load_dwordx4 v1, s[44:47], s54 offen offset:2048 sc1 lds
 s_waitcnt lgkmcnt(8)
 MF 184,16,72,184
 TR 36,7,96
 MF 188,16,76,188
 TR 38,7,2656
 s_waitcnt lgkmcnt(8)
 MF 192,20,72,192
 TR 40,7,128
 MF 196,20,76,196
 TR 42,7,2688
 s_waitcnt lgkmcnt(8)
 s_waitcnt vmcnt(26)
 MF 160,24,80,160
 TR 44,7,5120
 MF 164,24,84,164
 TR 46,7,7680
 s_add_u32 s55, s82, 73728
 buffer_load_dwordx4 v[144:147], v1, s[44:47], s55 offen offset:0 sc1
 s_waitcnt lgkmcnt(8)
 MF 168,28,80,168
 TR 16,7,5152
 MF 172,28,84,172
 TR 18,7,7712
 buffer_load_dwordx4 v[148:151], v1, s[44:47], s55 offen offset:1024 sc1
 s_waitcnt lgkmcnt(8)
 MF 176,32,80,176
 TR 20,7,5184
 MF 180,32,84,180
 TR 22,7,7744
 buffer_load_dwordx4 v[152:155], v1, s[44:47], s55 offen offset:2048 sc1
 s_waitcnt lgkmcnt(8)
 MF 184,36,80,184
 TR 24,7,5216
 MF 188,36,84,188
 TR 26,7,7776
 buffer_load_dwordx4 v[156:159], v1, s[44:47], s55 offen offset:3072 sc1
 s_waitcnt lgkmcnt(8)
 MF 192,40,80,192
 TR 28,7,5248
 MF 196,40,84,196
 TR 30,7,7808
 s_waitcnt lgkmcnt(8)
 s_waitcnt vmcnt(28)
 MF 160,44,88,160
 s_waitcnt vmcnt(25)
 s_barrier
 v_add_u32 v7, 0x5000, v7
 TR 32,7,0
 MF 164,44,92,164
 TR 34,7,2560
 s_add_u32 s54, s84, s85
 s_add_u32 s54, s54, 0x32000
 s_add_u32 m0, s85, 102400
 s_nop 0
 buffer_load_dwordx4 v1, s[44:47], s54 offen offset:0 sc1 lds
 s_waitcnt lgkmcnt(8)
 MF 168,16,88,168
 TR 36,7,32
 MF 172,16,92,172
 TR 38,7,2592
 buffer_load_dwordx4 v1, s[44:47], s54 offen offset:1024 sc1 lds
 s_waitcnt lgkmcnt(8)
 MF 176,20,88,176
 TR 40,7,64
 MF 180,20,92,180
 TR 42,7,2624
 buffer_load_dwordx4 v1, s[44:47], s54 offen offset:2048 sc1 lds
 s_waitcnt lgkmcnt(8)
 MF 184,24,88,184
 TR 44,7,96
 MF 188,24,92,188
 TR 46,7,2656
 s_waitcnt lgkmcnt(8)
 MF 192,28,88,192
 TR 16,7,128
 MF 196,28,92,196
 TR 18,7,2688
 s_waitcnt lgkmcnt(8)
 s_waitcnt vmcnt(26)
 MF 160,32,96,160
 TR 20,7,5120
 MF 164,32,100,164
 TR 22,7,7680
 s_add_u32 s55, s82, 81920
 buffer_load_dwordx4 v[48:51], v1, s[44:47], s55 offen offset:0 sc1
 s_waitcnt lgkmcnt(8)
 MF 168,36,96,168
 TR 24,7,5152
 MF 172,36,100,172
 TR 26,7,7712
 buffer_load_dwordx4 v[52:55], v1, s[44:47], s55 offen offset:1024 sc1
 s_waitcnt lgkmcnt(8)
 MF 176,40,96,176
 TR 28,7,5184
 MF 180,40,100,180
 TR 30,7,7744
 buffer_load_dwordx4 v[56:59], v1, s[44:47], s55 offen offset:2048 sc1
 s_waitcnt lgkmcnt(8)
 MF 184,44,96,184
 TR 32,7,5216
 MF 188,44,100,188
 TR 34,7,7776
 buffer_load_dwordx4 v[60:63], v1, s[44:47], s55 offen offset:3072 sc1
 s_waitcnt lgkmcnt(8)
 MF 192,16,96,192
 TR 36,7,5248
 MF 196,16,100,196
 TR 38,7,7808
 s_waitcnt lgkmcnt(8)
 s_waitcnt vmcnt(28)
 MF 160,20,104,160
 s_waitcnt vmcnt(25)
 s_barrier
 v_add_u32 v7, 0x5000, v7
 TR 40,7,0
 MF 164,20,108,164
 TR 42,7,2560
 s_add_u32 s54, s84, s85
 s_add_u32 s54, s54, 0x37000
 s_add_u32 m0, s85, 122880
 s_nop 0
 buffer_load_dwordx4 v1, s[44:47], s54 offen offset:0 sc1 lds
 s_waitcnt lgkmcnt(8)
 MF 168,24,104,168
 TR 44,7,32
 MF 172,24,108,172
 TR 46,7,2592
 buffer_load_dwordx4 v1, s[44:47], s54 offen offset:1024 sc1 lds
 s_waitcnt lgkmcnt(8)
 MF 176,28,104,176
 TR 16,7,64
 MF 180,28,108,180
 TR 18,7,2624
 buffer_load_dwordx4 v1, s[44:47], s54 offen offset:2048 sc1 lds
 s_waitcnt lgkmcnt(8)
 MF 184,32,104,184
 TR 20,7,96
 MF 188,32,108,188
 TR 22,7,2656
 s_waitcnt lgkmcnt(8)
 MF 192,36,104,192
 TR 24,7,128
 MF 196,36,108,196
 TR 26,7,2688
 s_waitcnt lgkmcnt(8)
 s_waitcnt vmcnt(26)
 MF 160,40,112,160
 TR 28,7,5120
 MF 164,40,116,164
 TR 30,7,7680
 s_add_u32 s55, s82, 90112
 buffer_load_dwordx4 v[64:67], v1, s[44:47], s55 offen offset:0 sc1
 s_waitcnt lgkmcnt(8)
 MF 168,44,112,168
 TR 32,7,5152
 MF 172,44,116,172
 TR 34,7,7712
 buffer_load_dwordx4 v[68:71], v1, s[44:47], s55 offen offset:1024 sc1
 s_waitcnt lgkmcnt(8)
 MF 176,16,112,176
 TR 36,7,5184
 MF 180,16,116,180
 TR 38,7,7744
 buffer_load_dwordx4 v[72:75], v1, s[44:47], s55 offen offset:2048 sc1
 s_waitcnt lgkmcnt(8)
 MF 184,20,112,184
 TR 40,7,5216
 MF 188,20,116,188
 TR 42,7,7776
 buffer_load_dwordx4 v[76:79], v1, s[44:47], s55 offen offset:3072 sc1
 s_waitcnt lgkmcnt(8)
 MF 192,24,112,192
 TR 44,7,5248
 MF 196,24,116,196
 TR 46,7,7808
 s_waitcnt lgkmcnt(8)
 s_waitcnt vmcnt(28)
 MF 160,28,120,160
 s_waitcnt vmcnt(25)
 s_barrier
 s_add_u32 s86, s86, 128
 buffer_load_dword v10, v4, s[44:47], s86 offen sc1
 v_add_u32 v7, 0x5000, v7
 TR 16,7,0
 MF 164,28,124,164
 TR 18,7,2560
 s_add_u32 s54, s84, s85
 s_add_u32 s54, s54, 0x14000
 s_add_u32 m0, s85, 143360
 s_nop 0
 buffer_load_dwordx4 v1, s[44:47], s54 offen offset:0 sc1 lds
 s_waitcnt lgkmcnt(8)
 MF 168,32,120,168
 TR 20,7,32
 MF 172,32,124,172
 TR 22,7,2592
 buffer_load_dwordx4 v1, s[44:47], s54 offen offset:1024 sc1 lds
 s_waitcnt lgkmcnt(8)
 MF 176,36,120,176
 TR 24,7,64
 MF 180,36,124,180
 TR 26,7,2624
 buffer_load_dwordx4 v1, s[44:47], s54 offen offset:2048 sc1 lds
 s_waitcnt lgkmcnt(8)
 MF 184,40,120,184
 TR 28,7,96
 MF 188,40,124,188
 TR 30,7,2656
 s_waitcnt lgkmcnt(8)
 MF 192,44,120,192
 TR 32,7,128
 MF 196,44,124,196
 TR 34,7,2688
 s_waitcnt lgkmcnt(8)
 s_waitcnt vmcnt(27)
 MF 160,16,128,160
 TR 36,7,5120
 MF 164,16,132,164
 TR 38,7,7680
 s_waitcnt lgkmcnt(8)
 MF 168,20,128,168
 TR 40,7,5152
 MF 172,20,132,172
 TR 42,7,7712
 s_waitcnt lgkmcnt(8)
 MF 176,24,128,176
 TR 44,7,5184
 MF 180,24,132,180
 TR 46,7,7744
 s_waitcnt lgkmcnt(8)
 MF 184,28,128,184
 TR 16,7,5216
 MF 188,28,132,188
 TR 18,7,7776
 s_waitcnt lgkmcnt(8)
 MF 192,32,128,192
 TR 20,7,5248
 MF 196,32,132,196
 TR 22,7,7808
 s_waitcnt lgkmcnt(8)
 s_waitcnt vmcnt(25)
 MF 160,36,136,160
 s_waitcnt vmcnt(3)
 v_readfirstlane_b32 s57, v10
 s_cmp_ge_u32 s57, 8
 s_cbranch_scc1 Lpok_99
 s_mov_b32 s66, 0x10000
Lpoll_100:
 buffer_load_dword v10, v4, s[44:47], s86 offen sc1
 s_waitcnt vmcnt(0)
 v_readfirstlane_b32 s57, v10
 s_cmp_ge_u32 s57, 8
 s_cbranch_scc1 Lpolld_101
 s_sleep 2
 s_sub_u32 s66, s66, 1
 s_cmp_lg_u32 s66, 0
 s_cbranch_scc1 Lpoll_100
Lpolld_101:
Lpok_99:
 s_barrier
 v_add_u32 v7, 0x5000, v7
 TR 24,7,0
 MF 164,36,140,164
 TR 26,7,2560
 s_add_u32 s54, s84, s85
 s_add_u32 s54, s54, 0x19000
 s_add_u32 m0, s85, 0
 s_nop 0
 buffer_load_dwordx4 v1, s[44:47], s54 offen offset:0 sc1 lds
 s_waitcnt lgkmcnt(8)
 MF 168,40,136,168
 TR 28,7,32
 MF 172,40,140,172
 TR 30,7,2592
 buffer_load_dwordx4 v1, s[44:47], s54 offen offset:1024 sc1 lds
 s_waitcnt lgkmcnt(8)
 MF 176,44,136,176
 TR 32,7,64
 MF 180,44,140,180
 TR 34,7,2624
 buffer_load_dwordx4 v1, s[44:47], s54 offen offset:2048 sc1 lds
 s_waitcnt lgkmcnt(8)
 MF 184,16,136,184
 TR 36,7,96
 MF 188,16,140,188
 TR 38,7,2656
 s_waitcnt lgkmcnt(8)
 MF 192,20,136,192
 TR 40,7,128
 MF 196,20,140,196
 TR 42,7,2688
 s_waitcnt lgkmcnt(8)
 MF 160,24,144,160
 TR 44,7,5120
 MF 164,24,148,164
 TR 46,7,7680
 s_add_u32 s55, s82, 32768
 buffer_load_dwordx4 v[80:83], v1, s[44:47], s55 offen offset:0 sc1
 buffer_load_dwordx4 v[84:87], v1, s[44:47], s55 offen offset:1024 sc1
 s_waitcnt lgkmcnt(8)
 MF 168,28,144,168
 TR 16,7,5152
 MF 172,28,148,172
 TR 18,7,7712
 buffer_load_dwordx4 v[88:91], v1, s[44:47], s55 offen offset:2048 sc1
 buffer_load_dwordx4 v[92:95], v1, s[44:47], s55 offen offset:3072 sc1
 s_waitcnt lgkmcnt(8)
 MF 176,32,144,176
 TR 20,7,5184
 MF 180,32,148,180
 TR 22,7,7744
 s_add_u32 s55, s82, 40960
 buffer_load_dwordx4 v[96:99], v1, s[44:47], s55 offen offset:0 sc1
 s_waitcnt lgkmcnt(8)
 MF 184,36,144,184
 TR 24,7,5216
 MF 188,36,148,188
 TR 26,7,7776
 buffer_load_dwordx4 v[100:103], v1, s[44:47], s55 offen offset:1024 sc1
 buffer_load_dwordx4 v[104:107], v1, s[44:47], s55 offen offset:2048 sc1
 s_waitcnt lgkmcnt(8)
 MF 192,40,144,192
 TR 28,7,5248
 MF 196,40,148,196
 TR 30,7,7808
 buffer_load_dwordx4 v[108:111], v1, s[44:47], s55 offen offset:3072 sc1
 s_waitcnt lgkmcnt(8)
 MF 160,44,152,160
 s_barrier
 v_add_u32 v7, 0x5000, v7
 TR 32,7,0
 MF 164,44,156,164
 TR 34,7,2560
 s_add_u32 s54, s84, s85
 s_add_u32 s54, s54, 0x1e000
 s_add_u32 m0, s85, 20480
 s_nop 0
 buffer_load_dwordx4 v1, s[44:47], s54 offen offset:0 sc1 lds
 s_waitcnt lgkmcnt(8)
 MF 168,16,152,168
 TR 36,7,32
 MF 172,16,156,172
 TR 38,7,2592
 buffer_load_dwordx4 v1, s[44:47], s54 offen offset:1024 sc1 lds
 s_waitcnt lgkmcnt(8)
 MF 176,20,152,176
 TR 40,7,64
 MF 180,20,156,180
 TR 42,7,2624
 buffer_load_dwordx4 v1, s[44:47], s54 offen offset:2048 sc1 lds
 s_waitcnt lgkmcnt(8)
 MF 184,24,152,184
 TR 44,7,96
 MF 188,24,156,188
 TR 46,7,2656
 s_waitcnt lgkmcnt(8)
 MF 192,28,152,192
 TR 16,7,128
 MF 196,28,156,196
 TR 18,7,2688
 s_waitcnt lgkmcnt(8)
 MF 160,32,48,160
 TR 20,7,5120
 MF 164,32,52,164
 TR 22,7,7680
 s_add_u32 s55, s82, 49152
 buffer_load_dwordx4 v[112:115], v1, s[44:47], s55 offen offset:0 sc1
 s_waitcnt lgkmcnt(8)
 MF 168,36,48,168
 TR 24,7,5152
 MF 172,36,52,172
 TR 26,7,7712
 buffer_load_dwordx4 v[116:119], v1, s[44:47], s55 offen offset:1024 sc1
 s_waitcnt lgkmcnt(8)
 MF 176,40,48,176
 TR 28,7,5184
 MF 180,40,52,180
 TR 30,7,7744
 buffer_load_dwordx4 v[120:123], v1, s[44:47], s55 offen offset:2048 sc1
 s_waitcnt lgkmcnt(8)
 MF 184,44,48,184
 TR 32,7,5216
 MF 188,44,52,188
 TR 34,7,7776
 buffer_load_dwordx4 v[124:127], v1, s[44:47], s55 offen offset:3072 sc1
 s_waitcnt lgkmcnt(8)
 MF 192,16,48,192
 TR 36,7,5248
 MF 196,16,52,196
 TR 38,7,7808
 s_waitcnt lgkmcnt(8)
 MF 160,20,56,160
 s_barrier
 v_add_u32 v7, 0x5000, v7
 TR 40,7,0
 MF 164,20,60,164
 TR 42,7,2560
 s_add_u32 s54, s84, s85
 s_add_u32 s54, s54, 0x23000
 s_add_u32 m0, s85, 40960
 s_nop 0
 buffer_load_dwordx4 v1, s[44:47], s54 offen offset:0 sc1 lds
 s_waitcnt lgkmcnt(8)
 MF 168,24,56,168
 TR 44,7,32
 MF 172,24,60,172
 TR 46,7,2592
 buffer_load_dwordx4 v1, s[44:47], s54 offen offset:1024 sc1 lds
 s_waitcnt lgkmcnt(8)
 MF 176,28,56,176
 TR 16,7,64
 MF 180,28,60,180
 TR 18,7,2624
 buffer_load_dwordx4 v1, s[44:47], s54 offen offset:2048 sc1 lds
 s_waitcnt lgkmcnt(8)
 MF 184,32,56,184
 TR 20,7,96
 MF 188,32,60,188
 TR 22,7,2656
 s_waitcnt lgkmcnt(8)
 MF 192,36,56,192
 TR 24,7,128
 MF 196,36,60,196
 TR 26,7,2688
 s_waitcnt lgkmcnt(8)
 MF 160,40,64,160
 TR 28,7,5120
 MF 164,40,68,164
 TR 30,7,7680
 s_add_u32 s55, s82, 57344
 buffer_load_dwordx4 v[128:131], v1, s[44:47], s55 offen offset:0 sc1
 s_waitcnt lgkmcnt(8)
 MF 168,44,64,168
 TR 32,7,5152
 MF 172,44,68,172
 TR 34,7,7712
 buffer_load_dwordx4 v[132:135], v1, s[44:47], s55 offen offset:1024 sc1
 s_waitcnt lgkmcnt(8)
 MF 176,16,64,176
 TR 36,7,5184
 MF 180,16,68,180
 TR 38,7,7744
 buffer_load_dwordx4 v[136:139], v1, s[44:47], s55 offen offset:2048 sc1
 s_waitcnt lgkmcnt(8)
 MF 184,20,64,184
 TR 40,7,5216
 MF 188,20,68,188
 TR 42,7,7776
 buffer_load_dwordx4 v[140:143], v1, s[44:47], s55 offen offset:3072 sc1
 s_waitcnt lgkmcnt(8)
 MF 192,24,64,192
 TR 44,7,5248
 MF 196,24,68,196
 TR 46,7,7808
 s_waitcnt lgkmcnt(8)
 MF 160,28,72,160
 s_waitcnt vmcnt(25)
 s_barrier
 v_add_u32 v7, 0x5000, v7
 TR 16,7,0
 MF 164,28,76,164
 TR 18,7,2560
 s_add_u32 s54, s84, s85
 s_add_u32 s54, s54, 0x3c000
 s_add_u32 m0, s85, 61440
 s_nop 0
 buffer_load_dwordx4 v1, s[44:47], s54 offen offset:0 sc1 lds
 s_waitcnt lgkmcnt(8)
 MF 168,32,72,168
 TR 20,7,32
 MF 172,32,76,172
 TR 22,7,2592
 buffer_load_dwordx4 v1, s[44:47], s54 offen offset:1024 sc1 lds
 s_waitcnt lgkmcnt(8)
 MF 176,36,72,176
 TR 24,7,64
 MF 180,36,76,180
 TR 26,7,2624
 buffer_load_dwordx4 v1, s[44:47], s54 offen offset:2048 sc1 lds
 s_waitcnt lgkmcnt(8)
 MF 184,40,72,184
 TR 28,7,96
 MF 188,40,76,188
 TR 30,7,2656
 s_waitcnt lgkmcnt(8)
 MF 192,44,72,192
 TR 32,7,128
 MF 196,44,76,196
 TR 34,7,2688
 s_waitcnt lgkmcnt(8)
 s_waitcnt vmcnt(23)
 MF 160,16,80,160
 TR 36,7,5120
 MF 164,16,84,164
 TR 38,7,7680
 s_add_u32 s55, s82, 98304
 buffer_load_dwordx4 v[144:147], v1, s[44:47], s55 offen offset:0 sc1
 s_waitcnt lgkmcnt(8)
 MF 168,20,80,168
 TR 40,7,5152
 MF 172,20,84,172
 TR 42,7,7712
 buffer_load_dwordx4 v[148:151], v1, s[44:47], s55 offen offset:1024 sc1
 s_waitcnt lgkmcnt(8)
 MF 176,24,80,176
 TR 44,7,5184
 MF 180,24,84,180
 TR 46,7,7744
 buffer_load_dwordx4 v[152:155], v1, s[44:47], s55 offen offset:2048 sc1
 s_waitcnt lgkmcnt(8)
 MF 184,28,80,184
 TR 16,7,5216
 MF 188,28,84,188
 TR 18,7,7776
 buffer_load_dwordx4 v[156:159], v1, s[44:47], s55 offen offset:3072 sc1
 s_waitcnt lgkmcnt(8)
 MF 192,32,80,192
 TR 20,7,5248
 MF 196,32,84,196
 TR 22,7,7808
 s_waitcnt lgkmcnt(8)
 s_waitcnt vmcnt(25)
 MF 160,36,88,160
 s_barrier
 v_add_u32 v7, 0xfffdd000, v7
 TR 24,7,0
 MF 164,36,92,164
 TR 26,7,2560
 s_add_u32 s54, s84, s85
 s_add_u32 s54, s54, 0x41000
 s_add_u32 m0, s85, 81920
 s_nop 0
 buffer_load_dwordx4 v1, s[44:47], s54 offen offset:0 sc1 lds
 s_waitcnt lgkmcnt(8)
 MF 168,40,88,168
 TR 28,7,32
 MF 172,40,92,172
 TR 30,7,2592
 buffer_load_dwordx4 v1, s[44:47], s54 offen offset:1024 sc1 lds
 s_waitcnt lgkmcnt(8)
 MF 176,44,88,176
 TR 32,7,64
 MF 180,44,92,180
 TR 34,7,2624
 buffer_load_dwordx4 v1, s[44:47], s54 offen offset:2048 sc1 lds
 s_waitcnt lgkmcnt(8)
 MF 184,16,88,184
 TR 36,7,96
 MF 188,16,92,188
 TR 38,7,2656
 s_waitcnt lgkmcnt(8)
 MF 192,20,88,192
 TR 40,7,128
 MF 196,20,92,196
 TR 42,7,2688
 s_waitcnt lgkmcnt(8)
 s_waitcnt vmcnt(26)
 MF 160,24,96,160
 TR 44,7,5120
 MF 164,24,100,164
 TR 46,7,7680
 s_add_u32 s55, s82, 106496
 buffer_load_dwordx4 v[48:51], v1, s[44:47], s55 offen offset:0 sc1
 s_waitcnt lgkmcnt(8)
 MF 168,28,96,168
 TR 16,7,5152
 MF 172,28,100,172
 TR 18,7,7712
 buffer_load_dwordx4 v[52:55], v1, s[44:47], s55 offen offset:1024 sc1
 s_waitcnt lgkmcnt(8)
 MF 176,32,96,176
 TR 20,7,5184
 MF 180,32,100,180
 TR 22,7,7744
 buffer_load_dwordx4 v[56:59], v1, s[44:47], s55 offen offset:2048 sc1
 s_waitcnt lgkmcnt(8)
 MF 184,36,96,184
 TR 24,7,5216
 MF 188,36,100,188
 TR 26,7,7776
 buffer_load_dwordx4 v[60:63], v1, s[44:47], s55 offen offset:3072 sc1
 s_waitcnt lgkmcnt(8)
 MF 192,40,96,192
 TR 28,7,5248
 MF 196,40,100,196
 TR 30,7,7808
 s_waitcnt lgkmcnt(8)
 s_waitcnt vmcnt(28)
 MF 160,44,104,160
 s_waitcnt vmcnt(25)
 s_barrier
 v_add_u32 v7, 0x5000, v7
 TR 32,7,0
 MF 164,44,108,164
 TR 34,7,2560
 s_add_u32 s54, s84, s85
 s_add_u32 s54, s54, 0x46000
 s_add_u32 m0, s85, 102400
 s_nop 0
 buffer_load_dwordx4 v1, s[44:47], s54 offen offset:0 sc1 lds
 s_waitcnt lgkmcnt(8)
 MF 168,16,104,168
 TR 36,7,32
 MF 172,16,108,172
 TR 38,7,2592
 buffer_load_dwordx4 v1, s[44:47], s54 offen offset:1024 sc1 lds
 s_waitcnt lgkmcnt(8)
 MF 176,20,104,176
 TR 40,7,64
 MF 180,20,108,180
 TR 42,7,2624
 buffer_load_dwordx4 v1, s[44:47], s54 offen offset:2048 sc1 lds
 s_waitcnt lgkmcnt(8)
 MF 184,24,104,184
 TR 44,7,96
 MF 188,24,108,188
 TR 46,7,2656
 s_waitcnt lgkmcnt(8)
 MF 192,28,104,192
 TR 16,7,128
 MF 196,28,108,196
 TR 18,7,2688
 s_waitcnt lgkmcnt(8)
 s_waitcnt vmcnt(26)
 MF 160,32,112,160
 TR 20,7,5120
 MF 164,32,116,164
 TR 22,7,7680
 s_add_u32 s55, s82, 114688
 buffer_load_dwordx4 v[64:67], v1, s[44:47], s55 offen offset:0 sc1
 s_waitcnt lgkmcnt(8)
 MF 168,36,112,168
 TR 24,7,5152
 MF 172,36,116,172
 TR 26,7,7712
 buffer_load_dwordx4 v[68:71], v1, s[44:47], s55 offen offset:1024 sc1
 s_waitcnt lgkmcnt(8)
 MF 176,40,112,176
 TR 28,7,5184
 MF 180,40,116,180
 TR 30,7,7744
 buffer_load_dwordx4 v[72:75], v1, s[44:47], s55 offen offset:2048 sc1
 s_waitcnt lgkmcnt(8)
 MF 184,44,112,184
 TR 32,7,5216
 MF 188,44,116,188
 TR 34,7,7776
 buffer_load_dwordx4 v[76:79], v1, s[44:47], s55 offen offset:3072 sc1
 s_waitcnt lgkmcnt(8)
 MF 192,16,112,192
 TR 36,7,5248
 MF 196,16,116,196
 TR 38,7,7808
 s_waitcnt lgkmcnt(8)
 s_waitcnt vmcnt(28)
 MF 160,20,120,160
 s_waitcnt vmcnt(25)
 s_barrier
 v_add_u32 v7, 0x5000, v7
 TR 40,7,0
 MF 164,20,124,164
 TR 42,7,2560
 s_add_u32 s54, s84, s85
 s_add_u32 s54, s54, 0x4b000
 s_add_u32 m0, s85, 122880
 s_nop 0
 buffer_load_dwordx4 v1, s[44:47], s54 offen offset:0 sc1 lds
 s_waitcnt lgkmcnt(8)
 MF 168,24,120,168
 TR 44,7,32
 MF 172,24,124,172
 TR 46,7,2592
 buffer_load_dwordx4 v1, s[44:47], s54 offen offset:1024 sc1 lds
 s_waitcnt lgkmcnt(8)
 MF 176,28,120,176
 TR 16,7,64
 MF 180,28,124,180
 TR 18,7,2624
 buffer_load_dwordx4 v1, s[44:47], s54 offen offset:2048 sc1 lds
 s_waitcnt lgkmcnt(8)
 MF 184,32,120,184
 TR 20,7,96
 MF 188,32,124,188
 TR 22,7,2656
 s_waitcnt lgkmcnt(8)
 MF 192,36,120,192
 TR 24,7,128
 MF 196,36,124,196
 TR 26,7,2688
 s_waitcnt lgkmcnt(8)
 s_waitcnt vmcnt(26)
 MF 160,40,128,160
 TR 28,7,5120
 MF 164,40,132,164
 TR 30,7,7680
 s_add_u32 s55, s82, 122880
 buffer_load_dwordx4 v[80:83], v1, s[44:47], s55 offen offset:0 sc1
 s_waitcnt lgkmcnt(8)
 MF 168,44,128,168
 TR 32,7,5152
 MF 172,44,132,172
 TR 34,7,7712
 buffer_load_dwordx4 v[84:87], v1, s[44:47], s55 offen offset:1024 sc1
 s_waitcnt lgkmcnt(8)
 MF 176,16,128,176
 TR 36,7,5184
 MF 180,16,132,180
 TR 38,7,7744
 buffer_load_dwordx4 v[88:91], v1, s[44:47], s55 offen offset:2048 sc1
 s_waitcnt lgkmcnt(8)
 MF 184,20,128,184
 TR 40,7,5216
 MF 188,20,132,188
 TR 42,7,7776
 buffer_load_dwordx4 v[92:95], v1, s[44:47], s55 offen offset:3072 sc1
 s_waitcnt lgkmcnt(8)
 MF 192,24,128,192
 TR 44,7,5248
 MF 196,24,132,196
 TR 46,7,7808
 s_waitcnt lgkmcnt(8)
 s_waitcnt vmcnt(28)
 MF 160,28,136,160
 s_waitcnt vmcnt(25)
 s_barrier
 v_add_u32 v7, 0x5000, v7
 TR 16,7,0
 MF 164,28,140,164
 TR 18,7,2560
 s_waitcnt lgkmcnt(8)
 MF 168,32,136,168
 TR 20,7,32
 MF 172,32,140,172
 TR 22,7,2592
 s_waitcnt lgkmcnt(8)
 MF 176,36,136,176
 TR 24,7,64
 MF 180,36,140,180
 TR 26,7,2624
 s_waitcnt lgkmcnt(8)
 MF 184,40,136,184
 TR 28,7,96
 MF 188,40,140,188
 TR 30,7,2656
 s_waitcnt lgkmcnt(8)
 MF 192,44,136,192
 TR 32,7,128
 MF 196,44,140,196
 TR 34,7,2688
 s_waitcnt lgkmcnt(8)
 s_waitcnt vmcnt(23)
 MF 160,16,144,160
 TR 36,7,5120
 MF 164,16,148,164
 TR 38,7,7680
 s_waitcnt lgkmcnt(8)
 MF 168,20,144,168
 TR 40,7,5152
 MF 172,20,148,172
 TR 42,7,7712
 s_waitcnt lgkmcnt(8)
 MF 176,24,144,176
 TR 44,7,5184
 MF 180,24,148,180
 TR 46,7,7744
 s_waitcnt lgkmcnt(8)
 MF 184,28,144,184
 TR 16,7,5216
 MF 188,28,148,188
 TR 18,7,7776
 s_waitcnt lgkmcnt(8)
 MF 192,32,144,192
 TR 20,7,5248
 MF 196,32,148,196
 TR 22,7,7808
 s_waitcnt lgkmcnt(8)
 s_waitcnt vmcnt(21)
 MF 160,36,152,160
 s_waitcnt vmcnt(18)
 s_barrier
 v_add_u32 v7, 0x5000, v7
 TR 24,7,0
 MF 164,36,156,164
 TR 26,7,2560
 s_waitcnt lgkmcnt(8)
 MF 168,40,152,168
 TR 28,7,32
 MF 172,40,156,172
 TR 30,7,2592
 s_waitcnt lgkmcnt(8)
 MF 176,44,152,176
 TR 32,7,64
 MF 180,44,156,180
 TR 34,7,2624
 s_waitcnt lgkmcnt(8)
 MF 184,16,152,184
 TR 36,7,96
 MF 188,16,156,188
 TR 38,7,2656
 s_waitcnt lgkmcnt(8)
 MF 192,20,152,192
 TR 40,7,128
 MF 196,20,156,196
 TR 42,7,2688
 s_waitcnt lgkmcnt(8)
 s_waitcnt vmcnt(16)
 MF 160,24,48,160
 TR 44,7,5120
 MF 164,24,52,164
 TR 46,7,7680
 s_waitcnt lgkmcnt(8)
 MF 168,28,48,168
 TR 16,7,5152
 MF 172,28,52,172
 TR 18,7,7712
 s_waitcnt lgkmcnt(8)
 MF 176,32,48,176
 TR 20,7,5184
 MF 180,32,52,180
 TR 22,7,7744
 s_waitcnt lgkmcnt(8)
 MF 184,36,48,184
 TR 24,7,5216
 MF 188,36,52,188
 TR 26,7,7776
 s_waitcnt lgkmcnt(8)
 MF 192,40,48,192
 TR 28,7,5248
 MF 196,40,52,196
 TR 30,7,7808
 s_waitcnt lgkmcnt(8)
 s_waitcnt vmcnt(14)
 MF 160,44,56,160
 s_waitcnt vmcnt(11)
 s_barrier
 v_add_u32 v7, 0x5000, v7
 TR 32,7,0
 MF 164,44,60,164
 TR 34,7,2560
 s_waitcnt lgkmcnt(8)
 MF 168,16,56,168
 TR 36,7,32
 MF 172,16,60,172
 TR 38,7,2592
 s_waitcnt lgkmcnt(8)
 MF 176,20,56,176
 TR 40,7,64
 MF 180,20,60,180
 TR 42,7,2624
 s_waitcnt lgkmcnt(8)
 MF 184,24,56,184
 TR 44,7,96
 MF 188,24,60,188
 TR 46,7,2656
 s_waitcnt lgkmcnt(8)
 MF 192,28,56,192
 TR 16,7,128
 MF 196,28,60,196
 TR 18,7,2688
 s_waitcnt lgkmcnt(8)
 s_waitcnt vmcnt(9)
 MF 160,32,64,160
 TR 20,7,5120
 MF 164,32,68,164
 TR 22,7,7680
 s_waitcnt lgkmcnt(8)
 MF 168,36,64,168
 TR 24,7,5152
 MF 172,36,68,172
 TR 26,7,7712
 s_waitcnt lgkmcnt(8)
 MF 176,40,64,176
 TR 28,7,5184
 MF 180,40,68,180
 TR 30,7,7744
 s_waitcnt lgkmcnt(8)
 MF 184,44,64,184
 TR 32,7,5216
 MF 188,44,68,188
 TR 34,7,7776
 s_waitcnt lgkmcnt(8)
 MF 192,16,64,192
 TR 36,7,5248
 MF 196,16,68,196
 TR 38,7,7808
 s_waitcnt lgkmcnt(8)
 s_waitcnt vmcnt(7)
 MF 160,20,72,160
 s_waitcnt vmcnt(4)
 s_barrier
 v_add_u32 v7, 0x5000, v7
 TR 40,7,0
 MF 164,20,76,164
 TR 42,7,2560
 s_waitcnt lgkmcnt(8)
 MF 168,24,72,168
 TR 44,7,32
 MF 172,24,76,172
 TR 46,7,2592
 s_waitcnt lgkmcnt(8)
 MF 176,28,72,176
 TR 16,7,64
 MF 180,28,76,180
 TR 18,7,2624
 s_waitcnt lgkmcnt(8)
 MF 184,32,72,184
 TR 20,7,96
 MF 188,32,76,188
 TR 22,7,2656
 s_waitcnt lgkmcnt(8)
 MF 192,36,72,192
 TR 24,7,128
 MF 196,36,76,196
 TR 26,7,2688
 s_waitcnt lgkmcnt(8)
 s_waitcnt vmcnt(2)
 MF 160,40,80,160
 TR 28,7,5120
 MF 164,40,84,164
 TR 30,7,7680
 s_waitcnt lgkmcnt(8)
 MF 168,44,80,168
 TR 32,7,5152
 MF 172,44,84,172
 TR 34,7,7712
 s_waitcnt lgkmcnt(8)
 MF 176,16,80,176
 TR 36,7,5184
 MF 180,16,84,180
 TR 38,7,7744
 s_waitcnt lgkmcnt(8)
 MF 184,20,80,184
 TR 40,7,5216
 MF 188,20,84,188
 TR 42,7,7776
 s_waitcnt lgkmcnt(8)
 MF 192,24,80,192
 TR 44,7,5248
 MF 196,24,84,196
 TR 46,7,7808
 s_waitcnt lgkmcnt(8)
 s_waitcnt vmcnt(0)
 MF 160,28,88,160
 MF 164,28,92,164
 s_waitcnt lgkmcnt(6)
 MF 168,32,88,168
 MF 172,32,92,172
 s_waitcnt lgkmcnt(4)
 MF 176,36,88,176
 MF 180,36,92,180
 s_waitcnt lgkmcnt(2)
 MF 184,40,88,184
 MF 188,40,92,188
 s_waitcnt lgkmcnt(0)
 MF 192,44,88,192
 MF 196,44,92,196
 s_mul_i32 s57, s48, 5120
 v_add_u32 v5, s57, v1
 s_xor_b32 s58, s48, 4
 s_mul_i32 s58, s58, 5120
 v_add_u32 v10, s58, v1
 v_add_u32 v5, 0, v5
 v_add_u32 v10, 0, v10
 s_nop 2
 ds_write_b128 v5, v[160:163] offset:0
 ds_write_b128 v5, v[168:171] offset:1024
 ds_write_b128 v5, v[176:179] offset:2048
 ds_write_b128 v5, v[184:187] offset:3072
 ds_write_b128 v5, v[192:195] offset:4096
 s_bfe_u32 s56, s48, 0x10001
 s_cmp_eq_u32 s56, s80
 s_cselect_b32 s56, 0xc1, 0
 s_xor_b32 s58, s2, s56
 s_mul_i32 s54, s58, 0xac00
 s_add_u32 s54, s54, s57
 s_add_u32 s54, s54, 0x3ae0000
 s_lshl_b32 s76, s58, 7
 s_lshl_b32 s58, s48, 2
 s_add_u32 s76, s76, s58
 s_add_u32 s76, s76, 45056
 s_waitcnt lgkmcnt(0)
 s_barrier
 RD 16,10,0
 RD 20,10,1024
 RD 24,10,2048
 RD 28,10,3072
 RD 32,10,4096
 s_cmp_lg_u32 s56, 0
 s_cbranch_scc1 Lkeep_102
 s_waitcnt lgkmcnt(4)
 v_pk_add_f32 v[164:165], v[164:165], v[16:17]
 v_pk_add_f32 v[166:167], v[166:167], v[18:19]
 buffer_store_dwordx4 v[164:167], v1, s[44:47], s54 offen offset:0 sc1
 s_waitcnt lgkmcnt(3)
 v_pk_add_f32 v[172:173], v[172:173], v[20:21]
 v_pk_add_f32 v[174:175], v[174:175], v[22:23]
 buffer_store_dwordx4 v[172:175], v1, s[44:47], s54 offen offset:1024 sc1
 s_waitcnt lgkmcnt(2)
 v_pk_add_f32 v[180:181], v[180:181], v[24:25]
 v_pk_add_f32 v[182:183], v[182:183], v[26:27]
 buffer_store_dwordx4 v[180:183], v1, s[44:47], s54 offen offset:2048 sc1
 s_waitcnt lgkmcnt(1)
 v_pk_add_f32 v[188:189], v[188:189], v[28:29]
 v_pk_add_f32 v[190:191], v[190:191], v[30:31]
 buffer_store_dwordx4 v[188:191], v1, s[44:47], s54 offen offset:3072 sc1
 s_waitcnt lgkmcnt(0)
 v_pk_add_f32 v[196:197], v[196:197], v[32:33]
 v_pk_add_f32 v[198:199], v[198:199], v[34:35]
 buffer_store_dwordx4 v[196:199], v15, s[44:47], s54 offen offset:0 sc1
 v_mov_b32 v5, 1
 s_waitcnt vmcnt(0)
 s_mov_b64 exec, 1
 buffer_store_dword v5, v4, s[44:47], s76 offen sc1
 s_endpgm
Lkeep_102:
 s_waitcnt lgkmcnt(4)
 v_pk_add_f32 v[164:165], v[164:165], v[16:17]
 v_pk_add_f32 v[166:167], v[166:167], v[18:19]
 s_waitcnt lgkmcnt(3)
 v_pk_add_f32 v[172:173], v[172:173], v[20:21]
 v_pk_add_f32 v[174:175], v[174:175], v[22:23]
 s_waitcnt lgkmcnt(2)
 v_pk_add_f32 v[180:181], v[180:181], v[24:25]
 v_pk_add_f32 v[182:183], v[182:183], v[26:27]
 s_waitcnt lgkmcnt(1)
 v_pk_add_f32 v[188:189], v[188:189], v[28:29]
 v_pk_add_f32 v[190:191], v[190:191], v[30:31]
 s_waitcnt lgkmcnt(0)
 v_pk_add_f32 v[196:197], v[196:197], v[32:33]
 v_pk_add_f32 v[198:199], v[198:199], v[34:35]
 s_mov_b32 s66, 0x10000
Lpoll_103:
 buffer_load_dword v10, v4, s[44:47], s76 offen sc1
 s_waitcnt vmcnt(0)
 v_readfirstlane_b32 s57, v10
 s_cmp_ge_u32 s57, 1
 s_cbranch_scc1 Lpolld_104
 s_sleep 2
 s_sub_u32 s66, s66, 1
 s_cmp_lg_u32 s66, 0
 s_cbranch_scc1 Lpoll_103
Lpolld_104:
 buffer_load_dwordx4 v[16:19], v1, s[44:47], s54 offen offset:0 sc1
 buffer_load_dwordx4 v[20:23], v1, s[44:47], s54 offen offset:1024 sc1
 buffer_load_dwordx4 v[24:27], v1, s[44:47], s54 offen offset:2048 sc1
 buffer_load_dwordx4 v[28:31], v1, s[44:47], s54 offen offset:3072 sc1
 buffer_load_dwordx4 v[32:35], v15, s[44:47], s54 offen offset:0 sc1
 s_waitcnt vmcnt(4)
 v_pk_add_f32 v[164:165], v[164:165], v[16:17]
 v_pk_add_f32 v[166:167], v[166:167], v[18:19]
 v_cvt_pk_bf16_f32 v164, v164, v165
 v_cvt_pk_bf16_f32 v165, v166, v167
 buffer_store_dwordx2 v[164:165], v6, s[36:39], 0 offen offset:0
 s_waitcnt vmcnt(4)
 v_pk_add_f32 v[172:173], v[172:173], v[20:21]
 v_pk_add_f32 v[174:175], v[174:175], v[22:23]
 v_cvt_pk_bf16_f32 v172, v172, v173
 v_cvt_pk_bf16_f32 v173, v174, v175
 buffer_store_dwordx2 v[172:173], v6, s[36:39], 0 offen offset:32
 s_waitcnt vmcnt(4)
 v_pk_add_f32 v[180:181], v[180:181], v[24:25]
 v_pk_add_f32 v[182:183], v[182:183], v[26:27]
 v_cvt_pk_bf16_f32 v180, v180, v181
 v_cvt_pk_bf16_f32 v181, v182, v183
 buffer_store_dwordx2 v[180:181], v6, s[36:39], 0 offen offset:64
 s_waitcnt vmcnt(4)
 v_pk_add_f32 v[188:189], v[188:189], v[28:29]
 v_pk_add_f32 v[190:191], v[190:191], v[30:31]
 v_cvt_pk_bf16_f32 v188, v188, v189
 v_cvt_pk_bf16_f32 v189, v190, v191
 buffer_store_dwordx2 v[188:189], v6, s[36:39], 0 offen offset:96
 s_waitcnt vmcnt(4)
 v_pk_add_f32 v[196:197], v[196:197], v[32:33]
 v_pk_add_f32 v[198:199], v[198:199], v[34:35]
 v_cvt_pk_bf16_f32 v196, v196, v197
 v_cvt_pk_bf16_f32 v197, v198, v199
 buffer_store_dwordx2 v[196:197], v6, s[36:39], 0 offen offset:128
 s_endpgm
L_p3_S1_8:
 v_mov_b32 v5, 1
 s_mov_b64 exec, 1
 buffer_atomic_add v5, v4, s[44:47], s76 offen
 s_mov_b64 exec, -1
 s_add_u32 s54, s83, s85
 s_add_u32 s54, s54, 0x5000
 s_add_u32 m0, s85, 0
 s_nop 0
 buffer_load_dwordx4 v1, s[44:47], s54 offen offset:0 sc1 lds
 buffer_load_dwordx4 v1, s[44:47], s54 offen offset:1024 sc1 lds
 buffer_load_dwordx4 v1, s[44:47], s54 offen offset:2048 sc1 lds
 s_add_u32 s54, s83, s85
 s_add_u32 s54, s54, 0xa000
 s_add_u32 m0, s85, 20480
 s_nop 0
 buffer_load_dwordx4 v1, s[44:47], s54 offen offset:0 sc1 lds
 buffer_load_dwordx4 v1, s[44:47], s54 offen offset:1024 sc1 lds
 buffer_load_dwordx4 v1, s[44:47], s54 offen offset:2048 sc1 lds
 s_add_u32 s54, s83, s85
 s_add_u32 s54, s54, 0xf000
 s_add_u32 m0, s85, 40960
 s_nop 0
 buffer_load_dwordx4 v1, s[44:47], s54 offen offset:0 sc1 lds
 buffer_load_dwordx4 v1, s[44:47], s54 offen offset:1024 sc1 lds
 buffer_load_dwordx4 v1, s[44:47], s54 offen offset:2048 sc1 lds
 s_add_u32 s54, s83, s85
 s_add_u32 s54, s54, 0x14000
 s_add_u32 m0, s85, 61440
 s_nop 0
 buffer_load_dwordx4 v1, s[44:47], s54 offen offset:0 sc1 lds
 buffer_load_dwordx4 v1, s[44:47], s54 offen offset:1024 sc1 lds
 buffer_load_dwordx4 v1, s[44:47], s54 offen offset:2048 sc1 lds
 s_waitcnt vmcnt(33)
 v_lshlrev_b32 v160, 16, v200
 v_and_b32 v161, 0xffff0000, v200
 v_lshlrev_b32 v162, 16, v201
 v_and_b32 v163, 0xffff0000, v201
 v_lshlrev_b32 v164, 16, v202
 v_and_b32 v165, 0xffff0000, v202
 v_lshlrev_b32 v166, 16, v203
 v_and_b32 v167, 0xffff0000, v203
 v_lshlrev_b32 v168, 16, v204
 v_and_b32 v169, 0xffff0000, v204
 v_lshlrev_b32 v170, 16, v205
 v_and_b32 v171, 0xffff0000, v205
 v_lshlrev_b32 v172, 16, v206
 v_and_b32 v173, 0xffff0000, v206
 v_lshlrev_b32 v174, 16, v207
 v_and_b32 v175, 0xffff0000, v207
 v_lshlrev_b32 v176, 16, v208
 v_and_b32 v177, 0xffff0000, v208
 v_lshlrev_b32 v178, 16, v209
 v_and_b32 v179, 0xffff0000, v209
 v_lshlrev_b32 v180, 16, v210
 v_and_b32 v181, 0xffff0000, v210
 v_lshlrev_b32 v182, 16, v211
 v_and_b32 v183, 0xffff0000, v211
 v_lshlrev_b32 v184, 16, v212
 v_and_b32 v185, 0xffff0000, v212
 v_lshlrev_b32 v186, 16, v213
 v_and_b32 v187, 0xffff0000, v213
 v_lshlrev_b32 v188, 16, v214
 v_and_b32 v189, 0xffff0000, v214
 v_lshlrev_b32 v190, 16, v215
 v_and_b32 v191, 0xffff0000, v215
 v_lshlrev_b32 v192, 16, v216
 v_and_b32 v193, 0xffff0000, v216
 v_lshlrev_b32 v194, 16, v217
 v_and_b32 v195, 0xffff0000, v217
 v_lshlrev_b32 v196, 16, v218
 v_and_b32 v197, 0xffff0000, v218
 v_lshlrev_b32 v198, 16, v219
 v_and_b32 v199, 0xffff0000, v219
 s_barrier
 TR 16,7,0
 TR 18,7,2560
 TR 20,7,32
 TR 22,7,2592
 TR 24,7,64
 TR 26,7,2624
 TR 28,7,96
 TR 30,7,2656
 TR 32,7,128
 TR 34,7,2688
 s_waitcnt lgkmcnt(8)
 MF 160,16,48,160
 TR 36,7,5120
 MF 164,16,52,164
 TR 38,7,7680
 s_waitcnt lgkmcnt(8)
 MF 168,20,48,168
 TR 40,7,5152
 MF 172,20,52,172
 TR 42,7,7712
 s_waitcnt lgkmcnt(8)
 MF 176,24,48,176
 TR 44,7,5184
 MF 180,24,52,180
 TR 46,7,7744
 s_waitcnt lgkmcnt(8)
 MF 184,28,48,184
 TR 16,7,5216
 MF 188,28,52,188
 TR 18,7,7776
 s_waitcnt lgkmcnt(8)
 MF 192,32,48,192
 TR 20,7,5248
 MF 196,32,52,196
 TR 22,7,7808
 s_waitcnt lgkmcnt(8)
 MF 160,36,56,160
 s_waitcnt vmcnt(9)
 s_barrier
 v_add_u32 v7, 0xfffdd000, v7
 TR 24,7,0
 MF 164,36,60,164
 TR 26,7,2560
 s_add_u32 s54, s83, s85
 s_add_u32 s54, s54, 0x19000
 s_add_u32 m0, s85, 81920
 s_nop 0
 buffer_load_dwordx4 v1, s[44:47], s54 offen offset:0 sc1 lds
 s_waitcnt lgkmcnt(8)
 MF 168,40,56,168
 TR 28,7,32
 MF 172,40,60,172
 TR 30,7,2592
 buffer_load_dwordx4 v1, s[44:47], s54 offen offset:1024 sc1 lds
 s_waitcnt lgkmcnt(8)
 MF 176,44,56,176
 TR 32,7,64
 MF 180,44,60,180
 TR 34,7,2624
 buffer_load_dwordx4 v1, s[44:47], s54 offen offset:2048 sc1 lds
 s_waitcnt lgkmcnt(8)
 MF 184,16,56,184
 TR 36,7,96
 MF 188,16,60,188
 TR 38,7,2656
 s_waitcnt lgkmcnt(8)
 MF 192,20,56,192
 TR 40,7,128
 MF 196,20,60,196
 TR 42,7,2688
 s_waitcnt lgkmcnt(8)
 MF 160,24,64,160
 TR 44,7,5120
 MF 164,24,68,164
 TR 46,7,7680
 s_waitcnt lgkmcnt(8)
 MF 168,28,64,168
 TR 16,7,5152
 MF 172,28,68,172
 TR 18,7,7712
 s_waitcnt lgkmcnt(8)
 MF 176,32,64,176
 TR 20,7,5184
 MF 180,32,68,180
 TR 22,7,7744
 s_waitcnt lgkmcnt(8)
 MF 184,36,64,184
 TR 24,7,5216
 MF 188,36,68,188
 TR 26,7,7776
 s_waitcnt lgkmcnt(8)
 MF 192,40,64,192
 TR 28,7,5248
 MF 196,40,68,196
 TR 30,7,7808
 s_waitcnt lgkmcnt(8)
 MF 160,44,72,160
 s_waitcnt vmcnt(9)
 s_barrier
 buffer_load_dword v10, v4, s[44:47], s86 offen sc1
 v_add_u32 v7, 0x5000, v7
 TR 32,7,0
 MF 164,44,76,164
 TR 34,7,2560
 s_add_u32 s54, s84, s85
 s_add_u32 m0, s85, 102400
 s_nop 0
 buffer_load_dwordx4 v1, s[44:47], s54 offen offset:0 sc1 lds
 s_waitcnt lgkmcnt(8)
 MF 168,16,72,168
 TR 36,7,32
 MF 172,16,76,172
 TR 38,7,2592
 buffer_load_dwordx4 v1, s[44:47], s54 offen offset:1024 sc1 lds
 s_waitcnt lgkmcnt(8)
 MF 176,20,72,176
 TR 40,7,64
 MF 180,20,76,180
 TR 42,7,2624
 buffer_load_dwordx4 v1, s[44:47], s54 offen offset:2048 sc1 lds
 s_waitcnt lgkmcnt(8)
 MF 184,24,72,184
 TR 44,7,96
 MF 188,24,76,188
 TR 46,7,2656
 s_waitcnt lgkmcnt(8)
 MF 192,28,72,192
 TR 16,7,128
 MF 196,28,76,196
 TR 18,7,2688
 s_waitcnt lgkmcnt(8)
 MF 160,32,80,160
 TR 20,7,5120
 MF 164,32,84,164
 TR 22,7,7680
 s_waitcnt lgkmcnt(8)
 MF 168,36,80,168
 TR 24,7,5152
 MF 172,36,84,172
 TR 26,7,7712
 s_waitcnt lgkmcnt(8)
 MF 176,40,80,176
 TR 28,7,5184
 MF 180,40,84,180
 TR 30,7,7744
 s_waitcnt lgkmcnt(8)
 MF 184,44,80,184
 TR 32,7,5216
 MF 188,44,84,188
 TR 34,7,7776
 s_waitcnt lgkmcnt(8)
 MF 192,16,80,192
 TR 36,7,5248
 MF 196,16,84,196
 TR 38,7,7808
 s_waitcnt lgkmcnt(8)
 MF 160,20,88,160
 s_waitcnt vmcnt(3)
 v_readfirstlane_b32 s57, v10
 s_cmp_ge_u32 s57, 8
 s_cbranch_scc1 Lpok_105
 s_mov_b32 s66, 0x10000
Lpoll_106:
 buffer_load_dword v10, v4, s[44:47], s86 offen sc1
 s_waitcnt vmcnt(0)
 v_readfirstlane_b32 s57, v10
 s_cmp_ge_u32 s57, 8
 s_cbranch_scc1 Lpolld_107
 s_sleep 2
 s_sub_u32 s66, s66, 1
 s_cmp_lg_u32 s66, 0
 s_cbranch_scc1 Lpoll_106
Lpolld_107:
Lpok_105:
 s_barrier
 v_add_u32 v7, 0x5000, v7
 TR 40,7,0
 MF 164,20,92,164
 TR 42,7,2560
 s_add_u32 s54, s84, s85
 s_add_u32 s54, s54, 0x5000
 s_add_u32 m0, s85, 122880
 s_nop 0
 buffer_load_dwordx4 v1, s[44:47], s54 offen offset:0 sc1 lds
 s_waitcnt lgkmcnt(8)
 MF 168,24,88,168
 TR 44,7,32
 MF 172,24,92,172
 TR 46,7,2592
 buffer_load_dwordx4 v1, s[44:47], s54 offen offset:1024 sc1 lds
 s_waitcnt lgkmcnt(8)
 MF 176,28,88,176
 TR 16,7,64
 MF 180,28,92,180
 TR 18,7,2624
 buffer_load_dwordx4 v1, s[44:47], s54 offen offset:2048 sc1 lds
 s_waitcnt lgkmcnt(8)
 MF 184,32,88,184
 TR 20,7,96
 MF 188,32,92,188
 TR 22,7,2656
 s_waitcnt lgkmcnt(8)
 MF 192,36,88,192
 TR 24,7,128
 MF 196,36,92,196
 TR 26,7,2688
 s_waitcnt lgkmcnt(8)
 MF 160,40,96,160
 TR 28,7,5120
 MF 164,40,100,164
 TR 30,7,7680
 s_add_u32 s55, s82, 0
 buffer_load_dwordx4 v[144:147], v1, s[44:47], s55 offen offset:0 sc1
 buffer_load_dwordx4 v[148:151], v1, s[44:47], s55 offen offset:1024 sc1
 s_waitcnt lgkmcnt(8)
 MF 168,44,96,168
 TR 32,7,5152
 MF 172,44,100,172
 TR 34,7,7712
 buffer_load_dwordx4 v[152:155], v1, s[44:47], s55 offen offset:2048 sc1
 buffer_load_dwordx4 v[156:159], v1, s[44:47], s55 offen offset:3072 sc1
 s_waitcnt lgkmcnt(8)
 MF 176,16,96,176
 TR 36,7,5184
 MF 180,16,100,180
 TR 38,7,7744
 s_add_u32 s55, s82, 8192
 buffer_load_dwordx4 v[48:51], v1, s[44:47], s55 offen offset:0 sc1
 s_waitcnt lgkmcnt(8)
 MF 184,20,96,184
 TR 40,7,5216
 MF 188,20,100,188
 TR 42,7,7776
 buffer_load_dwordx4 v[52:55], v1, s[44:47], s55 offen offset:1024 sc1
 buffer_load_dwordx4 v[56:59], v1, s[44:47], s55 offen offset:2048 sc1
 s_waitcnt lgkmcnt(8)
 MF 192,24,96,192
 TR 44,7,5248
 MF 196,24,100,196
 TR 46,7,7808
 buffer_load_dwordx4 v[60:63], v1, s[44:47], s55 offen offset:3072 sc1
 s_waitcnt lgkmcnt(8)
 MF 160,28,104,160
 s_barrier
 v_add_u32 v7, 0x5000, v7
 TR 16,7,0
 MF 164,28,108,164
 TR 18,7,2560
 s_add_u32 s54, s84, s85
 s_add_u32 s54, s54, 0xa000
 s_add_u32 m0, s85, 143360
 s_nop 0
 buffer_load_dwordx4 v1, s[44:47], s54 offen offset:0 sc1 lds
 s_waitcnt lgkmcnt(8)
 MF 168,32,104,168
 TR 20,7,32
 MF 172,32,108,172
 TR 22,7,2592
 buffer_load_dwordx4 v1, s[44:47], s54 offen offset:1024 sc1 lds
 s_waitcnt lgkmcnt(8)
 MF 176,36,104,176
 TR 24,7,64
 MF 180,36,108,180
 TR 26,7,2624
 buffer_load_dwordx4 v1, s[44:47], s54 offen offset:2048 sc1 lds
 s_waitcnt lgkmcnt(8)
 MF 184,40,104,184
 TR 28,7,96
 MF 188,40,108,188
 TR 30,7,2656
 s_waitcnt lgkmcnt(8)
 MF 192,44,104,192
 TR 32,7,128
 MF 196,44,108,196
 TR 34,7,2688
 s_waitcnt lgkmcnt(8)
 MF 160,16,112,160
 TR 36,7,5120
 MF 164,16,116,164
 TR 38,7,7680
 s_add_u32 s55, s82, 16384
 buffer_load_dwordx4 v[64:67], v1, s[44:47], s55 offen offset:0 sc1
 s_waitcnt lgkmcnt(8)
 MF 168,20,112,168
 TR 40,7,5152
 MF 172,20,116,172
 TR 42,7,7712
 buffer_load_dwordx4 v[68:71], v1, s[44:47], s55 offen offset:1024 sc1
 s_waitcnt lgkmcnt(8)
 MF 176,24,112,176
 TR 44,7,5184
 MF 180,24,116,180
 TR 46,7,7744
 buffer_load_dwordx4 v[72:75], v1, s[44:47], s55 offen offset:2048 sc1
 s_waitcnt lgkmcnt(8)
 MF 184,28,112,184
 TR 16,7,5216
 MF 188,28,116,188
 TR 18,7,7776
 buffer_load_dwordx4 v[76:79], v1, s[44:47], s55 offen offset:3072 sc1
 s_waitcnt lgkmcnt(8)
 MF 192,32,112,192
 TR 20,7,5248
 MF 196,32,116,196
 TR 22,7,7808
 s_waitcnt lgkmcnt(8)
 MF 160,36,120,160
 s_barrier
 v_add_u32 v7, 0x5000, v7
 TR 24,7,0
 MF 164,36,124,164
 TR 26,7,2560
 s_add_u32 s54, s84, s85
 s_add_u32 s54, s54, 0xf000
 s_add_u32 m0, s85, 0
 s_nop 0
 buffer_load_dwordx4 v1, s[44:47], s54 offen offset:0 sc1 lds
 s_waitcnt lgkmcnt(8)
 MF 168,40,120,168
 TR 28,7,32
 MF 172,40,124,172
 TR 30,7,2592
 buffer_load_dwordx4 v1, s[44:47], s54 offen offset:1024 sc1 lds
 s_waitcnt lgkmcnt(8)
 MF 176,44,120,176
 TR 32,7,64
 MF 180,44,124,180
 TR 34,7,2624
 buffer_load_dwordx4 v1, s[44:47], s54 offen offset:2048 sc1 lds
 s_waitcnt lgkmcnt(8)
 MF 184,16,120,184
 TR 36,7,96
 MF 188,16,124,188
 TR 38,7,2656
 s_waitcnt lgkmcnt(8)
 MF 192,20,120,192
 TR 40,7,128
 MF 196,20,124,196
 TR 42,7,2688
 s_waitcnt lgkmcnt(8)
 MF 160,24,128,160
 TR 44,7,5120
 MF 164,24,132,164
 TR 46,7,7680
 s_add_u32 s55, s82, 24576
 buffer_load_dwordx4 v[80:83], v1, s[44:47], s55 offen offset:0 sc1
 s_waitcnt lgkmcnt(8)
 MF 168,28,128,168
 TR 16,7,5152
 MF 172,28,132,172
 TR 18,7,7712
 buffer_load_dwordx4 v[84:87], v1, s[44:47], s55 offen offset:1024 sc1
 s_waitcnt lgkmcnt(8)
 MF 176,32,128,176
 TR 20,7,5184
 MF 180,32,132,180
 TR 22,7,7744
 buffer_load_dwordx4 v[88:91], v1, s[44:47], s55 offen offset:2048 sc1
 s_waitcnt lgkmcnt(8)
 MF 184,36,128,184
 TR 24,7,5216
 MF 188,36,132,188
 TR 26,7,7776
 buffer_load_dwordx4 v[92:95], v1, s[44:47], s55 offen offset:3072 sc1
 s_waitcnt lgkmcnt(8)
 MF 192,40,128,192
 TR 28,7,5248
 MF 196,40,132,196
 TR 30,7,7808
 s_waitcnt lgkmcnt(8)
 MF 160,44,136,160
 s_waitcnt vmcnt(25)
 s_barrier
 v_add_u32 v7, 0x5000, v7
 TR 32,7,0
 MF 164,44,140,164
 TR 34,7,2560
 s_add_u32 s54, s84, s85
 s_add_u32 s54, s54, 0x28000
 s_add_u32 m0, s85, 20480
 s_nop 0
 buffer_load_dwordx4 v1, s[44:47], s54 offen offset:0 sc1 lds
 s_waitcnt lgkmcnt(8)
 MF 168,16,136,168
 TR 36,7,32
 MF 172,16,140,172
 TR 38,7,2592
 buffer_load_dwordx4 v1, s[44:47], s54 offen offset:1024 sc1 lds
 s_waitcnt lgkmcnt(8)
 MF 176,20,136,176
 TR 40,7,64
 MF 180,20,140,180
 TR 42,7,2624
 buffer_load_dwordx4 v1, s[44:47], s54 offen offset:2048 sc1 lds
 s_waitcnt lgkmcnt(8)
 MF 184,24,136,184
 TR 44,7,96
 MF 188,24,140,188
 TR 46,7,2656
 s_waitcnt lgkmcnt(8)
 MF 192,28,136,192
 TR 16,7,128
 MF 196,28,140,196
 TR 18,7,2688
 s_waitcnt lgkmcnt(8)
 s_waitcnt vmcnt(23)
 MF 160,32,144,160
 TR 20,7,5120
 MF 164,32,148,164
 TR 22,7,7680
 s_add_u32 s55, s82, 65536
 buffer_load_dwordx4 v[96:99], v1, s[44:47], s55 offen offset:0 sc1
 s_waitcnt lgkmcnt(8)
 MF 168,36,144,168
 TR 24,7,5152
 MF 172,36,148,172
 TR 26,7,7712
 buffer_load_dwordx4 v[100:103], v1, s[44:47], s55 offen offset:1024 sc1
 s_waitcnt lgkmcnt(8)
 MF 176,40,144,176
 TR 28,7,5184
 MF 180,40,148,180
 TR 30,7,7744
 buffer_load_dwordx4 v[104:107], v1, s[44:47], s55 offen offset:2048 sc1
 s_waitcnt lgkmcnt(8)
 MF 184,44,144,184
 TR 32,7,5216
 MF 188,44,148,188
 TR 34,7,7776
 buffer_load_dwordx4 v[108:111], v1, s[44:47], s55 offen offset:3072 sc1
 s_waitcnt lgkmcnt(8)
 MF 192,16,144,192
 TR 36,7,5248
 MF 196,16,148,196
 TR 38,7,7808
 s_waitcnt lgkmcnt(8)
 s_waitcnt vmcnt(25)
 MF 160,20,152,160
 s_barrier
 v_add_u32 v7, 0x5000, v7
 TR 40,7,0
 MF 164,20,156,164
 TR 42,7,2560
 s_add_u32 s54, s84, s85
 s_add_u32 s54, s54, 0x2d000
 s_add_u32 m0, s85, 40960
 s_nop 0
 buffer_load_dwordx4 v1, s[44:47], s54 offen offset:0 sc1 lds
 s_waitcnt lgkmcnt(8)
 MF 168,24,152,168
 TR 44,7,32
 MF 172,24,156,172
 TR 46,7,2592
 buffer_load_dwordx4 v1, s[44:47], s54 offen offset:1024 sc1 lds
 s_waitcnt lgkmcnt(8)
 MF 176,28,152,176
 TR 16,7,64
 MF 180,28,156,180
 TR 18,7,2624
 buffer_load_dwordx4 v1, s[44:47], s54 offen offset:2048 sc1 lds
 s_waitcnt lgkmcnt(8)
 MF 184,32,152,184
 TR 20,7,96
 MF 188,32,156,188
 TR 22,7,2656
 s_waitcnt lgkmcnt(8)
 MF 192,36,152,192
 TR 24,7,128
 MF 196,36,156,196
 TR 26,7,2688
 s_waitcnt lgkmcnt(8)
 s_waitcnt vmcnt(26)
 MF 160,40,48,160
 TR 28,7,5120
 MF 164,40,52,164
 TR 30,7,7680
 s_add_u32 s55, s82, 73728
 buffer_load_dwordx4 v[112:115], v1, s[44:47], s55 offen offset:0 sc1
 s_waitcnt lgkmcnt(8)
 MF 168,44,48,168
 TR 32,7,5152
 MF 172,44,52,172
 TR 34,7,7712
 buffer_load_dwordx4 v[116:119], v1, s[44:47], s55 offen offset:1024 sc1
 s_waitcnt lgkmcnt(8)
 MF 176,16,48,176
 TR 36,7,5184
 MF 180,16,52,180
 TR 38,7,7744
 buffer_load_dwordx4 v[120:123], v1, s[44:47], s55 offen offset:2048 sc1
 s_waitcnt lgkmcnt(8)
 MF 184,20,48,184
 TR 40,7,5216
 MF 188,20,52,188
 TR 42,7,7776
 buffer_load_dwordx4 v[124:127], v1, s[44:47], s55 offen offset:3072 sc1
 s_waitcnt lgkmcnt(8)
 MF 192,24,48,192
 TR 44,7,5248
 MF 196,24,52,196
 TR 46,7,7808
 s_waitcnt lgkmcnt(8)
 s_waitcnt vmcnt(28)
 MF 160,28,56,160
 s_waitcnt vmcnt(25)
 s_barrier
 v_add_u32 v7, 0x5000, v7
 TR 16,7,0
 MF 164,28,60,164
 TR 18,7,2560
 s_add_u32 s54, s84, s85
 s_add_u32 s54, s54, 0x32000
 s_add_u32 m0, s85, 61440
 s_nop 0
 buffer_load_dwordx4 v1, s[44:47], s54 offen offset:0 sc1 lds
 s_waitcnt lgkmcnt(8)
 MF 168,32,56,168
 TR 20,7,32
 MF 172,32,60,172
 TR 22,7,2592
 buffer_load_dwordx4 v1, s[44:47], s54 offen offset:1024 sc1 lds
 s_waitcnt lgkmcnt(8)
 MF 176,36,56,176
 TR 24,7,64
 MF 180,36,60,180
 TR 26,7,2624
 buffer_load_dwordx4 v1, s[44:47], s54 offen offset:2048 sc1 lds
 s_waitcnt lgkmcnt(8)
 MF 184,40,56,184
 TR 28,7,96
 MF 188,40,60,188
 TR 30,7,2656
 s_waitcnt lgkmcnt(8)
 MF 192,44,56,192
 TR 32,7,128
 MF 196,44,60,196
 TR 34,7,2688
 s_waitcnt lgkmcnt(8)
 s_waitcnt vmcnt(26)
 MF 160,16,64,160
 TR 36,7,5120
 MF 164,16,68,164
 TR 38,7,7680
 s_add_u32 s55, s82, 81920
 buffer_load_dwordx4 v[128:131], v1, s[44:47], s55 offen offset:0 sc1
 s_waitcnt lgkmcnt(8)
 MF 168,20,64,168
 TR 40,7,5152
 MF 172,20,68,172
 TR 42,7,7712
 buffer_load_dwordx4 v[132:135], v1, s[44:47], s55 offen offset:1024 sc1
 s_waitcnt lgkmcnt(8)
 MF 176,24,64,176
 TR 44,7,5184
 MF 180,24,68,180
 TR 46,7,7744
 buffer_load_dwordx4 v[136:139], v1, s[44:47], s55 offen offset:2048 sc1
 s_waitcnt lgkmcnt(8)
 MF 184,28,64,184
 TR 16,7,5216
 MF 188,28,68,188
 TR 18,7,7776
 buffer_load_dwordx4 v[140:143], v1, s[44:47], s55 offen offset:3072 sc1
 s_waitcnt lgkmcnt(8)
 MF 192,32,64,192
 TR 20,7,5248
 MF 196,32,68,196
 TR 22,7,7808
 s_waitcnt lgkmcnt(8)
 s_waitcnt vmcnt(28)
 MF 160,36,72,160
 s_waitcnt vmcnt(25)
 s_barrier
 v_add_u32 v7, 0xfffdd000, v7
 TR 24,7,0
 MF 164,36,76,164
 TR 26,7,2560
 s_add_u32 s54, s84, s85
 s_add_u32 s54, s54, 0x37000
 s_add_u32 m0, s85, 81920
 s_nop 0
 buffer_load_dwordx4 v1, s[44:47], s54 offen offset:0 sc1 lds
 s_waitcnt lgkmcnt(8)
 MF 168,40,72,168
 TR 28,7,32
 MF 172,40,76,172
 TR 30,7,2592
 buffer_load_dwordx4 v1, s[44:47], s54 offen offset:1024 sc1 lds
 s_waitcnt lgkmcnt(8)
 MF 176,44,72,176
 TR 32,7,64
 MF 180,44,76,180
 TR 34,7,2624
 buffer_load_dwordx4 v1, s[44:47], s54 offen offset:2048 sc1 lds
 s_waitcnt lgkmcnt(8)
 MF 184,16,72,184
 TR 36,7,96
 MF 188,16,76,188
 TR 38,7,2656
 s_waitcnt lgkmcnt(8)
 MF 192,20,72,192
 TR 40,7,128
 MF 196,20,76,196
 TR 42,7,2688
 s_waitcnt lgkmcnt(8)
 s_waitcnt vmcnt(26)
 MF 160,24,80,160
 TR 44,7,5120
 MF 164,24,84,164
 TR 46,7,7680
 s_add_u32 s55, s82, 90112
 buffer_load_dwordx4 v[144:147], v1, s[44:47], s55 offen offset:0 sc1
 s_waitcnt lgkmcnt(8)
 MF 168,28,80,168
 TR 16,7,5152
 MF 172,28,84,172
 TR 18,7,7712
 buffer_load_dwordx4 v[148:151], v1, s[44:47], s55 offen offset:1024 sc1
 s_waitcnt lgkmcnt(8)
 MF 176,32,80,176
 TR 20,7,5184
 MF 180,32,84,180
 TR 22,7,7744
 buffer_load_dwordx4 v[152:155], v1, s[44:47], s55 offen offset:2048 sc1
 s_waitcnt lgkmcnt(8)
 MF 184,36,80,184
 TR 24,7,5216
 MF 188,36,84,188
 TR 26,7,7776
 buffer_load_dwordx4 v[156:159], v1, s[44:47], s55 offen offset:3072 sc1
 s_waitcnt lgkmcnt(8)
 MF 192,40,80,192
 TR 28,7,5248
 MF 196,40,84,196
 TR 30,7,7808
 s_waitcnt lgkmcnt(8)
 s_waitcnt vmcnt(28)
 MF 160,44,88,160
 s_waitcnt vmcnt(25)
 s_barrier
 s_add_u32 s86, s86, 128
 buffer_load_dword v10, v4, s[44:47], s86 offen sc1
 v_add_u32 v7, 0x5000, v7
 TR 32,7,0
 MF 164,44,92,164
 TR 34,7,2560
 s_add_u32 s54, s84, s85
 s_add_u32 s54, s54, 0x14000
 s_add_u32 m0, s85, 102400
 s_nop 0
 buffer_load_dwordx4 v1, s[44:47], s54 offen offset:0 sc1 lds
 s_waitcnt lgkmcnt(8)
 MF 168,16,88,168
 TR 36,7,32
 MF 172,16,92,172
 TR 38,7,2592
 buffer_load_dwordx4 v1, s[44:47], s54 offen offset:1024 sc1 lds
 s_waitcnt lgkmcnt(8)
 MF 176,20,88,176
 TR 40,7,64
 MF 180,20,92,180
 TR 42,7,2624
 buffer_load_dwordx4 v1, s[44:47], s54 offen offset:2048 sc1 lds
 s_waitcnt lgkmcnt(8)
 MF 184,24,88,184
 TR 44,7,96
 MF 188,24,92,188
 TR 46,7,2656
 s_waitcnt lgkmcnt(8)
 MF 192,28,88,192
 TR 16,7,128
 MF 196,28,92,196
 TR 18,7,2688
 s_waitcnt lgkmcnt(8)
 s_waitcnt vmcnt(27)
 MF 160,32,96,160
 TR 20,7,5120
 MF 164,32,100,164
 TR 22,7,7680
 s_waitcnt lgkmcnt(8)
 MF 168,36,96,168
 TR 24,7,5152
 MF 172,36,100,172
 TR 26,7,7712
 s_waitcnt lgkmcnt(8)
 MF 176,40,96,176
 TR 28,7,5184
 MF 180,40,100,180
 TR 30,7,7744
 s_waitcnt lgkmcnt(8)
 MF 184,44,96,184
 TR 32,7,5216
 MF 188,44,100,188
 TR 34,7,7776
 s_waitcnt lgkmcnt(8)
 MF 192,16,96,192
 TR 36,7,5248
 MF 196,16,100,196
 TR 38,7,7808
 s_waitcnt lgkmcnt(8)
 s_waitcnt vmcnt(25)
 MF 160,20,104,160
 s_waitcnt vmcnt(3)
 v_readfirstlane_b32 s57, v10
 s_cmp_ge_u32 s57, 8
 s_cbranch_scc1 Lpok_108
 s_mov_b32 s66, 0x10000
Lpoll_109:
 buffer_load_dword v10, v4, s[44:47], s86 offen sc1
 s_waitcnt vmcnt(0)
 v_readfirstlane_b32 s57, v10
 s_cmp_ge_u32 s57, 8
 s_cbranch_scc1 Lpolld_110
 s_sleep 2
 s_sub_u32 s66, s66, 1
 s_cmp_lg_u32 s66, 0
 s_cbranch_scc1 Lpoll_109
Lpolld_110:
Lpok_108:
 s_barrier
 v_add_u32 v7, 0x5000, v7
 TR 40,7,0
 MF 164,20,108,164
 TR 42,7,2560
 s_add_u32 s54, s84, s85
 s_add_u32 s54, s54, 0x19000
 s_add_u32 m0, s85, 122880
 s_nop 0
 buffer_load_dwordx4 v1, s[44:47], s54 offen offset:0 sc1 lds
 s_waitcnt lgkmcnt(8)
 MF 168,24,104,168
 TR 44,7,32
 MF 172,24,108,172
 TR 46,7,2592
 buffer_load_dwordx4 v1, s[44:47], s54 offen offset:1024 sc1 lds
 s_waitcnt lgkmcnt(8)
 MF 176,28,104,176
 TR 16,7,64
 MF 180,28,108,180
 TR 18,7,2624
 buffer_load_dwordx4 v1, s[44:47], s54 offen offset:2048 sc1 lds
 s_waitcnt lgkmcnt(8)
 MF 184,32,104,184
 TR 20,7,96
 MF 188,32,108,188
 TR 22,7,2656
 s_waitcnt lgkmcnt(8)
 MF 192,36,104,192
 TR 24,7,128
 MF 196,36,108,196
 TR 26,7,2688
 s_waitcnt lgkmcnt(8)
 MF 160,40,112,160
 TR 28,7,5120
 MF 164,40,116,164
 TR 30,7,7680
 s_add_u32 s55, s82, 32768
 buffer_load_dwordx4 v[48:51], v1, s[44:47], s55 offen offset:0 sc1
 buffer_load_dwordx4 v[52:55], v1, s[44:47], s55 offen offset:1024 sc1
 s_waitcnt lgkmcnt(8)
 MF 168,44,112,168
 TR 32,7,5152
 MF 172,44,116,172
 TR 34,7,7712
 buffer_load_dwordx4 v[56:59], v1, s[44:47], s55 offen offset:2048 sc1
 buffer_load_dwordx4 v[60:63], v1, s[44:47], s55 offen offset:3072 sc1
 s_waitcnt lgkmcnt(8)
 MF 176,16,112,176
 TR 36,7,5184
 MF 180,16,116,180
 TR 38,7,7744
 s_add_u32 s55, s82, 40960
 buffer_load_dwordx4 v[64:67], v1, s[44:47], s55 offen offset:0 sc1
 s_waitcnt lgkmcnt(8)
 MF 184,20,112,184
 TR 40,7,5216
 MF 188,20,116,188
 TR 42,7,7776
 buffer_load_dwordx4 v[68:71], v1, s[44:47], s55 offen offset:1024 sc1
 buffer_load_dwordx4 v[72:75], v1, s[44:47], s55 offen offset:2048 sc1
 s_waitcnt lgkmcnt(8)
 MF 192,24,112,192
 TR 44,7,5248
 MF 196,24,116,196
 TR 46,7,7808
 buffer_load_dwordx4 v[76:79], v1, s[44:47], s55 offen offset:3072 sc1
 s_waitcnt lgkmcnt(8)
 MF 160,28,120,160
 s_barrier
 v_add_u32 v7, 0x5000, v7
 TR 16,7,0
 MF 164,28,124,164
 TR 18,7,2560
 s_add_u32 s54, s84, s85
 s_add_u32 s54, s54, 0x1e000
 s_add_u32 m0, s85, 143360
 s_nop 0
 buffer_load_dwordx4 v1, s[44:47], s54 offen offset:0 sc1 lds
 s_waitcnt lgkmcnt(8)
 MF 168,32,120,168
 TR 20,7,32
 MF 172,32,124,172
 TR 22,7,2592
 buffer_load_dwordx4 v1, s[44:47], s54 offen offset:1024 sc1 lds
 s_waitcnt lgkmcnt(8)
 MF 176,36,120,176
 TR 24,7,64
 MF 180,36,124,180
 TR 26,7,2624
 buffer_load_dwordx4 v1, s[44:47], s54 offen offset:2048 sc1 lds
 s_waitcnt lgkmcnt(8)
 MF 184,40,120,184
 TR 28,7,96
 MF 188,40,124,188
 TR 30,7,2656
 s_waitcnt lgkmcnt(8)
 MF 192,44,120,192
 TR 32,7,128
 MF 196,44,124,196
 TR 34,7,2688
 s_waitcnt lgkmcnt(8)
 MF 160,16,128,160
 TR 36,7,5120
 MF 164,16,132,164
 TR 38,7,7680
 s_add_u32 s55, s82, 49152
 buffer_load_dwordx4 v[80:83], v1, s[44:47], s55 offen offset:0 sc1
 s_waitcnt lgkmcnt(8)
 MF 168,20,128,168
 TR 40,7,5152
 MF 172,20,132,172
 TR 42,7,7712
 buffer_load_dwordx4 v[84:87], v1, s[44:47], s55 offen offset:1024 sc1
 s_waitcnt lgkmcnt(8)
 MF 176,24,128,176
 TR 44,7,5184
 MF 180,24,132,180
 TR 46,7,7744
 buffer_load_dwordx4 v[88:91], v1, s[44:47], s55 offen offset:2048 sc1
 s_waitcnt lgkmcnt(8)
 MF 184,28,128,184
 TR 16,7,5216
 MF 188,28,132,188
 TR 18,7,7776
 buffer_load_dwordx4 v[92:95], v1, s[44:47], s55 offen offset:3072 sc1
 s_waitcnt lgkmcnt(8)
 MF 192,32,128,192
 TR 20,7,5248
 MF 196,32,132,196
 TR 22,7,7808
 s_waitcnt lgkmcnt(8)
 MF 160,36,136,160
 s_barrier
 v_add_u32 v7, 0x5000, v7
 TR 24,7,0
 MF 164,36,140,164
 TR 26,7,2560
 s_add_u32 s54, s84, s85
 s_add_u32 s54, s54, 0x23000
 s_add_u32 m0, s85, 0
 s_nop 0
 buffer_load_dwordx4 v1, s[44:47], s54 offen offset:0 sc1 lds
 s_waitcnt lgkmcnt(8)
 MF 168,40,136,168
 TR 28,7,32
 MF 172,40,140,172
 TR 30,7,2592
 buffer_load_dwordx4 v1, s[44:47], s54 offen offset:1024 sc1 lds
 s_waitcnt lgkmcnt(8)
 MF 176,44,136,176
 TR 32,7,64
 MF 180,44,140,180
 TR 34,7,2624
 buffer_load_dwordx4 v1, s[44:47], s54 offen offset:2048 sc1 lds
 s_waitcnt lgkmcnt(8)
 MF 184,16,136,184
 TR 36,7,96
 MF 188,16,140,188
 TR 38,7,2656
 s_waitcnt lgkmcnt(8)
 MF 192,20,136,192
 TR 40,7,128
 MF 196,20,140,196
 TR 42,7,2688
 s_waitcnt lgkmcnt(8)
 MF 160,24,144,160
 TR 44,7,5120
 MF 164,24,148,164
 TR 46,7,7680
 s_add_u32 s55, s82, 57344
 buffer_load_dwordx4 v[96:99], v1, s[44:47], s55 offen offset:0 sc1
 s_waitcnt lgkmcnt(8)
 MF 168,28,144,168
 TR 16,7,5152
 MF 172,28,148,172
 TR 18,7,7712
 buffer_load_dwordx4 v[100:103], v1, s[44:47], s55 offen offset:1024 sc1
 s_waitcnt lgkmcnt(8)
 MF 176,32,144,176
 TR 20,7,5184
 MF 180,32,148,180
 TR 22,7,7744
 buffer_load_dwordx4 v[104:107], v1, s[44:47], s55 offen offset:2048 sc1
 s_waitcnt lgkmcnt(8)
 MF 184,36,144,184
 TR 24,7,5216
 MF 188,36,148,188
 TR 26,7,7776
 buffer_load_dwordx4 v[108:111], v1, s[44:47], s55 offen offset:3072 sc1
 s_waitcnt lgkmcnt(8)
 MF 192,40,144,192
 TR 28,7,5248
 MF 196,40,148,196
 TR 30,7,7808
 s_waitcnt lgkmcnt(8)
 MF 160,44,152,160
 s_waitcnt vmcnt(25)
 s_barrier
 v_add_u32 v7, 0x5000, v7
 TR 32,7,0
 MF 164,44,156,164
 TR 34,7,2560
 s_add_u32 s54, s84, s85
 s_add_u32 s54, s54, 0x3c000
 s_add_u32 m0, s85, 20480
 s_nop 0
 buffer_load_dwordx4 v1, s[44:47], s54 offen offset:0 sc1 lds
 s_waitcnt lgkmcnt(8)
 MF 168,16,152,168
 TR 36,7,32
 MF 172,16,156,172
 TR 38,7,2592
 buffer_load_dwordx4 v1, s[44:47], s54 offen offset:1024 sc1 lds
 s_waitcnt lgkmcnt(8)
 MF 176,20,152,176
 TR 40,7,64
 MF 180,20,156,180
 TR 42,7,2624
 buffer_load_dwordx4 v1, s[44:47], s54 offen offset:2048 sc1 lds
 s_waitcnt lgkmcnt(8)
 MF 184,24,152,184
 TR 44,7,96
 MF 188,24,156,188
 TR 46,7,2656
 s_waitcnt lgkmcnt(8)
 MF 192,28,152,192
 TR 16,7,128
 MF 196,28,156,196
 TR 18,7,2688
 s_waitcnt lgkmcnt(8)
 s_waitcnt vmcnt(23)
 MF 160,32,48,160
 TR 20,7,5120
 MF 164,32,52,164
 TR 22,7,7680
 s_add_u32 s55, s82, 98304
 buffer_load_dwordx4 v[112:115], v1, s[44:47], s55 offen offset:0 sc1
 s_waitcnt lgkmcnt(8)
 MF 168,36,48,168
 TR 24,7,5152
 MF 172,36,52,172
 TR 26,7,7712
 buffer_load_dwordx4 v[116:119], v1, s[44:47], s55 offen offset:1024 sc1
 s_waitcnt lgkmcnt(8)
 MF 176,40,48,176
 TR 28,7,5184
 MF 180,40,52,180
 TR 30,7,7744
 buffer_load_dwordx4 v[120:123], v1, s[44:47], s55 offen offset:2048 sc1
 s_waitcnt lgkmcnt(8)
 MF 184,44,48,184
 TR 32,7,5216
 MF 188,44,52,188
 TR 34,7,7776
 buffer_load_dwordx4 v[124:127], v1, s[44:47], s55 offen offset:3072 sc1
 s_waitcnt lgkmcnt(8)
 MF 192,16,48,192
 TR 36,7,5248
 MF 196,16,52,196
 TR 38,7,7808
 s_waitcnt lgkmcnt(8)
 s_waitcnt vmcnt(25)
 MF 160,20,56,160
 s_barrier
 v_add_u32 v7, 0x5000, v7
 TR 40,7,0
 MF 164,20,60,164
 TR 42,7,2560
 s_add_u32 s54, s84, s85
 s_add_u32 s54, s54, 0x41000
 s_add_u32 m0, s85, 40960
 s_nop 0
 buffer_load_dwordx4 v1, s[44:47], s54 offen offset:0 sc1 lds
 s_waitcnt lgkmcnt(8)
 MF 168,24,56,168
 TR 44,7,32
 MF 172,24,60,172
 TR 46,7,2592
 buffer_load_dwordx4 v1, s[44:47], s54 offen offset:1024 sc1 lds
 s_waitcnt lgkmcnt(8)
 MF 176,28,56,176
 TR 16,7,64
 MF 180,28,60,180
 TR 18,7,2624
 buffer_load_dwordx4 v1, s[44:47], s54 offen offset:2048 sc1 lds
 s_waitcnt lgkmcnt(8)
 MF 184,32,56,184
 TR 20,7,96
 MF 188,32,60,188
 TR 22,7,2656
 s_waitcnt lgkmcnt(8)
 MF 192,36,56,192
 TR 24,7,128
 MF 196,36,60,196
 TR 26,7,2688
 s_waitcnt lgkmcnt(8)
 s_waitcnt vmcnt(26)
 MF 160,40,64,160
 TR 28,7,5120
 MF 164,40,68,164
 TR 30,7,7680
 s_add_u32 s55, s82, 106496
 buffer_load_dwordx4 v[128:131], v1, s[44:47], s55 offen offset:0 sc1
 s_waitcnt lgkmcnt(8)
 MF 168,44,64,168
 TR 32,7,5152
 MF 172,44,68,172
 TR 34,7,7712
 buffer_load_dwordx4 v[132:135], v1, s[44:47], s55 offen offset:1024 sc1
 s_waitcnt lgkmcnt(8)
 MF 176,16,64,176
 TR 36,7,5184
 MF 180,16,68,180
 TR 38,7,7744
 buffer_load_dwordx4 v[136:139], v1, s[44:47], s55 offen offset:2048 sc1
 s_waitcnt lgkmcnt(8)
 MF 184,20,64,184
 TR 40,7,5216
 MF 188,20,68,188
 TR 42,7,7776
 buffer_load_dwordx4 v[140:143], v1, s[44:47], s55 offen offset:3072 sc1
 s_waitcnt lgkmcnt(8)
 MF 192,24,64,192
 TR 44,7,5248
 MF 196,24,68,196
 TR 46,7,7808
 s_waitcnt lgkmcnt(8)
 s_waitcnt vmcnt(28)
 MF 160,28,72,160
 s_waitcnt vmcnt(25)
 s_barrier
 v_add_u32 v7, 0x5000, v7
 TR 16,7,0
 MF 164,28,76,164
 TR 18,7,2560
 s_add_u32 s54, s84, s85
 s_add_u32 s54, s54, 0x46000
 s_add_u32 m0, s85, 61440
 s_nop 0
 buffer_load_dwordx4 v1, s[44:47], s54 offen offset:0 sc1 lds
 s_waitcnt lgkmcnt(8)
 MF 168,32,72,168
 TR 20,7,32
 MF 172,32,76,172
 TR 22,7,2592
 buffer_load_dwordx4 v1, s[44:47], s54 offen offset:1024 sc1 lds
 s_waitcnt lgkmcnt(8)
 MF 176,36,72,176
 TR 24,7,64
 MF 180,36,76,180
 TR 26,7,2624
 buffer_load_dwordx4 v1, s[44:47], s54 offen offset:2048 sc1 lds
 s_waitcnt lgkmcnt(8)
 MF 184,40,72,184
 TR 28,7,96
 MF 188,40,76,188
 TR 30,7,2656
 s_waitcnt lgkmcnt(8)
 MF 192,44,72,192
 TR 32,7,128
 MF 196,44,76,196
 TR 34,7,2688
 s_waitcnt lgkmcnt(8)
 s_waitcnt vmcnt(26)
 MF 160,16,80,160
 TR 36,7,5120
 MF 164,16,84,164
 TR 38,7,7680
 s_add_u32 s55, s82, 114688
 buffer_load_dwordx4 v[144:147], v1, s[44:47], s55 offen offset:0 sc1
 s_waitcnt lgkmcnt(8)
 MF 168,20,80,168
 TR 40,7,5152
 MF 172,20,84,172
 TR 42,7,7712
 buffer_load_dwordx4 v[148:151], v1, s[44:47], s55 offen offset:1024 sc1
 s_waitcnt lgkmcnt(8)
 MF 176,24,80,176
 TR 44,7,5184
 MF 180,24,84,180
 TR 46,7,7744
 buffer_load_dwordx4 v[152:155], v1, s[44:47], s55 offen offset:2048 sc1
 s_waitcnt lgkmcnt(8)
 MF 184,28,80,184
 TR 16,7,5216
 MF 188,28,84,188
 TR 18,7,7776
 buffer_load_dwordx4 v[156:159], v1, s[44:47], s55 offen offset:3072 sc1
 s_waitcnt lgkmcnt(8)
 MF 192,32,80,192
 TR 20,7,5248
 MF 196,32,84,196
 TR 22,7,7808
 s_waitcnt lgkmcnt(8)
 s_waitcnt vmcnt(28)
 MF 160,36,88,160
 s_waitcnt vmcnt(25)
 s_barrier
 v_add_u32 v7, 0xfffdd000, v7
 TR 24,7,0
 MF 164,36,92,164
 TR 26,7,2560
 s_add_u32 s54, s84, s85
 s_add_u32 s54, s54, 0x4b000
 s_add_u32 m0, s85, 81920
 s_nop 0
 buffer_load_dwordx4 v1, s[44:47], s54 offen offset:0 sc1 lds
 s_waitcnt lgkmcnt(8)
 MF 168,40,88,168
 TR 28,7,32
 MF 172,40,92,172
 TR 30,7,2592
 buffer_load_dwordx4 v1, s[44:47], s54 offen offset:1024 sc1 lds
 s_waitcnt lgkmcnt(8)
 MF 176,44,88,176
 TR 32,7,64
 MF 180,44,92,180
 TR 34,7,2624
 buffer_load_dwordx4 v1, s[44:47], s54 offen offset:2048 sc1 lds
 s_waitcnt lgkmcnt(8)
 MF 184,16,88,184
 TR 36,7,96
 MF 188,16,92,188
 TR 38,7,2656
 s_waitcnt lgkmcnt(8)
 MF 192,20,88,192
 TR 40,7,128
 MF 196,20,92,196
 TR 42,7,2688
 s_waitcnt lgkmcnt(8)
 s_waitcnt vmcnt(26)
 MF 160,24,96,160
 TR 44,7,5120
 MF 164,24,100,164
 TR 46,7,7680
 s_add_u32 s55, s82, 122880
 buffer_load_dwordx4 v[48:51], v1, s[44:47], s55 offen offset:0 sc1
 s_waitcnt lgkmcnt(8)
 MF 168,28,96,168
 TR 16,7,5152
 MF 172,28,100,172
 TR 18,7,7712
 buffer_load_dwordx4 v[52:55], v1, s[44:47], s55 offen offset:1024 sc1
 s_waitcnt lgkmcnt(8)
 MF 176,32,96,176
 TR 20,7,5184
 MF 180,32,100,180
 TR 22,7,7744
 buffer_load_dwordx4 v[56:59], v1, s[44:47], s55 offen offset:2048 sc1
 s_waitcnt lgkmcnt(8)
 MF 184,36,96,184
 TR 24,7,5216
 MF 188,36,100,188
 TR 26,7,7776
 buffer_load_dwordx4 v[60:63], v1, s[44:47], s55 offen offset:3072 sc1
 s_waitcnt lgkmcnt(8)
 MF 192,40,96,192
 TR 28,7,5248
 MF 196,40,100,196
 TR 30,7,7808
 s_waitcnt lgkmcnt(8)
 s_waitcnt vmcnt(28)
 MF 160,44,104,160
 s_waitcnt vmcnt(25)
 s_barrier
 v_add_u32 v7, 0x5000, v7
 TR 32,7,0
 MF 164,44,108,164
 TR 34,7,2560
 s_waitcnt lgkmcnt(8)
 MF 168,16,104,168
 TR 36,7,32
 MF 172,16,108,172
 TR 38,7,2592
 s_waitcnt lgkmcnt(8)
 MF 176,20,104,176
 TR 40,7,64
 MF 180,20,108,180
 TR 42,7,2624
 s_waitcnt lgkmcnt(8)
 MF 184,24,104,184
 TR 44,7,96
 MF 188,24,108,188
 TR 46,7,2656
 s_waitcnt lgkmcnt(8)
 MF 192,28,104,192
 TR 16,7,128
 MF 196,28,108,196
 TR 18,7,2688
 s_waitcnt lgkmcnt(8)
 s_waitcnt vmcnt(23)
 MF 160,32,112,160
 TR 20,7,5120
 MF 164,32,116,164
 TR 22,7,7680
 s_waitcnt lgkmcnt(8)
 MF 168,36,112,168
 TR 24,7,5152
 MF 172,36,116,172
 TR 26,7,7712
 s_waitcnt lgkmcnt(8)
 MF 176,40,112,176
 TR 28,7,5184
 MF 180,40,116,180
 TR 30,7,7744
 s_waitcnt lgkmcnt(8)
 MF 184,44,112,184
 TR 32,7,5216
 MF 188,44,116,188
 TR 34,7,7776
 s_waitcnt lgkmcnt(8)
 MF 192,16,112,192
 TR 36,7,5248
 MF 196,16,116,196
 TR 38,7,7808
 s_waitcnt lgkmcnt(8)
 s_waitcnt vmcnt(21)
 MF 160,20,120,160
 s_waitcnt vmcnt(18)
 s_barrier
 v_add_u32 v7, 0x5000, v7
 TR 40,7,0
 MF 164,20,124,164
 TR 42,7,2560
 s_waitcnt lgkmcnt(8)
 MF 168,24,120,168
 TR 44,7,32
 MF 172,24,124,172
 TR 46,7,2592
 s_waitcnt lgkmcnt(8)
 MF 176,28,120,176
 TR 16,7,64
 MF 180,28,124,180
 TR 18,7,2624
 s_waitcnt lgkmcnt(8)
 MF 184,32,120,184
 TR 20,7,96
 MF 188,32,124,188
 TR 22,7,2656
 s_waitcnt lgkmcnt(8)
 MF 192,36,120,192
 TR 24,7,128
 MF 196,36,124,196
 TR 26,7,2688
 s_waitcnt lgkmcnt(8)
 s_waitcnt vmcnt(16)
 MF 160,40,128,160
 TR 28,7,5120
 MF 164,40,132,164
 TR 30,7,7680
 s_waitcnt lgkmcnt(8)
 MF 168,44,128,168
 TR 32,7,5152
 MF 172,44,132,172
 TR 34,7,7712
 s_waitcnt lgkmcnt(8)
 MF 176,16,128,176
 TR 36,7,5184
 MF 180,16,132,180
 TR 38,7,7744
 s_waitcnt lgkmcnt(8)
 MF 184,20,128,184
 TR 40,7,5216
 MF 188,20,132,188
 TR 42,7,7776
 s_waitcnt lgkmcnt(8)
 MF 192,24,128,192
 TR 44,7,5248
 MF 196,24,132,196
 TR 46,7,7808
 s_waitcnt lgkmcnt(8)
 s_waitcnt vmcnt(14)
 MF 160,28,136,160
 s_waitcnt vmcnt(11)
 s_barrier
 v_add_u32 v7, 0x5000, v7
 TR 16,7,0
 MF 164,28,140,164
 TR 18,7,2560
 s_waitcnt lgkmcnt(8)
 MF 168,32,136,168
 TR 20,7,32
 MF 172,32,140,172
 TR 22,7,2592
 s_waitcnt lgkmcnt(8)
 MF 176,36,136,176
 TR 24,7,64
 MF 180,36,140,180
 TR 26,7,2624
 s_waitcnt lgkmcnt(8)
 MF 184,40,136,184
 TR 28,7,96
 MF 188,40,140,188
 TR 30,7,2656
 s_waitcnt lgkmcnt(8)
 MF 192,44,136,192
 TR 32,7,128
 MF 196,44,140,196
 TR 34,7,2688
 s_waitcnt lgkmcnt(8)
 s_waitcnt vmcnt(9)
 MF 160,16,144,160
 TR 36,7,5120
 MF 164,16,148,164
 TR 38,7,7680
 s_waitcnt lgkmcnt(8)
 MF 168,20,144,168
 TR 40,7,5152
 MF 172,20,148,172
 TR 42,7,7712
 s_waitcnt lgkmcnt(8)
 MF 176,24,144,176
 TR 44,7,5184
 MF 180,24,148,180
 TR 46,7,7744
 s_waitcnt lgkmcnt(8)
 MF 184,28,144,184
 TR 16,7,5216
 MF 188,28,148,188
 TR 18,7,7776
 s_waitcnt lgkmcnt(8)
 MF 192,32,144,192
 TR 20,7,5248
 MF 196,32,148,196
 TR 22,7,7808
 s_waitcnt lgkmcnt(8)
 s_waitcnt vmcnt(7)
 MF 160,36,152,160
 s_waitcnt vmcnt(4)
 s_barrier
 v_add_u32 v7, 0x5000, v7
 TR 24,7,0
 MF 164,36,156,164
 TR 26,7,2560
 s_waitcnt lgkmcnt(8)
 MF 168,40,152,168
 TR 28,7,32
 MF 172,40,156,172
 TR 30,7,2592
 s_waitcnt lgkmcnt(8)
 MF 176,44,152,176
 TR 32,7,64
 MF 180,44,156,180
 TR 34,7,2624
 s_waitcnt lgkmcnt(8)
 MF 184,16,152,184
 TR 36,7,96
 MF 188,16,156,188
 TR 38,7,2656
 s_waitcnt lgkmcnt(8)
 MF 192,20,152,192
 TR 40,7,128
 MF 196,20,156,196
 TR 42,7,2688
 s_waitcnt lgkmcnt(8)
 s_waitcnt vmcnt(2)
 MF 160,24,48,160
 TR 44,7,5120
 MF 164,24,52,164
 TR 46,7,7680
 s_waitcnt lgkmcnt(8)
 MF 168,28,48,168
 TR 16,7,5152
 MF 172,28,52,172
 TR 18,7,7712
 s_waitcnt lgkmcnt(8)
 MF 176,32,48,176
 TR 20,7,5184
 MF 180,32,52,180
 TR 22,7,7744
 s_waitcnt lgkmcnt(8)
 MF 184,36,48,184
 TR 24,7,5216
 MF 188,36,52,188
 TR 26,7,7776
 s_waitcnt lgkmcnt(8)
 MF 192,40,48,192
 TR 28,7,5248
 MF 196,40,52,196
 TR 30,7,7808
 s_waitcnt lgkmcnt(8)
 s_waitcnt vmcnt(0)
 MF 160,44,56,160
 MF 164,44,60,164
 s_waitcnt lgkmcnt(6)
 MF 168,16,56,168
 MF 172,16,60,172
 s_waitcnt lgkmcnt(4)
 MF 176,20,56,176
 MF 180,20,60,180
 s_waitcnt lgkmcnt(2)
 MF 184,24,56,184
 MF 188,24,60,188
 s_waitcnt lgkmcnt(0)
 MF 192,28,56,192
 MF 196,28,60,196
 s_mul_i32 s57, s48, 5120
 v_add_u32 v5, s57, v1
 s_xor_b32 s58, s48, 4
 s_mul_i32 s58, s58, 5120
 v_add_u32 v10, s58, v1
 v_add_u32 v5, 0, v5
 v_add_u32 v10, 0, v10
 s_nop 2
 ds_write_b128 v5, v[160:163] offset:0
 ds_write_b128 v5, v[168:171] offset:1024
 ds_write_b128 v5, v[176:179] offset:2048
 ds_write_b128 v5, v[184:187] offset:3072
 ds_write_b128 v5, v[192:195] offset:4096
 s_bfe_u32 s56, s48, 0x10001
 s_cmp_eq_u32 s56, s80
 s_cselect_b32 s56, 0xc1, 0
 s_xor_b32 s58, s2, s56
 s_mul_i32 s54, s58, 0xac00
 s_add_u32 s54, s54, s57
 s_add_u32 s54, s54, 0x3ae0000
 s_lshl_b32 s76, s58, 7
 s_lshl_b32 s58, s48, 2
 s_add_u32 s76, s76, s58
 s_add_u32 s76, s76, 45056
 s_waitcnt lgkmcnt(0)
 s_barrier
 RD 16,10,0
 RD 20,10,1024
 RD 24,10,2048
 RD 28,10,3072
 RD 32,10,4096
 s_cmp_lg_u32 s56, 0
 s_cbranch_scc1 Lkeep_111
 s_waitcnt lgkmcnt(4)
 v_pk_add_f32 v[164:165], v[164:165], v[16:17]
 v_pk_add_f32 v[166:167], v[166:167], v[18:19]
 buffer_store_dwordx4 v[164:167], v1, s[44:47], s54 offen offset:0 sc1
 s_waitcnt lgkmcnt(3)
 v_pk_add_f32 v[172:173], v[172:173], v[20:21]
 v_pk_add_f32 v[174:175], v[174:175], v[22:23]
 buffer_store_dwordx4 v[172:175], v1, s[44:47], s54 offen offset:1024 sc1
 s_waitcnt lgkmcnt(2)
 v_pk_add_f32 v[180:181], v[180:181], v[24:25]
 v_pk_add_f32 v[182:183], v[182:183], v[26:27]
 buffer_store_dwordx4 v[180:183], v1, s[44:47], s54 offen offset:2048 sc1
 s_waitcnt lgkmcnt(1)
 v_pk_add_f32 v[188:189], v[188:189], v[28:29]
 v_pk_add_f32 v[190:191], v[190:191], v[30:31]
 buffer_store_dwordx4 v[188:191], v1, s[44:47], s54 offen offset:3072 sc1
 s_waitcnt lgkmcnt(0)
 v_pk_add_f32 v[196:197], v[196:197], v[32:33]
 v_pk_add_f32 v[198:199], v[198:199], v[34:35]
 buffer_store_dwordx4 v[196:199], v15, s[44:47], s54 offen offset:0 sc1
 v_mov_b32 v5, 1
 s_waitcnt vmcnt(0)
 s_mov_b64 exec, 1
 buffer_store_dword v5, v4, s[44:47], s76 offen sc1
 s_endpgm
Lkeep_111:
 s_waitcnt lgkmcnt(4)
 v_pk_add_f32 v[164:165], v[164:165], v[16:17]
 v_pk_add_f32 v[166:167], v[166:167], v[18:19]
 s_waitcnt lgkmcnt(3)
 v_pk_add_f32 v[172:173], v[172:173], v[20:21]
 v_pk_add_f32 v[174:175], v[174:175], v[22:23]
 s_waitcnt lgkmcnt(2)
 v_pk_add_f32 v[180:181], v[180:181], v[24:25]
 v_pk_add_f32 v[182:183], v[182:183], v[26:27]
 s_waitcnt lgkmcnt(1)
 v_pk_add_f32 v[188:189], v[188:189], v[28:29]
 v_pk_add_f32 v[190:191], v[190:191], v[30:31]
 s_waitcnt lgkmcnt(0)
 v_pk_add_f32 v[196:197], v[196:197], v[32:33]
 v_pk_add_f32 v[198:199], v[198:199], v[34:35]
 s_mov_b32 s66, 0x10000
Lpoll_112:
 buffer_load_dword v10, v4, s[44:47], s76 offen sc1
 s_waitcnt vmcnt(0)
 v_readfirstlane_b32 s57, v10
 s_cmp_ge_u32 s57, 1
 s_cbranch_scc1 Lpolld_113
 s_sleep 2
 s_sub_u32 s66, s66, 1
 s_cmp_lg_u32 s66, 0
 s_cbranch_scc1 Lpoll_112
Lpolld_113:
 buffer_load_dwordx4 v[16:19], v1, s[44:47], s54 offen offset:0 sc1
 buffer_load_dwordx4 v[20:23], v1, s[44:47], s54 offen offset:1024 sc1
 buffer_load_dwordx4 v[24:27], v1, s[44:47], s54 offen offset:2048 sc1
 buffer_load_dwordx4 v[28:31], v1, s[44:47], s54 offen offset:3072 sc1
 buffer_load_dwordx4 v[32:35], v15, s[44:47], s54 offen offset:0 sc1
 s_waitcnt vmcnt(4)
 v_pk_add_f32 v[164:165], v[164:165], v[16:17]
 v_pk_add_f32 v[166:167], v[166:167], v[18:19]
 v_cvt_pk_bf16_f32 v164, v164, v165
 v_cvt_pk_bf16_f32 v165, v166, v167
 buffer_store_dwordx2 v[164:165], v6, s[36:39], 0 offen offset:0
 s_waitcnt vmcnt(4)
 v_pk_add_f32 v[172:173], v[172:173], v[20:21]
 v_pk_add_f32 v[174:175], v[174:175], v[22:23]
 v_cvt_pk_bf16_f32 v172, v172, v173
 v_cvt_pk_bf16_f32 v173, v174, v175
 buffer_store_dwordx2 v[172:173], v6, s[36:39], 0 offen offset:32
 s_waitcnt vmcnt(4)
 v_pk_add_f32 v[180:181], v[180:181], v[24:25]
 v_pk_add_f32 v[182:183], v[182:183], v[26:27]
 v_cvt_pk_bf16_f32 v180, v180, v181
 v_cvt_pk_bf16_f32 v181, v182, v183
 buffer_store_dwordx2 v[180:181], v6, s[36:39], 0 offen offset:64
 s_waitcnt vmcnt(4)
 v_pk_add_f32 v[188:189], v[188:189], v[28:29]
 v_pk_add_f32 v[190:191], v[190:191], v[30:31]
 v_cvt_pk_bf16_f32 v188, v188, v189
 v_cvt_pk_bf16_f32 v189, v190, v191
 buffer_store_dwordx2 v[188:189], v6, s[36:39], 0 offen offset:96
 s_waitcnt vmcnt(4)
 v_pk_add_f32 v[196:197], v[196:197], v[32:33]
 v_pk_add_f32 v[198:199], v[198:199], v[34:35]
 v_cvt_pk_bf16_f32 v196, v196, v197
 v_cvt_pk_bf16_f32 v197, v198, v199
 buffer_store_dwordx2 v[196:197], v6, s[36:39], 0 offen offset:128
 s_endpgm
 s_waitcnt vmcnt(0)
L_exit:
 s_endpgm
.section .rodata,"a"
.p2align 6
.amdhsa_kernel parallel_sum__compressed_kv_cla__dense_activation_relu__prompt_kernel
  .amdhsa_next_free_vgpr 256
  .amdhsa_next_free_sgpr 102
  .amdhsa_accum_offset 256
  .amdhsa_group_segment_fixed_size 0
  .amdhsa_kernarg_size 96
  .amdhsa_user_sgpr_count 2
  .amdhsa_user_sgpr_kernarg_segment_ptr 1
  .amdhsa_system_sgpr_workgroup_id_x 1
.end_amdhsa_kernel
```
